```python
import torch

def _softmax(x, axis=-1):
    return torch.softmax(x, dim=axis)

def _gelu(x):
    return torch.nn.functional.gelu(x, approximate='tanh')

def _silu(x):
    return torch.nn.functional.silu(x)

def _sigmoid(x):
    return torch.sigmoid(x)

def _layernorm(x, axis=-1, eps=1e-05):
    m = x.mean(dim=axis, keepdim=True)
    v = x.var(dim=axis, keepdim=True, unbiased=False)
    return (x - m) / torch.sqrt(v + eps)

def _scatter_add(tgt, idx, src, axis=0):
    return tgt.clone().index_add_(axis, idx, src)

def _segment_sum(src, seg, n):
    out = torch.zeros((n,) + src.shape[1:], dtype=src.dtype)
    return out.index_add_(0, seg, src)

def _pad(x, pw):
    flat = tuple((v for pair in reversed(pw) for v in pair))
    return torch.nn.functional.pad(x, flat)
kernel_name = 'adaLN_cond__sliding_block_cached__glu_gated_swiglu__decode'

def setup_inputs():

    _w = lambda a: (lambda t: t.to(torch.bfloat16) if t.is_floating_point() else t)(torch.as_tensor(a))

    def _A_setup():
        B, Sq, D = (2, 1, 512)
        Hq, Hkv, Sk, Dh = (32, 8, 32768, 128)
        assert Hq % Hkv == 0, (Hq, Hkv)
        return {'x': _w((lambda *s: torch.randn(*s, dtype=torch.bfloat16) * 0.05)(B, Sq, D)), 'k_cache': _w((lambda *s: torch.randn(*s, dtype=torch.bfloat16) * 3.2)(B, Hkv, Sk, Dh)), 'v_cache': _w((lambda *s: torch.randn(*s, dtype=torch.bfloat16) * 3.2)(B, Hkv, Sk, Dh)), 'wq': _w((lambda *s: torch.randn(*s, dtype=torch.bfloat16) * 3.2)(D, Hq * Dh) * D ** (-0.5)), 'wo': _w((lambda *s: torch.randn(*s, dtype=torch.bfloat16) * 3.2)(Hq * Dh, D) * (Hq * Dh) ** (-0.5))}
    _A_in = _A_setup()

    def _B_setup():
        B, S, D, F = (2, 1, 512, 1792)
        return {'x': _w((lambda *s: torch.randn(*s, dtype=torch.bfloat16) * 0.05)(B, S, D)), 'w1': _w((lambda *s: torch.randn(*s, dtype=torch.bfloat16) * 3.2)(D, F) * (2.0 / D) ** 0.5), 'w3': _w((lambda *s: torch.randn(*s, dtype=torch.bfloat16) * 3.2)(D, F) * (2.0 / D) ** 0.5), 'w2': _w((lambda *s: torch.randn(*s, dtype=torch.bfloat16) * 3.2)(F, D) * (2.0 / F) ** 0.5)}
    _B_in = _B_setup()
    return {'A_x': _A_in['x'], 'A_k_cache': _A_in['k_cache'], 'A_v_cache': _A_in['v_cache'], 'A_wq': _A_in['wq'], 'A_wo': _A_in['wo'], 'B_x': _B_in['x'], 'B_w1': _B_in['w1'], 'B_w3': _B_in['w3'], 'B_w2': _B_in['w2'], 'c': _w((lambda *s: torch.randn(*s, dtype=torch.bfloat16) * 0.2)(2, 512) * 8.0), 'w_mod': _w((lambda *s: torch.randn(*s, dtype=torch.bfloat16) * 0.2)(512, 6 * 512) * 512 ** (-0.5) * 8.0)}

def reference(A_x, A_k_cache, A_v_cache, A_wq, A_wo, B_x, B_w1, B_w3, B_w2, c, w_mod):

    def _A_ref(x, k_cache, v_cache, wq, wo):
        B, Sq, D = x.shape
        Hq, Dh = (32, 128)
        Hkv, Sk = (k_cache.shape[1], k_cache.shape[2])
        W = min(4096, max(256, Sk // 4))
        rep = Hq // Hkv
        q = (lambda x, *d: x.permute(*d))((x @ wq).reshape(B, Sq, Hq, Dh), 0, 2, 1, 3)
        k = (lambda x, n, axis: torch.repeat_interleave(x, n, dim=axis))(k_cache[:, :, Sk - W:, :], rep, axis=1)
        v = (lambda x, n, axis: torch.repeat_interleave(x, n, dim=axis))(v_cache[:, :, Sk - W:, :], rep, axis=1)
        scores = torch.einsum('bhqd,bhkd->bhqk', q, k) * Dh ** (-0.5)
        p = _softmax(scores, axis=-1)
        o = torch.einsum('bhqk,bhkd->bhqd', p, v)
        return (lambda x, *d: x.permute(*d))(o, 0, 2, 1, 3).reshape(B, Sq, Hq * Dh) @ wo

    def _B_ref(x, w1, w3, w2):
        gate = torch.einsum('bsd,df->bsf', x, w1)
        up = torch.einsum('bsd,df->bsf', x, w3)
        h = _silu(gate) * up
        out = torch.einsum('bsf,fd->bsd', h, w2)
        return out
    x = A_x
    mod = (_silu(c) @ w_mod).reshape(c.shape[0], 6, 1, -1)
    sa, ca, ga, sb, cb, gb = (mod[:, 0].clone(), mod[:, 1].clone(), mod[:, 2].clone(), mod[:, 3].clone(), mod[:, 4].clone(), mod[:, 5].clone())
    h = _layernorm(x, axis=-1) * (1 + ca) + sa
    x = x + ga * _A_ref(h, A_k_cache, A_v_cache, A_wq, A_wo)
    h = _layernorm(x, axis=-1) * (1 + cb) + sb
    x = x + gb * _B_ref(h, B_w1, B_w3, B_w2)
    return x
```

```asm
; @launch grid=(256,1,1) block=(512,1,1) lds=24064
.amdgcn_target "amdgcn-amd-amdhsa--gfx950"
.text
.globl adaLN_cond__sliding_block_cached__glu_gated_swiglu__decode_kernel
.p2align 8
.type adaLN_cond__sliding_block_cached__glu_gated_swiglu__decode_kernel,@function
adaLN_cond__sliding_block_cached__glu_gated_swiglu__decode_kernel:
  s_cmp_ge_u32 s2, 256
  s_cbranch_scc1 L_exit
  s_load_dwordx16 s[16:31], s[0:1], 0
  s_load_dwordx8 s[32:39], s[0:1], 64
  s_load_dwordx4 s[40:43], s[0:1], 96
  v_lshrrev_b32 v1, 6, v0
  v_and_b32 v0, 63, v0
  v_readfirstlane_b32 s3, v1
  s_and_b32 s4, s2, 7
  s_lshr_b32 s5, s2, 3
  s_cmp_lg_u32 s3, 7
  s_cbranch_scc1 L_nopf
  s_cmp_lt_u32 s5, 24
  s_cbranch_scc1 L_nopf
  s_getpc_b64 s[92:93]
L_pc:
  s_sub_u32 s92, s92, L_pc-adaLN_cond__sliding_block_cached__glu_gated_swiglu__decode_kernel
  s_subb_u32 s93, s93, 0
  v_lshlrev_b32 v7, 7, v0
  v_min_u32 v4, L_exit-adaLN_cond__sliding_block_cached__glu_gated_swiglu__decode_kernel, v7
  v_mov_b32 v5, s93
  v_add_co_u32 v4, vcc, s92, v4
  s_nop 1
  v_addc_co_u32 v5, vcc, 0, v5, vcc
  global_load_dword v240, v[4:5], off
  v_add_u32 v7, 0x2000, v7
  v_min_u32 v4, L_exit-adaLN_cond__sliding_block_cached__glu_gated_swiglu__decode_kernel, v7
  v_mov_b32 v5, s93
  v_add_co_u32 v4, vcc, s92, v4
  s_nop 1
  v_addc_co_u32 v5, vcc, 0, v5, vcc
  global_load_dword v241, v[4:5], off
  v_add_u32 v7, 0x2000, v7
  v_min_u32 v4, L_exit-adaLN_cond__sliding_block_cached__glu_gated_swiglu__decode_kernel, v7
  v_mov_b32 v5, s93
  v_add_co_u32 v4, vcc, s92, v4
  s_nop 1
  v_addc_co_u32 v5, vcc, 0, v5, vcc
  global_load_dword v242, v[4:5], off
  v_add_u32 v7, 0x2000, v7
  v_min_u32 v4, L_exit-adaLN_cond__sliding_block_cached__glu_gated_swiglu__decode_kernel, v7
  v_mov_b32 v5, s93
  v_add_co_u32 v4, vcc, s92, v4
  s_nop 1
  v_addc_co_u32 v5, vcc, 0, v5, vcc
  global_load_dword v243, v[4:5], off
  v_add_u32 v7, 0x2000, v7
  v_min_u32 v4, L_exit-adaLN_cond__sliding_block_cached__glu_gated_swiglu__decode_kernel, v7
  v_mov_b32 v5, s93
  v_add_co_u32 v4, vcc, s92, v4
  s_nop 1
  v_addc_co_u32 v5, vcc, 0, v5, vcc
  global_load_dword v244, v[4:5], off
  v_add_u32 v7, 0x2000, v7
  v_min_u32 v4, L_exit-adaLN_cond__sliding_block_cached__glu_gated_swiglu__decode_kernel, v7
  v_mov_b32 v5, s93
  v_add_co_u32 v4, vcc, s92, v4
  s_nop 1
  v_addc_co_u32 v5, vcc, 0, v5, vcc
  global_load_dword v245, v[4:5], off
L_nopf:
  s_cmp_lg_u32 s3, 0
  s_cbranch_scc1 L_nz
  v_lshlrev_b32 v8, 2, v0
  v_mov_b32 v9, 0
  ds_write_b32 v8, v9 offset:1024
L_nz:
  s_mov_b32 s80, 0x05040100
  s_mov_b32 s81, 0x07060302
  s_mov_b32 s82, 0xffff0000
  s_mov_b32 s84, 200000
  s_mov_b32 s85, 0x3fb8aa3b
  s_getreg_b32 s90, hwreg(HW_REG_XCC_ID, 0, 4)
  s_cmp_ge_u32 s3, 4
  s_cbranch_scc1 L_tile
  s_and_b32 s64, s5, 1
  s_lshr_b32 s65, s5, 1
  s_lshl_b32 s66, s64, 3
  s_add_u32 s66, s66, s4
  s_lshl_b32 s66, s66, 23
  s_add_u32 s66, s66, 7340032
  s_lshr_b32 s67, s5, 2
  s_add_u32 s67, s67, s5
  s_add_u32 s67, s67, s4
  s_and_b32 s67, s67, 3
  s_lshl_b32 s8, s3, 12
  s_add_u32 s66, s66, s8
  v_and_b32 v5, 3, v0
  v_lshlrev_b32 v5, 10, v5
  v_bfe_u32 v6, v0, 2, 2
  v_lshlrev_b32 v6, 8, v6
  v_lshrrev_b32 v7, 4, v0
  v_lshlrev_b32 v7, 4, v7
  v_add3_u32 v1, v5, v6, v7
  v_lshlrev_b32 v2, 4, v0
  v_mov_b32 v28, 1024
  s_cmp_lt_u32 s5, 4
  s_cbranch_scc1 L_kv_0
  s_cmp_lt_u32 s5, 12
  s_cbranch_scc1 L_kv_1
  s_cmp_lt_u32 s5, 20
  s_cbranch_scc1 L_kv_2
  s_cmp_lt_u32 s5, 24
  s_cbranch_scc1 L_kv_3
L_kv_4:
  s_sub_u32 s8, s65, 12
  s_mul_i32 s8, s8, 81920
  s_add_u32 s66, s66, s8
  s_add_u32 s66, s66, 720896
  s_add_u32 s68, s67, 0
  s_sub_u32 s8, s68, 5
  s_cmp_ge_u32 s68, 5
  s_cselect_b32 s68, s8, s68
  s_lshl_b32 s68, s68, 14
  s_add_u32 s70, s66, s68
  s_add_u32 s68, s67, 1
  s_sub_u32 s8, s68, 5
  s_cmp_ge_u32 s68, 5
  s_cselect_b32 s68, s8, s68
  s_lshl_b32 s68, s68, 14
  s_add_u32 s71, s66, s68
  s_add_u32 s68, s67, 2
  s_sub_u32 s8, s68, 5
  s_cmp_ge_u32 s68, 5
  s_cselect_b32 s68, s8, s68
  s_lshl_b32 s68, s68, 14
  s_add_u32 s72, s66, s68
  s_add_u32 s68, s67, 3
  s_sub_u32 s8, s68, 5
  s_cmp_ge_u32 s68, 5
  s_cselect_b32 s68, s8, s68
  s_lshl_b32 s68, s68, 14
  s_add_u32 s73, s66, s68
  s_add_u32 s68, s67, 4
  s_sub_u32 s8, s68, 5
  s_cmp_ge_u32 s68, 5
  s_cselect_b32 s68, s8, s68
  s_lshl_b32 s68, s68, 14
  s_add_u32 s74, s66, s68
  s_waitcnt lgkmcnt(0)
  s_barrier
  s_load_dword s6, s[42:43], 0
  s_mov_b32 s44, s42
  s_mov_b32 s45, s43
  s_mov_b32 s46, 0x180000
  s_mov_b32 s47, 0x20000
  s_mov_b32 s48, s18
  s_mov_b32 s49, s19
  s_mov_b32 s50, 0x8000000
  s_mov_b32 s51, 0x20000
  s_mov_b32 s52, s20
  s_mov_b32 s53, s21
  s_mov_b32 s54, 0x8000000
  s_mov_b32 s55, 0x20000
  buffer_load_dwordx4 v[64:67], v1, s[48:51], s70 offen offset:0 nt
  buffer_load_dwordx4 v[68:71], v1, s[48:51], s70 offen offset:64 nt
  buffer_load_dwordx4 v[72:75], v1, s[48:51], s70 offen offset:128 nt
  buffer_load_dwordx4 v[76:79], v1, s[48:51], s70 offen offset:192 nt
  s_waitcnt lgkmcnt(0)
  s_mul_i32 s7, s6, 1664525
  s_add_u32 s7, s7, 1013904223
  s_and_b32 s7, s7, 0xbfffbfff
  s_cmp_lg_u32 s3, 3
  s_cbranch_scc1 L_nxt_1
  s_lshl_b32 s8, s4, 9
  s_lshl_b32 s9, s5, 4
  s_add_u32 s8, s8, s9
  s_add_u32 s8, s8, 0xc1000
  v_mov_b32 v8, s90
  v_mov_b32 v9, 0
  v_mov_b32 v10, 0
  v_mov_b32 v11, s7
  v_mov_b32 v12, 0
  s_mov_b64 exec, 1
  buffer_store_dwordx4 v[8:11], v12, s[44:47], s8 offen sc1
  s_mov_b64 exec, -1
L_nxt_1:
  ds_read_b32 v29, v28
  buffer_load_dwordx4 v[80:83], v1, s[48:51], s71 offen offset:0 nt
  s_waitcnt vmcnt(4) lgkmcnt(0)
  v_cmp_ne_u32 vcc, 0, v29
  s_cbranch_vccnz L_ff_4_5
  ds_read_b32 v29, v28
  buffer_load_dwordx4 v[84:87], v1, s[48:51], s71 offen offset:64 nt
  s_waitcnt vmcnt(4) lgkmcnt(0)
  v_cmp_ne_u32 vcc, 0, v29
  s_cbranch_vccnz L_ff_4_6
  ds_read_b32 v29, v28
  buffer_load_dwordx4 v[88:91], v1, s[48:51], s71 offen offset:128 nt
  s_waitcnt vmcnt(4) lgkmcnt(0)
  v_cmp_ne_u32 vcc, 0, v29
  s_cbranch_vccnz L_ff_4_7
  ds_read_b32 v29, v28
  buffer_load_dwordx4 v[92:95], v1, s[48:51], s71 offen offset:192 nt
  s_waitcnt vmcnt(4) lgkmcnt(0)
  v_cmp_ne_u32 vcc, 0, v29
  s_cbranch_vccnz L_ff_4_8
  ds_read_b32 v29, v28
  buffer_load_dwordx4 v[96:99], v1, s[48:51], s72 offen offset:0 nt
  s_waitcnt vmcnt(4) lgkmcnt(0)
  v_cmp_ne_u32 vcc, 0, v29
  s_cbranch_vccnz L_ff_4_9
  ds_read_b32 v29, v28
  buffer_load_dwordx4 v[100:103], v1, s[48:51], s72 offen offset:64 nt
  s_waitcnt vmcnt(4) lgkmcnt(0)
  v_cmp_ne_u32 vcc, 0, v29
  s_cbranch_vccnz L_ff_4_10
  ds_read_b32 v29, v28
  buffer_load_dwordx4 v[104:107], v1, s[48:51], s72 offen offset:128 nt
  s_waitcnt vmcnt(4) lgkmcnt(0)
  v_cmp_ne_u32 vcc, 0, v29
  s_cbranch_vccnz L_ff_4_11
  ds_read_b32 v29, v28
  buffer_load_dwordx4 v[108:111], v1, s[48:51], s72 offen offset:192 nt
  s_waitcnt vmcnt(4) lgkmcnt(0)
  v_cmp_ne_u32 vcc, 0, v29
  s_cbranch_vccnz L_ff_4_12
  ds_read_b32 v29, v28
  buffer_load_dwordx4 v[112:115], v1, s[48:51], s73 offen offset:0 nt
  s_waitcnt vmcnt(4) lgkmcnt(0)
  v_cmp_ne_u32 vcc, 0, v29
  s_cbranch_vccnz L_ff_4_13
  ds_read_b32 v29, v28
  buffer_load_dwordx4 v[116:119], v1, s[48:51], s73 offen offset:64 nt
  s_waitcnt vmcnt(4) lgkmcnt(0)
  v_cmp_ne_u32 vcc, 0, v29
  s_cbranch_vccnz L_ff_4_14
  ds_read_b32 v29, v28
  buffer_load_dwordx4 v[120:123], v1, s[48:51], s73 offen offset:128 nt
  s_waitcnt vmcnt(4) lgkmcnt(0)
  v_cmp_ne_u32 vcc, 0, v29
  s_cbranch_vccnz L_ff_4_15
  ds_read_b32 v29, v28
  buffer_load_dwordx4 v[124:127], v1, s[48:51], s73 offen offset:192 nt
  s_waitcnt vmcnt(4) lgkmcnt(0)
  v_cmp_ne_u32 vcc, 0, v29
  s_cbranch_vccnz L_ff_4_16
  ds_read_b32 v29, v28
  buffer_load_dwordx4 v[128:131], v1, s[48:51], s74 offen offset:0 nt
  s_waitcnt vmcnt(4) lgkmcnt(0)
  v_cmp_ne_u32 vcc, 0, v29
  s_cbranch_vccnz L_ff_4_17
  ds_read_b32 v29, v28
  buffer_load_dwordx4 v[132:135], v1, s[48:51], s74 offen offset:64 nt
  s_waitcnt vmcnt(4) lgkmcnt(0)
  v_cmp_ne_u32 vcc, 0, v29
  s_cbranch_vccnz L_ff_4_18
  ds_read_b32 v29, v28
  buffer_load_dwordx4 v[136:139], v1, s[48:51], s74 offen offset:128 nt
  s_waitcnt vmcnt(4) lgkmcnt(0)
  v_cmp_ne_u32 vcc, 0, v29
  s_cbranch_vccnz L_ff_4_19
  ds_read_b32 v29, v28
  buffer_load_dwordx4 v[140:143], v1, s[48:51], s74 offen offset:192 nt
  s_waitcnt vmcnt(4) lgkmcnt(0)
  v_cmp_ne_u32 vcc, 0, v29
  s_cbranch_vccnz L_ff_4_20
  ds_read_b32 v29, v28
  buffer_load_dwordx4 v[144:147], v2, s[52:55], s70 offen offset:0 nt
  s_waitcnt vmcnt(4) lgkmcnt(0)
  v_cmp_ne_u32 vcc, 0, v29
  s_cbranch_vccnz L_ff_4_21
  ds_read_b32 v29, v28
  buffer_load_dwordx4 v[148:151], v2, s[52:55], s70 offen offset:1024 nt
  s_waitcnt vmcnt(4) lgkmcnt(0)
  v_cmp_ne_u32 vcc, 0, v29
  s_cbranch_vccnz L_ff_4_22
  ds_read_b32 v29, v28
  buffer_load_dwordx4 v[152:155], v2, s[52:55], s70 offen offset:2048 nt
  s_waitcnt vmcnt(4) lgkmcnt(0)
  v_cmp_ne_u32 vcc, 0, v29
  s_cbranch_vccnz L_ff_4_23
  ds_read_b32 v29, v28
  buffer_load_dwordx4 v[156:159], v2, s[52:55], s70 offen offset:3072 nt
  s_waitcnt vmcnt(4) lgkmcnt(0)
  v_cmp_ne_u32 vcc, 0, v29
  s_cbranch_vccnz L_ff_4_24
  ds_read_b32 v29, v28
  buffer_load_dwordx4 v[160:163], v2, s[52:55], s71 offen offset:0 nt
  s_waitcnt vmcnt(4) lgkmcnt(0)
  v_cmp_ne_u32 vcc, 0, v29
  s_cbranch_vccnz L_ff_4_25
  ds_read_b32 v29, v28
  buffer_load_dwordx4 v[164:167], v2, s[52:55], s71 offen offset:1024 nt
  s_waitcnt vmcnt(4) lgkmcnt(0)
  v_cmp_ne_u32 vcc, 0, v29
  s_cbranch_vccnz L_ff_4_26
  ds_read_b32 v29, v28
  buffer_load_dwordx4 v[168:171], v2, s[52:55], s71 offen offset:2048 nt
  s_waitcnt vmcnt(4) lgkmcnt(0)
  v_cmp_ne_u32 vcc, 0, v29
  s_cbranch_vccnz L_ff_4_27
  ds_read_b32 v29, v28
  buffer_load_dwordx4 v[172:175], v2, s[52:55], s71 offen offset:3072 nt
  s_waitcnt vmcnt(4) lgkmcnt(0)
  v_cmp_ne_u32 vcc, 0, v29
  s_cbranch_vccnz L_ff_4_28
  ds_read_b32 v29, v28
  buffer_load_dwordx4 v[176:179], v2, s[52:55], s72 offen offset:0 nt
  s_waitcnt vmcnt(4) lgkmcnt(0)
  v_cmp_ne_u32 vcc, 0, v29
  s_cbranch_vccnz L_ff_4_29
  ds_read_b32 v29, v28
  buffer_load_dwordx4 v[180:183], v2, s[52:55], s72 offen offset:1024 nt
  s_waitcnt vmcnt(4) lgkmcnt(0)
  v_cmp_ne_u32 vcc, 0, v29
  s_cbranch_vccnz L_ff_4_30
  ds_read_b32 v29, v28
  buffer_load_dwordx4 v[184:187], v2, s[52:55], s72 offen offset:2048 nt
  s_waitcnt vmcnt(4) lgkmcnt(0)
  v_cmp_ne_u32 vcc, 0, v29
  s_cbranch_vccnz L_ff_4_31
  ds_read_b32 v29, v28
  buffer_load_dwordx4 v[188:191], v2, s[52:55], s72 offen offset:3072 nt
  s_waitcnt vmcnt(4) lgkmcnt(0)
  v_cmp_ne_u32 vcc, 0, v29
  s_cbranch_vccnz L_ff_4_32
  ds_read_b32 v29, v28
  buffer_load_dwordx4 v[192:195], v2, s[52:55], s73 offen offset:0 nt
  s_waitcnt vmcnt(4) lgkmcnt(0)
  v_cmp_ne_u32 vcc, 0, v29
  s_cbranch_vccnz L_ff_4_33
  ds_read_b32 v29, v28
  buffer_load_dwordx4 v[196:199], v2, s[52:55], s73 offen offset:1024 nt
  s_waitcnt vmcnt(4) lgkmcnt(0)
  v_cmp_ne_u32 vcc, 0, v29
  s_cbranch_vccnz L_ff_4_34
  ds_read_b32 v29, v28
  buffer_load_dwordx4 v[200:203], v2, s[52:55], s73 offen offset:2048 nt
  s_waitcnt vmcnt(4) lgkmcnt(0)
  v_cmp_ne_u32 vcc, 0, v29
  s_cbranch_vccnz L_ff_4_35
  ds_read_b32 v29, v28
  buffer_load_dwordx4 v[204:207], v2, s[52:55], s73 offen offset:3072 nt
  s_waitcnt vmcnt(4) lgkmcnt(0)
  v_cmp_ne_u32 vcc, 0, v29
  s_cbranch_vccnz L_ff_4_36
  ds_read_b32 v29, v28
  buffer_load_dwordx4 v[208:211], v2, s[52:55], s74 offen offset:0 nt
  s_waitcnt vmcnt(4) lgkmcnt(0)
  v_cmp_ne_u32 vcc, 0, v29
  s_cbranch_vccnz L_ff_4_37
  ds_read_b32 v29, v28
  buffer_load_dwordx4 v[212:215], v2, s[52:55], s74 offen offset:1024 nt
  s_waitcnt vmcnt(4) lgkmcnt(0)
  v_cmp_ne_u32 vcc, 0, v29
  s_cbranch_vccnz L_ff_4_38
  ds_read_b32 v29, v28
  buffer_load_dwordx4 v[216:219], v2, s[52:55], s74 offen offset:2048 nt
  s_waitcnt vmcnt(4) lgkmcnt(0)
  v_cmp_ne_u32 vcc, 0, v29
  s_cbranch_vccnz L_ff_4_39
  buffer_load_dwordx4 v[220:223], v2, s[52:55], s74 offen offset:3072 nt
  s_branch L_kvj_5
L_ff_4_5:
  buffer_load_dwordx4 v[84:87], v1, s[48:51], s71 offen offset:64 nt
L_ff_4_6:
  buffer_load_dwordx4 v[88:91], v1, s[48:51], s71 offen offset:128 nt
L_ff_4_7:
  buffer_load_dwordx4 v[92:95], v1, s[48:51], s71 offen offset:192 nt
L_ff_4_8:
  buffer_load_dwordx4 v[96:99], v1, s[48:51], s72 offen offset:0 nt
L_ff_4_9:
  buffer_load_dwordx4 v[100:103], v1, s[48:51], s72 offen offset:64 nt
L_ff_4_10:
  buffer_load_dwordx4 v[104:107], v1, s[48:51], s72 offen offset:128 nt
L_ff_4_11:
  buffer_load_dwordx4 v[108:111], v1, s[48:51], s72 offen offset:192 nt
L_ff_4_12:
  buffer_load_dwordx4 v[112:115], v1, s[48:51], s73 offen offset:0 nt
L_ff_4_13:
  buffer_load_dwordx4 v[116:119], v1, s[48:51], s73 offen offset:64 nt
L_ff_4_14:
  buffer_load_dwordx4 v[120:123], v1, s[48:51], s73 offen offset:128 nt
L_ff_4_15:
  buffer_load_dwordx4 v[124:127], v1, s[48:51], s73 offen offset:192 nt
L_ff_4_16:
  buffer_load_dwordx4 v[128:131], v1, s[48:51], s74 offen offset:0 nt
L_ff_4_17:
  buffer_load_dwordx4 v[132:135], v1, s[48:51], s74 offen offset:64 nt
L_ff_4_18:
  buffer_load_dwordx4 v[136:139], v1, s[48:51], s74 offen offset:128 nt
L_ff_4_19:
  buffer_load_dwordx4 v[140:143], v1, s[48:51], s74 offen offset:192 nt
L_ff_4_20:
  buffer_load_dwordx4 v[144:147], v2, s[52:55], s70 offen offset:0 nt
L_ff_4_21:
  buffer_load_dwordx4 v[148:151], v2, s[52:55], s70 offen offset:1024 nt
L_ff_4_22:
  buffer_load_dwordx4 v[152:155], v2, s[52:55], s70 offen offset:2048 nt
L_ff_4_23:
  buffer_load_dwordx4 v[156:159], v2, s[52:55], s70 offen offset:3072 nt
L_ff_4_24:
  buffer_load_dwordx4 v[160:163], v2, s[52:55], s71 offen offset:0 nt
L_ff_4_25:
  buffer_load_dwordx4 v[164:167], v2, s[52:55], s71 offen offset:1024 nt
L_ff_4_26:
  buffer_load_dwordx4 v[168:171], v2, s[52:55], s71 offen offset:2048 nt
L_ff_4_27:
  buffer_load_dwordx4 v[172:175], v2, s[52:55], s71 offen offset:3072 nt
L_ff_4_28:
  buffer_load_dwordx4 v[176:179], v2, s[52:55], s72 offen offset:0 nt
L_ff_4_29:
  buffer_load_dwordx4 v[180:183], v2, s[52:55], s72 offen offset:1024 nt
L_ff_4_30:
  buffer_load_dwordx4 v[184:187], v2, s[52:55], s72 offen offset:2048 nt
L_ff_4_31:
  buffer_load_dwordx4 v[188:191], v2, s[52:55], s72 offen offset:3072 nt
L_ff_4_32:
  buffer_load_dwordx4 v[192:195], v2, s[52:55], s73 offen offset:0 nt
L_ff_4_33:
  buffer_load_dwordx4 v[196:199], v2, s[52:55], s73 offen offset:1024 nt
L_ff_4_34:
  buffer_load_dwordx4 v[200:203], v2, s[52:55], s73 offen offset:2048 nt
L_ff_4_35:
  buffer_load_dwordx4 v[204:207], v2, s[52:55], s73 offen offset:3072 nt
L_ff_4_36:
  buffer_load_dwordx4 v[208:211], v2, s[52:55], s74 offen offset:0 nt
L_ff_4_37:
  buffer_load_dwordx4 v[212:215], v2, s[52:55], s74 offen offset:1024 nt
L_ff_4_38:
  buffer_load_dwordx4 v[216:219], v2, s[52:55], s74 offen offset:2048 nt
L_ff_4_39:
  buffer_load_dwordx4 v[220:223], v2, s[52:55], s74 offen offset:3072 nt
  s_branch L_kvq_5
L_kv_0:
  s_sub_u32 s8, s65, 0
  s_mul_i32 s8, s8, 65536
  s_add_u32 s66, s66, s8
  s_add_u32 s66, s66, 0
  s_add_u32 s68, s67, 0
  s_sub_u32 s8, s68, 4
  s_cmp_ge_u32 s68, 4
  s_cselect_b32 s68, s8, s68
  s_lshl_b32 s68, s68, 14
  s_add_u32 s70, s66, s68
  s_add_u32 s68, s67, 1
  s_sub_u32 s8, s68, 4
  s_cmp_ge_u32 s68, 4
  s_cselect_b32 s68, s8, s68
  s_lshl_b32 s68, s68, 14
  s_add_u32 s71, s66, s68
  s_add_u32 s68, s67, 2
  s_sub_u32 s8, s68, 4
  s_cmp_ge_u32 s68, 4
  s_cselect_b32 s68, s8, s68
  s_lshl_b32 s68, s68, 14
  s_add_u32 s72, s66, s68
  s_add_u32 s68, s67, 3
  s_sub_u32 s8, s68, 4
  s_cmp_ge_u32 s68, 4
  s_cselect_b32 s68, s8, s68
  s_lshl_b32 s68, s68, 14
  s_add_u32 s73, s66, s68
  s_waitcnt lgkmcnt(0)
  s_barrier
  s_load_dword s6, s[42:43], 0
  s_mov_b32 s44, s42
  s_mov_b32 s45, s43
  s_mov_b32 s46, 0x180000
  s_mov_b32 s47, 0x20000
  s_mov_b32 s48, s18
  s_mov_b32 s49, s19
  s_mov_b32 s50, 0x8000000
  s_mov_b32 s51, 0x20000
  s_mov_b32 s52, s20
  s_mov_b32 s53, s21
  s_mov_b32 s54, 0x8000000
  s_mov_b32 s55, 0x20000
  s_waitcnt lgkmcnt(0)
  s_mul_i32 s7, s6, 1664525
  s_add_u32 s7, s7, 1013904223
  s_and_b32 s7, s7, 0xbfffbfff
  s_cmp_lg_u32 s3, 3
  s_cbranch_scc1 L_nxt_2
  s_lshl_b32 s8, s4, 9
  s_lshl_b32 s9, s5, 4
  s_add_u32 s8, s8, s9
  s_add_u32 s8, s8, 0xc1000
  v_mov_b32 v8, s90
  v_mov_b32 v9, 0
  v_mov_b32 v10, 0
  v_mov_b32 v11, s7
  v_mov_b32 v12, 0
  s_mov_b64 exec, 1
  buffer_store_dwordx4 v[8:11], v12, s[44:47], s8 offen sc1
  s_mov_b64 exec, -1
L_nxt_2:
  v_mov_b32 v12, 1136
L_lw_3:
  ds_read_b128 v[8:11], v12
  s_waitcnt lgkmcnt(0)
  v_min3_u32 v8, v8, v9, v10
  v_min_u32 v8, v8, v11
  v_cmp_ne_u32 vcc, 0, v8
  s_cbranch_vccnz L_lwd_4
  s_sub_u32 s84, s84, 1
  s_cbranch_scc0 L_lw_3
  s_mov_b32 s84, 0
L_lwd_4:
  buffer_load_dwordx4 v[64:67], v1, s[48:51], s70 offen offset:0 nt
  buffer_load_dwordx4 v[68:71], v1, s[48:51], s70 offen offset:64 nt
  buffer_load_dwordx4 v[72:75], v1, s[48:51], s70 offen offset:128 nt
  buffer_load_dwordx4 v[76:79], v1, s[48:51], s70 offen offset:192 nt
  v_mov_b32 v9, 1168
L_lw_5:
  ds_read_b32 v8, v9
  s_waitcnt lgkmcnt(0)
  v_cmp_ne_u32 vcc, 0, v8
  s_cbranch_vccnz L_lwd_6
  s_sub_u32 s84, s84, 1
  s_cbranch_scc0 L_lw_5
  s_mov_b32 s84, 0
L_lwd_6:
  ds_read_b32 v29, v28
  buffer_load_dwordx4 v[80:83], v1, s[48:51], s71 offen offset:0 nt
  s_waitcnt vmcnt(4) lgkmcnt(0)
  v_cmp_ne_u32 vcc, 0, v29
  s_cbranch_vccnz L_ff_0_5
  ds_read_b32 v29, v28
  buffer_load_dwordx4 v[84:87], v1, s[48:51], s71 offen offset:64 nt
  s_waitcnt vmcnt(4) lgkmcnt(0)
  v_cmp_ne_u32 vcc, 0, v29
  s_cbranch_vccnz L_ff_0_6
  ds_read_b32 v29, v28
  buffer_load_dwordx4 v[88:91], v1, s[48:51], s71 offen offset:128 nt
  s_waitcnt vmcnt(4) lgkmcnt(0)
  v_cmp_ne_u32 vcc, 0, v29
  s_cbranch_vccnz L_ff_0_7
  ds_read_b32 v29, v28
  buffer_load_dwordx4 v[92:95], v1, s[48:51], s71 offen offset:192 nt
  s_waitcnt vmcnt(4) lgkmcnt(0)
  v_cmp_ne_u32 vcc, 0, v29
  s_cbranch_vccnz L_ff_0_8
  ds_read_b32 v29, v28
  buffer_load_dwordx4 v[96:99], v1, s[48:51], s72 offen offset:0 nt
  s_waitcnt vmcnt(4) lgkmcnt(0)
  v_cmp_ne_u32 vcc, 0, v29
  s_cbranch_vccnz L_ff_0_9
  ds_read_b32 v29, v28
  buffer_load_dwordx4 v[100:103], v1, s[48:51], s72 offen offset:64 nt
  s_waitcnt vmcnt(4) lgkmcnt(0)
  v_cmp_ne_u32 vcc, 0, v29
  s_cbranch_vccnz L_ff_0_10
  ds_read_b32 v29, v28
  buffer_load_dwordx4 v[104:107], v1, s[48:51], s72 offen offset:128 nt
  s_waitcnt vmcnt(4) lgkmcnt(0)
  v_cmp_ne_u32 vcc, 0, v29
  s_cbranch_vccnz L_ff_0_11
  ds_read_b32 v29, v28
  buffer_load_dwordx4 v[108:111], v1, s[48:51], s72 offen offset:192 nt
  s_waitcnt vmcnt(4) lgkmcnt(0)
  v_cmp_ne_u32 vcc, 0, v29
  s_cbranch_vccnz L_ff_0_12
  ds_read_b32 v29, v28
  buffer_load_dwordx4 v[112:115], v1, s[48:51], s73 offen offset:0 nt
  s_waitcnt vmcnt(4) lgkmcnt(0)
  v_cmp_ne_u32 vcc, 0, v29
  s_cbranch_vccnz L_ff_0_13
  ds_read_b32 v29, v28
  buffer_load_dwordx4 v[116:119], v1, s[48:51], s73 offen offset:64 nt
  s_waitcnt vmcnt(4) lgkmcnt(0)
  v_cmp_ne_u32 vcc, 0, v29
  s_cbranch_vccnz L_ff_0_14
  ds_read_b32 v29, v28
  buffer_load_dwordx4 v[120:123], v1, s[48:51], s73 offen offset:128 nt
  s_waitcnt vmcnt(4) lgkmcnt(0)
  v_cmp_ne_u32 vcc, 0, v29
  s_cbranch_vccnz L_ff_0_15
  ds_read_b32 v29, v28
  buffer_load_dwordx4 v[124:127], v1, s[48:51], s73 offen offset:192 nt
  s_waitcnt vmcnt(4) lgkmcnt(0)
  v_cmp_ne_u32 vcc, 0, v29
  s_cbranch_vccnz L_ff_0_16
  ds_read_b32 v29, v28
  buffer_load_dwordx4 v[144:147], v2, s[52:55], s70 offen offset:0 nt
  s_waitcnt vmcnt(4) lgkmcnt(0)
  v_cmp_ne_u32 vcc, 0, v29
  s_cbranch_vccnz L_ff_0_17
  ds_read_b32 v29, v28
  buffer_load_dwordx4 v[148:151], v2, s[52:55], s70 offen offset:1024 nt
  s_waitcnt vmcnt(4) lgkmcnt(0)
  v_cmp_ne_u32 vcc, 0, v29
  s_cbranch_vccnz L_ff_0_18
  ds_read_b32 v29, v28
  buffer_load_dwordx4 v[152:155], v2, s[52:55], s70 offen offset:2048 nt
  s_waitcnt vmcnt(4) lgkmcnt(0)
  v_cmp_ne_u32 vcc, 0, v29
  s_cbranch_vccnz L_ff_0_19
  ds_read_b32 v29, v28
  buffer_load_dwordx4 v[156:159], v2, s[52:55], s70 offen offset:3072 nt
  s_waitcnt vmcnt(4) lgkmcnt(0)
  v_cmp_ne_u32 vcc, 0, v29
  s_cbranch_vccnz L_ff_0_20
  ds_read_b32 v29, v28
  buffer_load_dwordx4 v[160:163], v2, s[52:55], s71 offen offset:0 nt
  s_waitcnt vmcnt(4) lgkmcnt(0)
  v_cmp_ne_u32 vcc, 0, v29
  s_cbranch_vccnz L_ff_0_21
  ds_read_b32 v29, v28
  buffer_load_dwordx4 v[164:167], v2, s[52:55], s71 offen offset:1024 nt
  s_waitcnt vmcnt(4) lgkmcnt(0)
  v_cmp_ne_u32 vcc, 0, v29
  s_cbranch_vccnz L_ff_0_22
  ds_read_b32 v29, v28
  buffer_load_dwordx4 v[168:171], v2, s[52:55], s71 offen offset:2048 nt
  s_waitcnt vmcnt(4) lgkmcnt(0)
  v_cmp_ne_u32 vcc, 0, v29
  s_cbranch_vccnz L_ff_0_23
  ds_read_b32 v29, v28
  buffer_load_dwordx4 v[172:175], v2, s[52:55], s71 offen offset:3072 nt
  s_waitcnt vmcnt(4) lgkmcnt(0)
  v_cmp_ne_u32 vcc, 0, v29
  s_cbranch_vccnz L_ff_0_24
  ds_read_b32 v29, v28
  buffer_load_dwordx4 v[176:179], v2, s[52:55], s72 offen offset:0 nt
  s_waitcnt vmcnt(4) lgkmcnt(0)
  v_cmp_ne_u32 vcc, 0, v29
  s_cbranch_vccnz L_ff_0_25
  ds_read_b32 v29, v28
  buffer_load_dwordx4 v[180:183], v2, s[52:55], s72 offen offset:1024 nt
  s_waitcnt vmcnt(4) lgkmcnt(0)
  v_cmp_ne_u32 vcc, 0, v29
  s_cbranch_vccnz L_ff_0_26
  ds_read_b32 v29, v28
  buffer_load_dwordx4 v[184:187], v2, s[52:55], s72 offen offset:2048 nt
  s_waitcnt vmcnt(4) lgkmcnt(0)
  v_cmp_ne_u32 vcc, 0, v29
  s_cbranch_vccnz L_ff_0_27
  ds_read_b32 v29, v28
  buffer_load_dwordx4 v[188:191], v2, s[52:55], s72 offen offset:3072 nt
  s_waitcnt vmcnt(4) lgkmcnt(0)
  v_cmp_ne_u32 vcc, 0, v29
  s_cbranch_vccnz L_ff_0_28
  ds_read_b32 v29, v28
  buffer_load_dwordx4 v[192:195], v2, s[52:55], s73 offen offset:0 nt
  s_waitcnt vmcnt(4) lgkmcnt(0)
  v_cmp_ne_u32 vcc, 0, v29
  s_cbranch_vccnz L_ff_0_29
  ds_read_b32 v29, v28
  buffer_load_dwordx4 v[196:199], v2, s[52:55], s73 offen offset:1024 nt
  s_waitcnt vmcnt(4) lgkmcnt(0)
  v_cmp_ne_u32 vcc, 0, v29
  s_cbranch_vccnz L_ff_0_30
  ds_read_b32 v29, v28
  buffer_load_dwordx4 v[200:203], v2, s[52:55], s73 offen offset:2048 nt
  s_waitcnt vmcnt(4) lgkmcnt(0)
  v_cmp_ne_u32 vcc, 0, v29
  s_cbranch_vccnz L_ff_0_31
  buffer_load_dwordx4 v[204:207], v2, s[52:55], s73 offen offset:3072 nt
  s_branch L_kvj_4
L_ff_0_5:
  buffer_load_dwordx4 v[84:87], v1, s[48:51], s71 offen offset:64 nt
L_ff_0_6:
  buffer_load_dwordx4 v[88:91], v1, s[48:51], s71 offen offset:128 nt
L_ff_0_7:
  buffer_load_dwordx4 v[92:95], v1, s[48:51], s71 offen offset:192 nt
L_ff_0_8:
  buffer_load_dwordx4 v[96:99], v1, s[48:51], s72 offen offset:0 nt
L_ff_0_9:
  buffer_load_dwordx4 v[100:103], v1, s[48:51], s72 offen offset:64 nt
L_ff_0_10:
  buffer_load_dwordx4 v[104:107], v1, s[48:51], s72 offen offset:128 nt
L_ff_0_11:
  buffer_load_dwordx4 v[108:111], v1, s[48:51], s72 offen offset:192 nt
L_ff_0_12:
  buffer_load_dwordx4 v[112:115], v1, s[48:51], s73 offen offset:0 nt
L_ff_0_13:
  buffer_load_dwordx4 v[116:119], v1, s[48:51], s73 offen offset:64 nt
L_ff_0_14:
  buffer_load_dwordx4 v[120:123], v1, s[48:51], s73 offen offset:128 nt
L_ff_0_15:
  buffer_load_dwordx4 v[124:127], v1, s[48:51], s73 offen offset:192 nt
L_ff_0_16:
  buffer_load_dwordx4 v[144:147], v2, s[52:55], s70 offen offset:0 nt
L_ff_0_17:
  buffer_load_dwordx4 v[148:151], v2, s[52:55], s70 offen offset:1024 nt
L_ff_0_18:
  buffer_load_dwordx4 v[152:155], v2, s[52:55], s70 offen offset:2048 nt
L_ff_0_19:
  buffer_load_dwordx4 v[156:159], v2, s[52:55], s70 offen offset:3072 nt
L_ff_0_20:
  buffer_load_dwordx4 v[160:163], v2, s[52:55], s71 offen offset:0 nt
L_ff_0_21:
  buffer_load_dwordx4 v[164:167], v2, s[52:55], s71 offen offset:1024 nt
L_ff_0_22:
  buffer_load_dwordx4 v[168:171], v2, s[52:55], s71 offen offset:2048 nt
L_ff_0_23:
  buffer_load_dwordx4 v[172:175], v2, s[52:55], s71 offen offset:3072 nt
L_ff_0_24:
  buffer_load_dwordx4 v[176:179], v2, s[52:55], s72 offen offset:0 nt
L_ff_0_25:
  buffer_load_dwordx4 v[180:183], v2, s[52:55], s72 offen offset:1024 nt
L_ff_0_26:
  buffer_load_dwordx4 v[184:187], v2, s[52:55], s72 offen offset:2048 nt
L_ff_0_27:
  buffer_load_dwordx4 v[188:191], v2, s[52:55], s72 offen offset:3072 nt
L_ff_0_28:
  buffer_load_dwordx4 v[192:195], v2, s[52:55], s73 offen offset:0 nt
L_ff_0_29:
  buffer_load_dwordx4 v[196:199], v2, s[52:55], s73 offen offset:1024 nt
L_ff_0_30:
  buffer_load_dwordx4 v[200:203], v2, s[52:55], s73 offen offset:2048 nt
L_ff_0_31:
  buffer_load_dwordx4 v[204:207], v2, s[52:55], s73 offen offset:3072 nt
  s_branch L_kvq_4
L_kv_1:
  s_sub_u32 s8, s65, 2
  s_mul_i32 s8, s8, 40960
  s_add_u32 s66, s66, s8
  s_add_u32 s66, s66, 131072
  s_cmp_ge_u32 s3, 2
  s_cbranch_scc1 L_kvlo_1
  s_sub_u32 s8, s67, 3
  s_cmp_ge_u32 s67, 3
  s_cselect_b32 s67, s8, s67
  s_add_u32 s68, s67, 0
  s_sub_u32 s8, s68, 3
  s_cmp_ge_u32 s68, 3
  s_cselect_b32 s68, s8, s68
  s_lshl_b32 s68, s68, 14
  s_add_u32 s70, s66, s68
  s_add_u32 s68, s67, 1
  s_sub_u32 s8, s68, 3
  s_cmp_ge_u32 s68, 3
  s_cselect_b32 s68, s8, s68
  s_lshl_b32 s68, s68, 14
  s_add_u32 s71, s66, s68
  s_add_u32 s68, s67, 2
  s_sub_u32 s8, s68, 3
  s_cmp_ge_u32 s68, 3
  s_cselect_b32 s68, s8, s68
  s_lshl_b32 s68, s68, 14
  s_add_u32 s72, s66, s68
  s_waitcnt lgkmcnt(0)
  s_barrier
  s_load_dword s6, s[42:43], 0
  s_mov_b32 s44, s42
  s_mov_b32 s45, s43
  s_mov_b32 s46, 0x180000
  s_mov_b32 s47, 0x20000
  s_mov_b32 s48, s18
  s_mov_b32 s49, s19
  s_mov_b32 s50, 0x8000000
  s_mov_b32 s51, 0x20000
  s_mov_b32 s52, s20
  s_mov_b32 s53, s21
  s_mov_b32 s54, 0x8000000
  s_mov_b32 s55, 0x20000
  s_waitcnt lgkmcnt(0)
  s_mul_i32 s7, s6, 1664525
  s_add_u32 s7, s7, 1013904223
  s_and_b32 s7, s7, 0xbfffbfff
  s_cmp_lg_u32 s3, 3
  s_cbranch_scc1 L_nxt_7
  s_lshl_b32 s8, s4, 9
  s_lshl_b32 s9, s5, 4
  s_add_u32 s8, s8, s9
  s_add_u32 s8, s8, 0xc1000
  v_mov_b32 v8, s90
  v_mov_b32 v9, 0
  v_mov_b32 v10, 0
  v_mov_b32 v11, s7
  v_mov_b32 v12, 0
  s_mov_b64 exec, 1
  buffer_store_dwordx4 v[8:11], v12, s[44:47], s8 offen sc1
  s_mov_b64 exec, -1
L_nxt_7:
  v_mov_b32 v12, 1136
L_lw_8:
  ds_read_b128 v[8:11], v12
  s_waitcnt lgkmcnt(0)
  v_min3_u32 v8, v8, v9, v10
  v_min_u32 v8, v8, v11
  v_cmp_ne_u32 vcc, 0, v8
  s_cbranch_vccnz L_lwd_9
  s_sub_u32 s84, s84, 1
  s_cbranch_scc0 L_lw_8
  s_mov_b32 s84, 0
L_lwd_9:
  buffer_load_dwordx4 v[64:67], v1, s[48:51], s70 offen offset:0 nt
  buffer_load_dwordx4 v[68:71], v1, s[48:51], s70 offen offset:64 nt
  buffer_load_dwordx4 v[72:75], v1, s[48:51], s70 offen offset:128 nt
  buffer_load_dwordx4 v[76:79], v1, s[48:51], s70 offen offset:192 nt
  v_mov_b32 v9, 1168
L_lw_10:
  ds_read_b32 v8, v9
  s_waitcnt lgkmcnt(0)
  v_cmp_ne_u32 vcc, 0, v8
  s_cbranch_vccnz L_lwd_11
  s_sub_u32 s84, s84, 1
  s_cbranch_scc0 L_lw_10
  s_mov_b32 s84, 0
L_lwd_11:
  ds_read_b32 v29, v28
  buffer_load_dwordx4 v[80:83], v1, s[48:51], s71 offen offset:0 nt
  s_waitcnt vmcnt(4) lgkmcnt(0)
  v_cmp_ne_u32 vcc, 0, v29
  s_cbranch_vccnz L_ff_1h_5
  ds_read_b32 v29, v28
  buffer_load_dwordx4 v[84:87], v1, s[48:51], s71 offen offset:64 nt
  s_waitcnt vmcnt(4) lgkmcnt(0)
  v_cmp_ne_u32 vcc, 0, v29
  s_cbranch_vccnz L_ff_1h_6
  ds_read_b32 v29, v28
  buffer_load_dwordx4 v[88:91], v1, s[48:51], s71 offen offset:128 nt
  s_waitcnt vmcnt(4) lgkmcnt(0)
  v_cmp_ne_u32 vcc, 0, v29
  s_cbranch_vccnz L_ff_1h_7
  ds_read_b32 v29, v28
  buffer_load_dwordx4 v[92:95], v1, s[48:51], s71 offen offset:192 nt
  s_waitcnt vmcnt(4) lgkmcnt(0)
  v_cmp_ne_u32 vcc, 0, v29
  s_cbranch_vccnz L_ff_1h_8
  ds_read_b32 v29, v28
  buffer_load_dwordx4 v[96:99], v1, s[48:51], s72 offen offset:0 nt
  s_waitcnt vmcnt(4) lgkmcnt(0)
  v_cmp_ne_u32 vcc, 0, v29
  s_cbranch_vccnz L_ff_1h_9
  ds_read_b32 v29, v28
  buffer_load_dwordx4 v[100:103], v1, s[48:51], s72 offen offset:64 nt
  s_waitcnt vmcnt(4) lgkmcnt(0)
  v_cmp_ne_u32 vcc, 0, v29
  s_cbranch_vccnz L_ff_1h_10
  ds_read_b32 v29, v28
  buffer_load_dwordx4 v[104:107], v1, s[48:51], s72 offen offset:128 nt
  s_waitcnt vmcnt(4) lgkmcnt(0)
  v_cmp_ne_u32 vcc, 0, v29
  s_cbranch_vccnz L_ff_1h_11
  ds_read_b32 v29, v28
  buffer_load_dwordx4 v[108:111], v1, s[48:51], s72 offen offset:192 nt
  s_waitcnt vmcnt(4) lgkmcnt(0)
  v_cmp_ne_u32 vcc, 0, v29
  s_cbranch_vccnz L_ff_1h_12
  ds_read_b32 v29, v28
  buffer_load_dwordx4 v[144:147], v2, s[52:55], s70 offen offset:0 nt
  s_waitcnt vmcnt(4) lgkmcnt(0)
  v_cmp_ne_u32 vcc, 0, v29
  s_cbranch_vccnz L_ff_1h_13
  ds_read_b32 v29, v28
  buffer_load_dwordx4 v[148:151], v2, s[52:55], s70 offen offset:1024 nt
  s_waitcnt vmcnt(4) lgkmcnt(0)
  v_cmp_ne_u32 vcc, 0, v29
  s_cbranch_vccnz L_ff_1h_14
  ds_read_b32 v29, v28
  buffer_load_dwordx4 v[152:155], v2, s[52:55], s70 offen offset:2048 nt
  s_waitcnt vmcnt(4) lgkmcnt(0)
  v_cmp_ne_u32 vcc, 0, v29
  s_cbranch_vccnz L_ff_1h_15
  ds_read_b32 v29, v28
  buffer_load_dwordx4 v[156:159], v2, s[52:55], s70 offen offset:3072 nt
  s_waitcnt vmcnt(4) lgkmcnt(0)
  v_cmp_ne_u32 vcc, 0, v29
  s_cbranch_vccnz L_ff_1h_16
  ds_read_b32 v29, v28
  buffer_load_dwordx4 v[160:163], v2, s[52:55], s71 offen offset:0 nt
  s_waitcnt vmcnt(4) lgkmcnt(0)
  v_cmp_ne_u32 vcc, 0, v29
  s_cbranch_vccnz L_ff_1h_17
  ds_read_b32 v29, v28
  buffer_load_dwordx4 v[164:167], v2, s[52:55], s71 offen offset:1024 nt
  s_waitcnt vmcnt(4) lgkmcnt(0)
  v_cmp_ne_u32 vcc, 0, v29
  s_cbranch_vccnz L_ff_1h_18
  ds_read_b32 v29, v28
  buffer_load_dwordx4 v[168:171], v2, s[52:55], s71 offen offset:2048 nt
  s_waitcnt vmcnt(4) lgkmcnt(0)
  v_cmp_ne_u32 vcc, 0, v29
  s_cbranch_vccnz L_ff_1h_19
  ds_read_b32 v29, v28
  buffer_load_dwordx4 v[172:175], v2, s[52:55], s71 offen offset:3072 nt
  s_waitcnt vmcnt(4) lgkmcnt(0)
  v_cmp_ne_u32 vcc, 0, v29
  s_cbranch_vccnz L_ff_1h_20
  ds_read_b32 v29, v28
  buffer_load_dwordx4 v[176:179], v2, s[52:55], s72 offen offset:0 nt
  s_waitcnt vmcnt(4) lgkmcnt(0)
  v_cmp_ne_u32 vcc, 0, v29
  s_cbranch_vccnz L_ff_1h_21
  ds_read_b32 v29, v28
  buffer_load_dwordx4 v[180:183], v2, s[52:55], s72 offen offset:1024 nt
  s_waitcnt vmcnt(4) lgkmcnt(0)
  v_cmp_ne_u32 vcc, 0, v29
  s_cbranch_vccnz L_ff_1h_22
  ds_read_b32 v29, v28
  buffer_load_dwordx4 v[184:187], v2, s[52:55], s72 offen offset:2048 nt
  s_waitcnt vmcnt(4) lgkmcnt(0)
  v_cmp_ne_u32 vcc, 0, v29
  s_cbranch_vccnz L_ff_1h_23
  buffer_load_dwordx4 v[188:191], v2, s[52:55], s72 offen offset:3072 nt
  s_branch L_kvj_3
L_ff_1h_5:
  buffer_load_dwordx4 v[84:87], v1, s[48:51], s71 offen offset:64 nt
L_ff_1h_6:
  buffer_load_dwordx4 v[88:91], v1, s[48:51], s71 offen offset:128 nt
L_ff_1h_7:
  buffer_load_dwordx4 v[92:95], v1, s[48:51], s71 offen offset:192 nt
L_ff_1h_8:
  buffer_load_dwordx4 v[96:99], v1, s[48:51], s72 offen offset:0 nt
L_ff_1h_9:
  buffer_load_dwordx4 v[100:103], v1, s[48:51], s72 offen offset:64 nt
L_ff_1h_10:
  buffer_load_dwordx4 v[104:107], v1, s[48:51], s72 offen offset:128 nt
L_ff_1h_11:
  buffer_load_dwordx4 v[108:111], v1, s[48:51], s72 offen offset:192 nt
L_ff_1h_12:
  buffer_load_dwordx4 v[144:147], v2, s[52:55], s70 offen offset:0 nt
L_ff_1h_13:
  buffer_load_dwordx4 v[148:151], v2, s[52:55], s70 offen offset:1024 nt
L_ff_1h_14:
  buffer_load_dwordx4 v[152:155], v2, s[52:55], s70 offen offset:2048 nt
L_ff_1h_15:
  buffer_load_dwordx4 v[156:159], v2, s[52:55], s70 offen offset:3072 nt
L_ff_1h_16:
  buffer_load_dwordx4 v[160:163], v2, s[52:55], s71 offen offset:0 nt
L_ff_1h_17:
  buffer_load_dwordx4 v[164:167], v2, s[52:55], s71 offen offset:1024 nt
L_ff_1h_18:
  buffer_load_dwordx4 v[168:171], v2, s[52:55], s71 offen offset:2048 nt
L_ff_1h_19:
  buffer_load_dwordx4 v[172:175], v2, s[52:55], s71 offen offset:3072 nt
L_ff_1h_20:
  buffer_load_dwordx4 v[176:179], v2, s[52:55], s72 offen offset:0 nt
L_ff_1h_21:
  buffer_load_dwordx4 v[180:183], v2, s[52:55], s72 offen offset:1024 nt
L_ff_1h_22:
  buffer_load_dwordx4 v[184:187], v2, s[52:55], s72 offen offset:2048 nt
L_ff_1h_23:
  buffer_load_dwordx4 v[188:191], v2, s[52:55], s72 offen offset:3072 nt
  s_branch L_kvq_3
L_kvlo_1:
  s_sub_u32 s8, s67, 2
  s_cmp_ge_u32 s67, 2
  s_cselect_b32 s67, s8, s67
  s_add_u32 s68, s67, 0
  s_sub_u32 s8, s68, 2
  s_cmp_ge_u32 s68, 2
  s_cselect_b32 s68, s8, s68
  s_lshl_b32 s68, s68, 14
  s_add_u32 s70, s66, s68
  s_add_u32 s68, s67, 1
  s_sub_u32 s8, s68, 2
  s_cmp_ge_u32 s68, 2
  s_cselect_b32 s68, s8, s68
  s_lshl_b32 s68, s68, 14
  s_add_u32 s71, s66, s68
  s_waitcnt lgkmcnt(0)
  s_barrier
  s_load_dword s6, s[42:43], 0
  s_mov_b32 s44, s42
  s_mov_b32 s45, s43
  s_mov_b32 s46, 0x180000
  s_mov_b32 s47, 0x20000
  s_mov_b32 s48, s18
  s_mov_b32 s49, s19
  s_mov_b32 s50, 0x8000000
  s_mov_b32 s51, 0x20000
  s_mov_b32 s52, s20
  s_mov_b32 s53, s21
  s_mov_b32 s54, 0x8000000
  s_mov_b32 s55, 0x20000
  s_waitcnt lgkmcnt(0)
  s_mul_i32 s7, s6, 1664525
  s_add_u32 s7, s7, 1013904223
  s_and_b32 s7, s7, 0xbfffbfff
  s_cmp_lg_u32 s3, 3
  s_cbranch_scc1 L_nxt_12
  s_lshl_b32 s8, s4, 9
  s_lshl_b32 s9, s5, 4
  s_add_u32 s8, s8, s9
  s_add_u32 s8, s8, 0xc1000
  v_mov_b32 v8, s90
  v_mov_b32 v9, 0
  v_mov_b32 v10, 0
  v_mov_b32 v11, s7
  v_mov_b32 v12, 0
  s_mov_b64 exec, 1
  buffer_store_dwordx4 v[8:11], v12, s[44:47], s8 offen sc1
  s_mov_b64 exec, -1
L_nxt_12:
  v_mov_b32 v12, 1136
L_lw_13:
  ds_read_b128 v[8:11], v12
  s_waitcnt lgkmcnt(0)
  v_min3_u32 v8, v8, v9, v10
  v_min_u32 v8, v8, v11
  v_cmp_ne_u32 vcc, 0, v8
  s_cbranch_vccnz L_lwd_14
  s_sub_u32 s84, s84, 1
  s_cbranch_scc0 L_lw_13
  s_mov_b32 s84, 0
L_lwd_14:
  buffer_load_dwordx4 v[64:67], v1, s[48:51], s70 offen offset:0 nt
  buffer_load_dwordx4 v[68:71], v1, s[48:51], s70 offen offset:64 nt
  buffer_load_dwordx4 v[72:75], v1, s[48:51], s70 offen offset:128 nt
  buffer_load_dwordx4 v[76:79], v1, s[48:51], s70 offen offset:192 nt
  v_mov_b32 v9, 1168
L_lw_15:
  ds_read_b32 v8, v9
  s_waitcnt lgkmcnt(0)
  v_cmp_ne_u32 vcc, 0, v8
  s_cbranch_vccnz L_lwd_16
  s_sub_u32 s84, s84, 1
  s_cbranch_scc0 L_lw_15
  s_mov_b32 s84, 0
L_lwd_16:
  ds_read_b32 v29, v28
  buffer_load_dwordx4 v[80:83], v1, s[48:51], s71 offen offset:0 nt
  s_waitcnt vmcnt(4) lgkmcnt(0)
  v_cmp_ne_u32 vcc, 0, v29
  s_cbranch_vccnz L_ff_1l_5
  ds_read_b32 v29, v28
  buffer_load_dwordx4 v[84:87], v1, s[48:51], s71 offen offset:64 nt
  s_waitcnt vmcnt(4) lgkmcnt(0)
  v_cmp_ne_u32 vcc, 0, v29
  s_cbranch_vccnz L_ff_1l_6
  ds_read_b32 v29, v28
  buffer_load_dwordx4 v[88:91], v1, s[48:51], s71 offen offset:128 nt
  s_waitcnt vmcnt(4) lgkmcnt(0)
  v_cmp_ne_u32 vcc, 0, v29
  s_cbranch_vccnz L_ff_1l_7
  ds_read_b32 v29, v28
  buffer_load_dwordx4 v[92:95], v1, s[48:51], s71 offen offset:192 nt
  s_waitcnt vmcnt(4) lgkmcnt(0)
  v_cmp_ne_u32 vcc, 0, v29
  s_cbranch_vccnz L_ff_1l_8
  ds_read_b32 v29, v28
  buffer_load_dwordx4 v[144:147], v2, s[52:55], s70 offen offset:0 nt
  s_waitcnt vmcnt(4) lgkmcnt(0)
  v_cmp_ne_u32 vcc, 0, v29
  s_cbranch_vccnz L_ff_1l_9
  ds_read_b32 v29, v28
  buffer_load_dwordx4 v[148:151], v2, s[52:55], s70 offen offset:1024 nt
  s_waitcnt vmcnt(4) lgkmcnt(0)
  v_cmp_ne_u32 vcc, 0, v29
  s_cbranch_vccnz L_ff_1l_10
  ds_read_b32 v29, v28
  buffer_load_dwordx4 v[152:155], v2, s[52:55], s70 offen offset:2048 nt
  s_waitcnt vmcnt(4) lgkmcnt(0)
  v_cmp_ne_u32 vcc, 0, v29
  s_cbranch_vccnz L_ff_1l_11
  ds_read_b32 v29, v28
  buffer_load_dwordx4 v[156:159], v2, s[52:55], s70 offen offset:3072 nt
  s_waitcnt vmcnt(4) lgkmcnt(0)
  v_cmp_ne_u32 vcc, 0, v29
  s_cbranch_vccnz L_ff_1l_12
  ds_read_b32 v29, v28
  buffer_load_dwordx4 v[160:163], v2, s[52:55], s71 offen offset:0 nt
  s_waitcnt vmcnt(4) lgkmcnt(0)
  v_cmp_ne_u32 vcc, 0, v29
  s_cbranch_vccnz L_ff_1l_13
  ds_read_b32 v29, v28
  buffer_load_dwordx4 v[164:167], v2, s[52:55], s71 offen offset:1024 nt
  s_waitcnt vmcnt(4) lgkmcnt(0)
  v_cmp_ne_u32 vcc, 0, v29
  s_cbranch_vccnz L_ff_1l_14
  ds_read_b32 v29, v28
  buffer_load_dwordx4 v[168:171], v2, s[52:55], s71 offen offset:2048 nt
  s_waitcnt vmcnt(4) lgkmcnt(0)
  v_cmp_ne_u32 vcc, 0, v29
  s_cbranch_vccnz L_ff_1l_15
  buffer_load_dwordx4 v[172:175], v2, s[52:55], s71 offen offset:3072 nt
  s_branch L_kvj_2
L_ff_1l_5:
  buffer_load_dwordx4 v[84:87], v1, s[48:51], s71 offen offset:64 nt
L_ff_1l_6:
  buffer_load_dwordx4 v[88:91], v1, s[48:51], s71 offen offset:128 nt
L_ff_1l_7:
  buffer_load_dwordx4 v[92:95], v1, s[48:51], s71 offen offset:192 nt
L_ff_1l_8:
  buffer_load_dwordx4 v[144:147], v2, s[52:55], s70 offen offset:0 nt
L_ff_1l_9:
  buffer_load_dwordx4 v[148:151], v2, s[52:55], s70 offen offset:1024 nt
L_ff_1l_10:
  buffer_load_dwordx4 v[152:155], v2, s[52:55], s70 offen offset:2048 nt
L_ff_1l_11:
  buffer_load_dwordx4 v[156:159], v2, s[52:55], s70 offen offset:3072 nt
L_ff_1l_12:
  buffer_load_dwordx4 v[160:163], v2, s[52:55], s71 offen offset:0 nt
L_ff_1l_13:
  buffer_load_dwordx4 v[164:167], v2, s[52:55], s71 offen offset:1024 nt
L_ff_1l_14:
  buffer_load_dwordx4 v[168:171], v2, s[52:55], s71 offen offset:2048 nt
L_ff_1l_15:
  buffer_load_dwordx4 v[172:175], v2, s[52:55], s71 offen offset:3072 nt
  s_branch L_kvq_2
L_kv_2:
  s_sub_u32 s8, s65, 6
  s_mul_i32 s8, s8, 69632
  s_add_u32 s66, s66, s8
  s_add_u32 s66, s66, 294912
  s_cmp_ge_u32 s3, 1
  s_cbranch_scc1 L_kvlo_2
  s_add_u32 s68, s67, 0
  s_sub_u32 s8, s68, 5
  s_cmp_ge_u32 s68, 5
  s_cselect_b32 s68, s8, s68
  s_lshl_b32 s68, s68, 14
  s_add_u32 s70, s66, s68
  s_add_u32 s68, s67, 1
  s_sub_u32 s8, s68, 5
  s_cmp_ge_u32 s68, 5
  s_cselect_b32 s68, s8, s68
  s_lshl_b32 s68, s68, 14
  s_add_u32 s71, s66, s68
  s_add_u32 s68, s67, 2
  s_sub_u32 s8, s68, 5
  s_cmp_ge_u32 s68, 5
  s_cselect_b32 s68, s8, s68
  s_lshl_b32 s68, s68, 14
  s_add_u32 s72, s66, s68
  s_add_u32 s68, s67, 3
  s_sub_u32 s8, s68, 5
  s_cmp_ge_u32 s68, 5
  s_cselect_b32 s68, s8, s68
  s_lshl_b32 s68, s68, 14
  s_add_u32 s73, s66, s68
  s_add_u32 s68, s67, 4
  s_sub_u32 s8, s68, 5
  s_cmp_ge_u32 s68, 5
  s_cselect_b32 s68, s8, s68
  s_lshl_b32 s68, s68, 14
  s_add_u32 s74, s66, s68
  s_waitcnt lgkmcnt(0)
  s_barrier
  s_load_dword s6, s[42:43], 0
  s_mov_b32 s44, s42
  s_mov_b32 s45, s43
  s_mov_b32 s46, 0x180000
  s_mov_b32 s47, 0x20000
  s_mov_b32 s48, s18
  s_mov_b32 s49, s19
  s_mov_b32 s50, 0x8000000
  s_mov_b32 s51, 0x20000
  s_mov_b32 s52, s20
  s_mov_b32 s53, s21
  s_mov_b32 s54, 0x8000000
  s_mov_b32 s55, 0x20000
  buffer_load_dwordx4 v[64:67], v1, s[48:51], s70 offen offset:0 nt
  buffer_load_dwordx4 v[68:71], v1, s[48:51], s70 offen offset:64 nt
  buffer_load_dwordx4 v[72:75], v1, s[48:51], s70 offen offset:128 nt
  buffer_load_dwordx4 v[76:79], v1, s[48:51], s70 offen offset:192 nt
  s_waitcnt lgkmcnt(0)
  s_mul_i32 s7, s6, 1664525
  s_add_u32 s7, s7, 1013904223
  s_and_b32 s7, s7, 0xbfffbfff
  s_cmp_lg_u32 s3, 3
  s_cbranch_scc1 L_nxt_17
  s_lshl_b32 s8, s4, 9
  s_lshl_b32 s9, s5, 4
  s_add_u32 s8, s8, s9
  s_add_u32 s8, s8, 0xc1000
  v_mov_b32 v8, s90
  v_mov_b32 v9, 0
  v_mov_b32 v10, 0
  v_mov_b32 v11, s7
  v_mov_b32 v12, 0
  s_mov_b64 exec, 1
  buffer_store_dwordx4 v[8:11], v12, s[44:47], s8 offen sc1
  s_mov_b64 exec, -1
L_nxt_17:
  ds_read_b32 v29, v28
  buffer_load_dwordx4 v[80:83], v1, s[48:51], s71 offen offset:0 nt
  s_waitcnt vmcnt(4) lgkmcnt(0)
  v_cmp_ne_u32 vcc, 0, v29
  s_cbranch_vccnz L_ff_2h_5
  ds_read_b32 v29, v28
  buffer_load_dwordx4 v[84:87], v1, s[48:51], s71 offen offset:64 nt
  s_waitcnt vmcnt(4) lgkmcnt(0)
  v_cmp_ne_u32 vcc, 0, v29
  s_cbranch_vccnz L_ff_2h_6
  ds_read_b32 v29, v28
  buffer_load_dwordx4 v[88:91], v1, s[48:51], s71 offen offset:128 nt
  s_waitcnt vmcnt(4) lgkmcnt(0)
  v_cmp_ne_u32 vcc, 0, v29
  s_cbranch_vccnz L_ff_2h_7
  ds_read_b32 v29, v28
  buffer_load_dwordx4 v[92:95], v1, s[48:51], s71 offen offset:192 nt
  s_waitcnt vmcnt(4) lgkmcnt(0)
  v_cmp_ne_u32 vcc, 0, v29
  s_cbranch_vccnz L_ff_2h_8
  ds_read_b32 v29, v28
  buffer_load_dwordx4 v[96:99], v1, s[48:51], s72 offen offset:0 nt
  s_waitcnt vmcnt(4) lgkmcnt(0)
  v_cmp_ne_u32 vcc, 0, v29
  s_cbranch_vccnz L_ff_2h_9
  ds_read_b32 v29, v28
  buffer_load_dwordx4 v[100:103], v1, s[48:51], s72 offen offset:64 nt
  s_waitcnt vmcnt(4) lgkmcnt(0)
  v_cmp_ne_u32 vcc, 0, v29
  s_cbranch_vccnz L_ff_2h_10
  ds_read_b32 v29, v28
  buffer_load_dwordx4 v[104:107], v1, s[48:51], s72 offen offset:128 nt
  s_waitcnt vmcnt(4) lgkmcnt(0)
  v_cmp_ne_u32 vcc, 0, v29
  s_cbranch_vccnz L_ff_2h_11
  ds_read_b32 v29, v28
  buffer_load_dwordx4 v[108:111], v1, s[48:51], s72 offen offset:192 nt
  s_waitcnt vmcnt(4) lgkmcnt(0)
  v_cmp_ne_u32 vcc, 0, v29
  s_cbranch_vccnz L_ff_2h_12
  ds_read_b32 v29, v28
  buffer_load_dwordx4 v[112:115], v1, s[48:51], s73 offen offset:0 nt
  s_waitcnt vmcnt(4) lgkmcnt(0)
  v_cmp_ne_u32 vcc, 0, v29
  s_cbranch_vccnz L_ff_2h_13
  ds_read_b32 v29, v28
  buffer_load_dwordx4 v[116:119], v1, s[48:51], s73 offen offset:64 nt
  s_waitcnt vmcnt(4) lgkmcnt(0)
  v_cmp_ne_u32 vcc, 0, v29
  s_cbranch_vccnz L_ff_2h_14
  ds_read_b32 v29, v28
  buffer_load_dwordx4 v[120:123], v1, s[48:51], s73 offen offset:128 nt
  s_waitcnt vmcnt(4) lgkmcnt(0)
  v_cmp_ne_u32 vcc, 0, v29
  s_cbranch_vccnz L_ff_2h_15
  ds_read_b32 v29, v28
  buffer_load_dwordx4 v[124:127], v1, s[48:51], s73 offen offset:192 nt
  s_waitcnt vmcnt(4) lgkmcnt(0)
  v_cmp_ne_u32 vcc, 0, v29
  s_cbranch_vccnz L_ff_2h_16
  ds_read_b32 v29, v28
  buffer_load_dwordx4 v[128:131], v1, s[48:51], s74 offen offset:0 nt
  s_waitcnt vmcnt(4) lgkmcnt(0)
  v_cmp_ne_u32 vcc, 0, v29
  s_cbranch_vccnz L_ff_2h_17
  ds_read_b32 v29, v28
  buffer_load_dwordx4 v[132:135], v1, s[48:51], s74 offen offset:64 nt
  s_waitcnt vmcnt(4) lgkmcnt(0)
  v_cmp_ne_u32 vcc, 0, v29
  s_cbranch_vccnz L_ff_2h_18
  ds_read_b32 v29, v28
  buffer_load_dwordx4 v[136:139], v1, s[48:51], s74 offen offset:128 nt
  s_waitcnt vmcnt(4) lgkmcnt(0)
  v_cmp_ne_u32 vcc, 0, v29
  s_cbranch_vccnz L_ff_2h_19
  ds_read_b32 v29, v28
  buffer_load_dwordx4 v[140:143], v1, s[48:51], s74 offen offset:192 nt
  s_waitcnt vmcnt(4) lgkmcnt(0)
  v_cmp_ne_u32 vcc, 0, v29
  s_cbranch_vccnz L_ff_2h_20
  ds_read_b32 v29, v28
  buffer_load_dwordx4 v[144:147], v2, s[52:55], s70 offen offset:0 nt
  s_waitcnt vmcnt(4) lgkmcnt(0)
  v_cmp_ne_u32 vcc, 0, v29
  s_cbranch_vccnz L_ff_2h_21
  ds_read_b32 v29, v28
  buffer_load_dwordx4 v[148:151], v2, s[52:55], s70 offen offset:1024 nt
  s_waitcnt vmcnt(4) lgkmcnt(0)
  v_cmp_ne_u32 vcc, 0, v29
  s_cbranch_vccnz L_ff_2h_22
  ds_read_b32 v29, v28
  buffer_load_dwordx4 v[152:155], v2, s[52:55], s70 offen offset:2048 nt
  s_waitcnt vmcnt(4) lgkmcnt(0)
  v_cmp_ne_u32 vcc, 0, v29
  s_cbranch_vccnz L_ff_2h_23
  ds_read_b32 v29, v28
  buffer_load_dwordx4 v[156:159], v2, s[52:55], s70 offen offset:3072 nt
  s_waitcnt vmcnt(4) lgkmcnt(0)
  v_cmp_ne_u32 vcc, 0, v29
  s_cbranch_vccnz L_ff_2h_24
  ds_read_b32 v29, v28
  buffer_load_dwordx4 v[160:163], v2, s[52:55], s71 offen offset:0 nt
  s_waitcnt vmcnt(4) lgkmcnt(0)
  v_cmp_ne_u32 vcc, 0, v29
  s_cbranch_vccnz L_ff_2h_25
  ds_read_b32 v29, v28
  buffer_load_dwordx4 v[164:167], v2, s[52:55], s71 offen offset:1024 nt
  s_waitcnt vmcnt(4) lgkmcnt(0)
  v_cmp_ne_u32 vcc, 0, v29
  s_cbranch_vccnz L_ff_2h_26
  ds_read_b32 v29, v28
  buffer_load_dwordx4 v[168:171], v2, s[52:55], s71 offen offset:2048 nt
  s_waitcnt vmcnt(4) lgkmcnt(0)
  v_cmp_ne_u32 vcc, 0, v29
  s_cbranch_vccnz L_ff_2h_27
  ds_read_b32 v29, v28
  buffer_load_dwordx4 v[172:175], v2, s[52:55], s71 offen offset:3072 nt
  s_waitcnt vmcnt(4) lgkmcnt(0)
  v_cmp_ne_u32 vcc, 0, v29
  s_cbranch_vccnz L_ff_2h_28
  ds_read_b32 v29, v28
  buffer_load_dwordx4 v[176:179], v2, s[52:55], s72 offen offset:0 nt
  s_waitcnt vmcnt(4) lgkmcnt(0)
  v_cmp_ne_u32 vcc, 0, v29
  s_cbranch_vccnz L_ff_2h_29
  ds_read_b32 v29, v28
  buffer_load_dwordx4 v[180:183], v2, s[52:55], s72 offen offset:1024 nt
  s_waitcnt vmcnt(4) lgkmcnt(0)
  v_cmp_ne_u32 vcc, 0, v29
  s_cbranch_vccnz L_ff_2h_30
  ds_read_b32 v29, v28
  buffer_load_dwordx4 v[184:187], v2, s[52:55], s72 offen offset:2048 nt
  s_waitcnt vmcnt(4) lgkmcnt(0)
  v_cmp_ne_u32 vcc, 0, v29
  s_cbranch_vccnz L_ff_2h_31
  ds_read_b32 v29, v28
  buffer_load_dwordx4 v[188:191], v2, s[52:55], s72 offen offset:3072 nt
  s_waitcnt vmcnt(4) lgkmcnt(0)
  v_cmp_ne_u32 vcc, 0, v29
  s_cbranch_vccnz L_ff_2h_32
  ds_read_b32 v29, v28
  buffer_load_dwordx4 v[192:195], v2, s[52:55], s73 offen offset:0 nt
  s_waitcnt vmcnt(4) lgkmcnt(0)
  v_cmp_ne_u32 vcc, 0, v29
  s_cbranch_vccnz L_ff_2h_33
  ds_read_b32 v29, v28
  buffer_load_dwordx4 v[196:199], v2, s[52:55], s73 offen offset:1024 nt
  s_waitcnt vmcnt(4) lgkmcnt(0)
  v_cmp_ne_u32 vcc, 0, v29
  s_cbranch_vccnz L_ff_2h_34
  ds_read_b32 v29, v28
  buffer_load_dwordx4 v[200:203], v2, s[52:55], s73 offen offset:2048 nt
  s_waitcnt vmcnt(4) lgkmcnt(0)
  v_cmp_ne_u32 vcc, 0, v29
  s_cbranch_vccnz L_ff_2h_35
  ds_read_b32 v29, v28
  buffer_load_dwordx4 v[204:207], v2, s[52:55], s73 offen offset:3072 nt
  s_waitcnt vmcnt(4) lgkmcnt(0)
  v_cmp_ne_u32 vcc, 0, v29
  s_cbranch_vccnz L_ff_2h_36
  ds_read_b32 v29, v28
  buffer_load_dwordx4 v[208:211], v2, s[52:55], s74 offen offset:0 nt
  s_waitcnt vmcnt(4) lgkmcnt(0)
  v_cmp_ne_u32 vcc, 0, v29
  s_cbranch_vccnz L_ff_2h_37
  ds_read_b32 v29, v28
  buffer_load_dwordx4 v[212:215], v2, s[52:55], s74 offen offset:1024 nt
  s_waitcnt vmcnt(4) lgkmcnt(0)
  v_cmp_ne_u32 vcc, 0, v29
  s_cbranch_vccnz L_ff_2h_38
  ds_read_b32 v29, v28
  buffer_load_dwordx4 v[216:219], v2, s[52:55], s74 offen offset:2048 nt
  s_waitcnt vmcnt(4) lgkmcnt(0)
  v_cmp_ne_u32 vcc, 0, v29
  s_cbranch_vccnz L_ff_2h_39
  buffer_load_dwordx4 v[220:223], v2, s[52:55], s74 offen offset:3072 nt
  s_branch L_kvj_5
L_ff_2h_5:
  buffer_load_dwordx4 v[84:87], v1, s[48:51], s71 offen offset:64 nt
L_ff_2h_6:
  buffer_load_dwordx4 v[88:91], v1, s[48:51], s71 offen offset:128 nt
L_ff_2h_7:
  buffer_load_dwordx4 v[92:95], v1, s[48:51], s71 offen offset:192 nt
L_ff_2h_8:
  buffer_load_dwordx4 v[96:99], v1, s[48:51], s72 offen offset:0 nt
L_ff_2h_9:
  buffer_load_dwordx4 v[100:103], v1, s[48:51], s72 offen offset:64 nt
L_ff_2h_10:
  buffer_load_dwordx4 v[104:107], v1, s[48:51], s72 offen offset:128 nt
L_ff_2h_11:
  buffer_load_dwordx4 v[108:111], v1, s[48:51], s72 offen offset:192 nt
L_ff_2h_12:
  buffer_load_dwordx4 v[112:115], v1, s[48:51], s73 offen offset:0 nt
L_ff_2h_13:
  buffer_load_dwordx4 v[116:119], v1, s[48:51], s73 offen offset:64 nt
L_ff_2h_14:
  buffer_load_dwordx4 v[120:123], v1, s[48:51], s73 offen offset:128 nt
L_ff_2h_15:
  buffer_load_dwordx4 v[124:127], v1, s[48:51], s73 offen offset:192 nt
L_ff_2h_16:
  buffer_load_dwordx4 v[128:131], v1, s[48:51], s74 offen offset:0 nt
L_ff_2h_17:
  buffer_load_dwordx4 v[132:135], v1, s[48:51], s74 offen offset:64 nt
L_ff_2h_18:
  buffer_load_dwordx4 v[136:139], v1, s[48:51], s74 offen offset:128 nt
L_ff_2h_19:
  buffer_load_dwordx4 v[140:143], v1, s[48:51], s74 offen offset:192 nt
L_ff_2h_20:
  buffer_load_dwordx4 v[144:147], v2, s[52:55], s70 offen offset:0 nt
L_ff_2h_21:
  buffer_load_dwordx4 v[148:151], v2, s[52:55], s70 offen offset:1024 nt
L_ff_2h_22:
  buffer_load_dwordx4 v[152:155], v2, s[52:55], s70 offen offset:2048 nt
L_ff_2h_23:
  buffer_load_dwordx4 v[156:159], v2, s[52:55], s70 offen offset:3072 nt
L_ff_2h_24:
  buffer_load_dwordx4 v[160:163], v2, s[52:55], s71 offen offset:0 nt
L_ff_2h_25:
  buffer_load_dwordx4 v[164:167], v2, s[52:55], s71 offen offset:1024 nt
L_ff_2h_26:
  buffer_load_dwordx4 v[168:171], v2, s[52:55], s71 offen offset:2048 nt
L_ff_2h_27:
  buffer_load_dwordx4 v[172:175], v2, s[52:55], s71 offen offset:3072 nt
L_ff_2h_28:
  buffer_load_dwordx4 v[176:179], v2, s[52:55], s72 offen offset:0 nt
L_ff_2h_29:
  buffer_load_dwordx4 v[180:183], v2, s[52:55], s72 offen offset:1024 nt
L_ff_2h_30:
  buffer_load_dwordx4 v[184:187], v2, s[52:55], s72 offen offset:2048 nt
L_ff_2h_31:
  buffer_load_dwordx4 v[188:191], v2, s[52:55], s72 offen offset:3072 nt
L_ff_2h_32:
  buffer_load_dwordx4 v[192:195], v2, s[52:55], s73 offen offset:0 nt
L_ff_2h_33:
  buffer_load_dwordx4 v[196:199], v2, s[52:55], s73 offen offset:1024 nt
L_ff_2h_34:
  buffer_load_dwordx4 v[200:203], v2, s[52:55], s73 offen offset:2048 nt
L_ff_2h_35:
  buffer_load_dwordx4 v[204:207], v2, s[52:55], s73 offen offset:3072 nt
L_ff_2h_36:
  buffer_load_dwordx4 v[208:211], v2, s[52:55], s74 offen offset:0 nt
L_ff_2h_37:
  buffer_load_dwordx4 v[212:215], v2, s[52:55], s74 offen offset:1024 nt
L_ff_2h_38:
  buffer_load_dwordx4 v[216:219], v2, s[52:55], s74 offen offset:2048 nt
L_ff_2h_39:
  buffer_load_dwordx4 v[220:223], v2, s[52:55], s74 offen offset:3072 nt
  s_branch L_kvq_5
L_kvlo_2:
  s_add_u32 s68, s67, 0
  s_sub_u32 s8, s68, 4
  s_cmp_ge_u32 s68, 4
  s_cselect_b32 s68, s8, s68
  s_lshl_b32 s68, s68, 14
  s_add_u32 s70, s66, s68
  s_add_u32 s68, s67, 1
  s_sub_u32 s8, s68, 4
  s_cmp_ge_u32 s68, 4
  s_cselect_b32 s68, s8, s68
  s_lshl_b32 s68, s68, 14
  s_add_u32 s71, s66, s68
  s_add_u32 s68, s67, 2
  s_sub_u32 s8, s68, 4
  s_cmp_ge_u32 s68, 4
  s_cselect_b32 s68, s8, s68
  s_lshl_b32 s68, s68, 14
  s_add_u32 s72, s66, s68
  s_add_u32 s68, s67, 3
  s_sub_u32 s8, s68, 4
  s_cmp_ge_u32 s68, 4
  s_cselect_b32 s68, s8, s68
  s_lshl_b32 s68, s68, 14
  s_add_u32 s73, s66, s68
  s_waitcnt lgkmcnt(0)
  s_barrier
  s_load_dword s6, s[42:43], 0
  s_mov_b32 s44, s42
  s_mov_b32 s45, s43
  s_mov_b32 s46, 0x180000
  s_mov_b32 s47, 0x20000
  s_mov_b32 s48, s18
  s_mov_b32 s49, s19
  s_mov_b32 s50, 0x8000000
  s_mov_b32 s51, 0x20000
  s_mov_b32 s52, s20
  s_mov_b32 s53, s21
  s_mov_b32 s54, 0x8000000
  s_mov_b32 s55, 0x20000
  buffer_load_dwordx4 v[64:67], v1, s[48:51], s70 offen offset:0 nt
  buffer_load_dwordx4 v[68:71], v1, s[48:51], s70 offen offset:64 nt
  buffer_load_dwordx4 v[72:75], v1, s[48:51], s70 offen offset:128 nt
  buffer_load_dwordx4 v[76:79], v1, s[48:51], s70 offen offset:192 nt
  s_waitcnt lgkmcnt(0)
  s_mul_i32 s7, s6, 1664525
  s_add_u32 s7, s7, 1013904223
  s_and_b32 s7, s7, 0xbfffbfff
  s_cmp_lg_u32 s3, 3
  s_cbranch_scc1 L_nxt_18
  s_lshl_b32 s8, s4, 9
  s_lshl_b32 s9, s5, 4
  s_add_u32 s8, s8, s9
  s_add_u32 s8, s8, 0xc1000
  v_mov_b32 v8, s90
  v_mov_b32 v9, 0
  v_mov_b32 v10, 0
  v_mov_b32 v11, s7
  v_mov_b32 v12, 0
  s_mov_b64 exec, 1
  buffer_store_dwordx4 v[8:11], v12, s[44:47], s8 offen sc1
  s_mov_b64 exec, -1
L_nxt_18:
  ds_read_b32 v29, v28
  buffer_load_dwordx4 v[80:83], v1, s[48:51], s71 offen offset:0 nt
  s_waitcnt vmcnt(4) lgkmcnt(0)
  v_cmp_ne_u32 vcc, 0, v29
  s_cbranch_vccnz L_ff_2l_5
  ds_read_b32 v29, v28
  buffer_load_dwordx4 v[84:87], v1, s[48:51], s71 offen offset:64 nt
  s_waitcnt vmcnt(4) lgkmcnt(0)
  v_cmp_ne_u32 vcc, 0, v29
  s_cbranch_vccnz L_ff_2l_6
  ds_read_b32 v29, v28
  buffer_load_dwordx4 v[88:91], v1, s[48:51], s71 offen offset:128 nt
  s_waitcnt vmcnt(4) lgkmcnt(0)
  v_cmp_ne_u32 vcc, 0, v29
  s_cbranch_vccnz L_ff_2l_7
  ds_read_b32 v29, v28
  buffer_load_dwordx4 v[92:95], v1, s[48:51], s71 offen offset:192 nt
  s_waitcnt vmcnt(4) lgkmcnt(0)
  v_cmp_ne_u32 vcc, 0, v29
  s_cbranch_vccnz L_ff_2l_8
  ds_read_b32 v29, v28
  buffer_load_dwordx4 v[96:99], v1, s[48:51], s72 offen offset:0 nt
  s_waitcnt vmcnt(4) lgkmcnt(0)
  v_cmp_ne_u32 vcc, 0, v29
  s_cbranch_vccnz L_ff_2l_9
  ds_read_b32 v29, v28
  buffer_load_dwordx4 v[100:103], v1, s[48:51], s72 offen offset:64 nt
  s_waitcnt vmcnt(4) lgkmcnt(0)
  v_cmp_ne_u32 vcc, 0, v29
  s_cbranch_vccnz L_ff_2l_10
  ds_read_b32 v29, v28
  buffer_load_dwordx4 v[104:107], v1, s[48:51], s72 offen offset:128 nt
  s_waitcnt vmcnt(4) lgkmcnt(0)
  v_cmp_ne_u32 vcc, 0, v29
  s_cbranch_vccnz L_ff_2l_11
  ds_read_b32 v29, v28
  buffer_load_dwordx4 v[108:111], v1, s[48:51], s72 offen offset:192 nt
  s_waitcnt vmcnt(4) lgkmcnt(0)
  v_cmp_ne_u32 vcc, 0, v29
  s_cbranch_vccnz L_ff_2l_12
  ds_read_b32 v29, v28
  buffer_load_dwordx4 v[112:115], v1, s[48:51], s73 offen offset:0 nt
  s_waitcnt vmcnt(4) lgkmcnt(0)
  v_cmp_ne_u32 vcc, 0, v29
  s_cbranch_vccnz L_ff_2l_13
  ds_read_b32 v29, v28
  buffer_load_dwordx4 v[116:119], v1, s[48:51], s73 offen offset:64 nt
  s_waitcnt vmcnt(4) lgkmcnt(0)
  v_cmp_ne_u32 vcc, 0, v29
  s_cbranch_vccnz L_ff_2l_14
  ds_read_b32 v29, v28
  buffer_load_dwordx4 v[120:123], v1, s[48:51], s73 offen offset:128 nt
  s_waitcnt vmcnt(4) lgkmcnt(0)
  v_cmp_ne_u32 vcc, 0, v29
  s_cbranch_vccnz L_ff_2l_15
  ds_read_b32 v29, v28
  buffer_load_dwordx4 v[124:127], v1, s[48:51], s73 offen offset:192 nt
  s_waitcnt vmcnt(4) lgkmcnt(0)
  v_cmp_ne_u32 vcc, 0, v29
  s_cbranch_vccnz L_ff_2l_16
  ds_read_b32 v29, v28
  buffer_load_dwordx4 v[144:147], v2, s[52:55], s70 offen offset:0 nt
  s_waitcnt vmcnt(4) lgkmcnt(0)
  v_cmp_ne_u32 vcc, 0, v29
  s_cbranch_vccnz L_ff_2l_17
  ds_read_b32 v29, v28
  buffer_load_dwordx4 v[148:151], v2, s[52:55], s70 offen offset:1024 nt
  s_waitcnt vmcnt(4) lgkmcnt(0)
  v_cmp_ne_u32 vcc, 0, v29
  s_cbranch_vccnz L_ff_2l_18
  ds_read_b32 v29, v28
  buffer_load_dwordx4 v[152:155], v2, s[52:55], s70 offen offset:2048 nt
  s_waitcnt vmcnt(4) lgkmcnt(0)
  v_cmp_ne_u32 vcc, 0, v29
  s_cbranch_vccnz L_ff_2l_19
  ds_read_b32 v29, v28
  buffer_load_dwordx4 v[156:159], v2, s[52:55], s70 offen offset:3072 nt
  s_waitcnt vmcnt(4) lgkmcnt(0)
  v_cmp_ne_u32 vcc, 0, v29
  s_cbranch_vccnz L_ff_2l_20
  ds_read_b32 v29, v28
  buffer_load_dwordx4 v[160:163], v2, s[52:55], s71 offen offset:0 nt
  s_waitcnt vmcnt(4) lgkmcnt(0)
  v_cmp_ne_u32 vcc, 0, v29
  s_cbranch_vccnz L_ff_2l_21
  ds_read_b32 v29, v28
  buffer_load_dwordx4 v[164:167], v2, s[52:55], s71 offen offset:1024 nt
  s_waitcnt vmcnt(4) lgkmcnt(0)
  v_cmp_ne_u32 vcc, 0, v29
  s_cbranch_vccnz L_ff_2l_22
  ds_read_b32 v29, v28
  buffer_load_dwordx4 v[168:171], v2, s[52:55], s71 offen offset:2048 nt
  s_waitcnt vmcnt(4) lgkmcnt(0)
  v_cmp_ne_u32 vcc, 0, v29
  s_cbranch_vccnz L_ff_2l_23
  ds_read_b32 v29, v28
  buffer_load_dwordx4 v[172:175], v2, s[52:55], s71 offen offset:3072 nt
  s_waitcnt vmcnt(4) lgkmcnt(0)
  v_cmp_ne_u32 vcc, 0, v29
  s_cbranch_vccnz L_ff_2l_24
  ds_read_b32 v29, v28
  buffer_load_dwordx4 v[176:179], v2, s[52:55], s72 offen offset:0 nt
  s_waitcnt vmcnt(4) lgkmcnt(0)
  v_cmp_ne_u32 vcc, 0, v29
  s_cbranch_vccnz L_ff_2l_25
  ds_read_b32 v29, v28
  buffer_load_dwordx4 v[180:183], v2, s[52:55], s72 offen offset:1024 nt
  s_waitcnt vmcnt(4) lgkmcnt(0)
  v_cmp_ne_u32 vcc, 0, v29
  s_cbranch_vccnz L_ff_2l_26
  ds_read_b32 v29, v28
  buffer_load_dwordx4 v[184:187], v2, s[52:55], s72 offen offset:2048 nt
  s_waitcnt vmcnt(4) lgkmcnt(0)
  v_cmp_ne_u32 vcc, 0, v29
  s_cbranch_vccnz L_ff_2l_27
  ds_read_b32 v29, v28
  buffer_load_dwordx4 v[188:191], v2, s[52:55], s72 offen offset:3072 nt
  s_waitcnt vmcnt(4) lgkmcnt(0)
  v_cmp_ne_u32 vcc, 0, v29
  s_cbranch_vccnz L_ff_2l_28
  ds_read_b32 v29, v28
  buffer_load_dwordx4 v[192:195], v2, s[52:55], s73 offen offset:0 nt
  s_waitcnt vmcnt(4) lgkmcnt(0)
  v_cmp_ne_u32 vcc, 0, v29
  s_cbranch_vccnz L_ff_2l_29
  ds_read_b32 v29, v28
  buffer_load_dwordx4 v[196:199], v2, s[52:55], s73 offen offset:1024 nt
  s_waitcnt vmcnt(4) lgkmcnt(0)
  v_cmp_ne_u32 vcc, 0, v29
  s_cbranch_vccnz L_ff_2l_30
  ds_read_b32 v29, v28
  buffer_load_dwordx4 v[200:203], v2, s[52:55], s73 offen offset:2048 nt
  s_waitcnt vmcnt(4) lgkmcnt(0)
  v_cmp_ne_u32 vcc, 0, v29
  s_cbranch_vccnz L_ff_2l_31
  buffer_load_dwordx4 v[204:207], v2, s[52:55], s73 offen offset:3072 nt
  s_branch L_kvj_4
L_ff_2l_5:
  buffer_load_dwordx4 v[84:87], v1, s[48:51], s71 offen offset:64 nt
L_ff_2l_6:
  buffer_load_dwordx4 v[88:91], v1, s[48:51], s71 offen offset:128 nt
L_ff_2l_7:
  buffer_load_dwordx4 v[92:95], v1, s[48:51], s71 offen offset:192 nt
L_ff_2l_8:
  buffer_load_dwordx4 v[96:99], v1, s[48:51], s72 offen offset:0 nt
L_ff_2l_9:
  buffer_load_dwordx4 v[100:103], v1, s[48:51], s72 offen offset:64 nt
L_ff_2l_10:
  buffer_load_dwordx4 v[104:107], v1, s[48:51], s72 offen offset:128 nt
L_ff_2l_11:
  buffer_load_dwordx4 v[108:111], v1, s[48:51], s72 offen offset:192 nt
L_ff_2l_12:
  buffer_load_dwordx4 v[112:115], v1, s[48:51], s73 offen offset:0 nt
L_ff_2l_13:
  buffer_load_dwordx4 v[116:119], v1, s[48:51], s73 offen offset:64 nt
L_ff_2l_14:
  buffer_load_dwordx4 v[120:123], v1, s[48:51], s73 offen offset:128 nt
L_ff_2l_15:
  buffer_load_dwordx4 v[124:127], v1, s[48:51], s73 offen offset:192 nt
L_ff_2l_16:
  buffer_load_dwordx4 v[144:147], v2, s[52:55], s70 offen offset:0 nt
L_ff_2l_17:
  buffer_load_dwordx4 v[148:151], v2, s[52:55], s70 offen offset:1024 nt
L_ff_2l_18:
  buffer_load_dwordx4 v[152:155], v2, s[52:55], s70 offen offset:2048 nt
L_ff_2l_19:
  buffer_load_dwordx4 v[156:159], v2, s[52:55], s70 offen offset:3072 nt
L_ff_2l_20:
  buffer_load_dwordx4 v[160:163], v2, s[52:55], s71 offen offset:0 nt
L_ff_2l_21:
  buffer_load_dwordx4 v[164:167], v2, s[52:55], s71 offen offset:1024 nt
L_ff_2l_22:
  buffer_load_dwordx4 v[168:171], v2, s[52:55], s71 offen offset:2048 nt
L_ff_2l_23:
  buffer_load_dwordx4 v[172:175], v2, s[52:55], s71 offen offset:3072 nt
L_ff_2l_24:
  buffer_load_dwordx4 v[176:179], v2, s[52:55], s72 offen offset:0 nt
L_ff_2l_25:
  buffer_load_dwordx4 v[180:183], v2, s[52:55], s72 offen offset:1024 nt
L_ff_2l_26:
  buffer_load_dwordx4 v[184:187], v2, s[52:55], s72 offen offset:2048 nt
L_ff_2l_27:
  buffer_load_dwordx4 v[188:191], v2, s[52:55], s72 offen offset:3072 nt
L_ff_2l_28:
  buffer_load_dwordx4 v[192:195], v2, s[52:55], s73 offen offset:0 nt
L_ff_2l_29:
  buffer_load_dwordx4 v[196:199], v2, s[52:55], s73 offen offset:1024 nt
L_ff_2l_30:
  buffer_load_dwordx4 v[200:203], v2, s[52:55], s73 offen offset:2048 nt
L_ff_2l_31:
  buffer_load_dwordx4 v[204:207], v2, s[52:55], s73 offen offset:3072 nt
  s_branch L_kvq_4
L_kv_3:
  s_sub_u32 s8, s65, 10
  s_mul_i32 s8, s8, 73728
  s_add_u32 s66, s66, s8
  s_add_u32 s66, s66, 573440
  s_cmp_ge_u32 s3, 2
  s_cbranch_scc1 L_kvlo_3
  s_add_u32 s68, s67, 0
  s_sub_u32 s8, s68, 5
  s_cmp_ge_u32 s68, 5
  s_cselect_b32 s68, s8, s68
  s_lshl_b32 s68, s68, 14
  s_add_u32 s70, s66, s68
  s_add_u32 s68, s67, 1
  s_sub_u32 s8, s68, 5
  s_cmp_ge_u32 s68, 5
  s_cselect_b32 s68, s8, s68
  s_lshl_b32 s68, s68, 14
  s_add_u32 s71, s66, s68
  s_add_u32 s68, s67, 2
  s_sub_u32 s8, s68, 5
  s_cmp_ge_u32 s68, 5
  s_cselect_b32 s68, s8, s68
  s_lshl_b32 s68, s68, 14
  s_add_u32 s72, s66, s68
  s_add_u32 s68, s67, 3
  s_sub_u32 s8, s68, 5
  s_cmp_ge_u32 s68, 5
  s_cselect_b32 s68, s8, s68
  s_lshl_b32 s68, s68, 14
  s_add_u32 s73, s66, s68
  s_add_u32 s68, s67, 4
  s_sub_u32 s8, s68, 5
  s_cmp_ge_u32 s68, 5
  s_cselect_b32 s68, s8, s68
  s_lshl_b32 s68, s68, 14
  s_add_u32 s74, s66, s68
  s_waitcnt lgkmcnt(0)
  s_barrier
  s_load_dword s6, s[42:43], 0
  s_mov_b32 s44, s42
  s_mov_b32 s45, s43
  s_mov_b32 s46, 0x180000
  s_mov_b32 s47, 0x20000
  s_mov_b32 s48, s18
  s_mov_b32 s49, s19
  s_mov_b32 s50, 0x8000000
  s_mov_b32 s51, 0x20000
  s_mov_b32 s52, s20
  s_mov_b32 s53, s21
  s_mov_b32 s54, 0x8000000
  s_mov_b32 s55, 0x20000
  buffer_load_dwordx4 v[64:67], v1, s[48:51], s70 offen offset:0 nt
  buffer_load_dwordx4 v[68:71], v1, s[48:51], s70 offen offset:64 nt
  buffer_load_dwordx4 v[72:75], v1, s[48:51], s70 offen offset:128 nt
  buffer_load_dwordx4 v[76:79], v1, s[48:51], s70 offen offset:192 nt
  s_waitcnt lgkmcnt(0)
  s_mul_i32 s7, s6, 1664525
  s_add_u32 s7, s7, 1013904223
  s_and_b32 s7, s7, 0xbfffbfff
  s_cmp_lg_u32 s3, 3
  s_cbranch_scc1 L_nxt_19
  s_lshl_b32 s8, s4, 9
  s_lshl_b32 s9, s5, 4
  s_add_u32 s8, s8, s9
  s_add_u32 s8, s8, 0xc1000
  v_mov_b32 v8, s90
  v_mov_b32 v9, 0
  v_mov_b32 v10, 0
  v_mov_b32 v11, s7
  v_mov_b32 v12, 0
  s_mov_b64 exec, 1
  buffer_store_dwordx4 v[8:11], v12, s[44:47], s8 offen sc1
  s_mov_b64 exec, -1
L_nxt_19:
  ds_read_b32 v29, v28
  buffer_load_dwordx4 v[80:83], v1, s[48:51], s71 offen offset:0 nt
  s_waitcnt vmcnt(4) lgkmcnt(0)
  v_cmp_ne_u32 vcc, 0, v29
  s_cbranch_vccnz L_ff_3h_5
  ds_read_b32 v29, v28
  buffer_load_dwordx4 v[84:87], v1, s[48:51], s71 offen offset:64 nt
  s_waitcnt vmcnt(4) lgkmcnt(0)
  v_cmp_ne_u32 vcc, 0, v29
  s_cbranch_vccnz L_ff_3h_6
  ds_read_b32 v29, v28
  buffer_load_dwordx4 v[88:91], v1, s[48:51], s71 offen offset:128 nt
  s_waitcnt vmcnt(4) lgkmcnt(0)
  v_cmp_ne_u32 vcc, 0, v29
  s_cbranch_vccnz L_ff_3h_7
  ds_read_b32 v29, v28
  buffer_load_dwordx4 v[92:95], v1, s[48:51], s71 offen offset:192 nt
  s_waitcnt vmcnt(4) lgkmcnt(0)
  v_cmp_ne_u32 vcc, 0, v29
  s_cbranch_vccnz L_ff_3h_8
  ds_read_b32 v29, v28
  buffer_load_dwordx4 v[96:99], v1, s[48:51], s72 offen offset:0 nt
  s_waitcnt vmcnt(4) lgkmcnt(0)
  v_cmp_ne_u32 vcc, 0, v29
  s_cbranch_vccnz L_ff_3h_9
  ds_read_b32 v29, v28
  buffer_load_dwordx4 v[100:103], v1, s[48:51], s72 offen offset:64 nt
  s_waitcnt vmcnt(4) lgkmcnt(0)
  v_cmp_ne_u32 vcc, 0, v29
  s_cbranch_vccnz L_ff_3h_10
  ds_read_b32 v29, v28
  buffer_load_dwordx4 v[104:107], v1, s[48:51], s72 offen offset:128 nt
  s_waitcnt vmcnt(4) lgkmcnt(0)
  v_cmp_ne_u32 vcc, 0, v29
  s_cbranch_vccnz L_ff_3h_11
  ds_read_b32 v29, v28
  buffer_load_dwordx4 v[108:111], v1, s[48:51], s72 offen offset:192 nt
  s_waitcnt vmcnt(4) lgkmcnt(0)
  v_cmp_ne_u32 vcc, 0, v29
  s_cbranch_vccnz L_ff_3h_12
  ds_read_b32 v29, v28
  buffer_load_dwordx4 v[112:115], v1, s[48:51], s73 offen offset:0 nt
  s_waitcnt vmcnt(4) lgkmcnt(0)
  v_cmp_ne_u32 vcc, 0, v29
  s_cbranch_vccnz L_ff_3h_13
  ds_read_b32 v29, v28
  buffer_load_dwordx4 v[116:119], v1, s[48:51], s73 offen offset:64 nt
  s_waitcnt vmcnt(4) lgkmcnt(0)
  v_cmp_ne_u32 vcc, 0, v29
  s_cbranch_vccnz L_ff_3h_14
  ds_read_b32 v29, v28
  buffer_load_dwordx4 v[120:123], v1, s[48:51], s73 offen offset:128 nt
  s_waitcnt vmcnt(4) lgkmcnt(0)
  v_cmp_ne_u32 vcc, 0, v29
  s_cbranch_vccnz L_ff_3h_15
  ds_read_b32 v29, v28
  buffer_load_dwordx4 v[124:127], v1, s[48:51], s73 offen offset:192 nt
  s_waitcnt vmcnt(4) lgkmcnt(0)
  v_cmp_ne_u32 vcc, 0, v29
  s_cbranch_vccnz L_ff_3h_16
  ds_read_b32 v29, v28
  buffer_load_dwordx4 v[128:131], v1, s[48:51], s74 offen offset:0 nt
  s_waitcnt vmcnt(4) lgkmcnt(0)
  v_cmp_ne_u32 vcc, 0, v29
  s_cbranch_vccnz L_ff_3h_17
  ds_read_b32 v29, v28
  buffer_load_dwordx4 v[132:135], v1, s[48:51], s74 offen offset:64 nt
  s_waitcnt vmcnt(4) lgkmcnt(0)
  v_cmp_ne_u32 vcc, 0, v29
  s_cbranch_vccnz L_ff_3h_18
  ds_read_b32 v29, v28
  buffer_load_dwordx4 v[136:139], v1, s[48:51], s74 offen offset:128 nt
  s_waitcnt vmcnt(4) lgkmcnt(0)
  v_cmp_ne_u32 vcc, 0, v29
  s_cbranch_vccnz L_ff_3h_19
  ds_read_b32 v29, v28
  buffer_load_dwordx4 v[140:143], v1, s[48:51], s74 offen offset:192 nt
  s_waitcnt vmcnt(4) lgkmcnt(0)
  v_cmp_ne_u32 vcc, 0, v29
  s_cbranch_vccnz L_ff_3h_20
  ds_read_b32 v29, v28
  buffer_load_dwordx4 v[144:147], v2, s[52:55], s70 offen offset:0 nt
  s_waitcnt vmcnt(4) lgkmcnt(0)
  v_cmp_ne_u32 vcc, 0, v29
  s_cbranch_vccnz L_ff_3h_21
  ds_read_b32 v29, v28
  buffer_load_dwordx4 v[148:151], v2, s[52:55], s70 offen offset:1024 nt
  s_waitcnt vmcnt(4) lgkmcnt(0)
  v_cmp_ne_u32 vcc, 0, v29
  s_cbranch_vccnz L_ff_3h_22
  ds_read_b32 v29, v28
  buffer_load_dwordx4 v[152:155], v2, s[52:55], s70 offen offset:2048 nt
  s_waitcnt vmcnt(4) lgkmcnt(0)
  v_cmp_ne_u32 vcc, 0, v29
  s_cbranch_vccnz L_ff_3h_23
  ds_read_b32 v29, v28
  buffer_load_dwordx4 v[156:159], v2, s[52:55], s70 offen offset:3072 nt
  s_waitcnt vmcnt(4) lgkmcnt(0)
  v_cmp_ne_u32 vcc, 0, v29
  s_cbranch_vccnz L_ff_3h_24
  ds_read_b32 v29, v28
  buffer_load_dwordx4 v[160:163], v2, s[52:55], s71 offen offset:0 nt
  s_waitcnt vmcnt(4) lgkmcnt(0)
  v_cmp_ne_u32 vcc, 0, v29
  s_cbranch_vccnz L_ff_3h_25
  ds_read_b32 v29, v28
  buffer_load_dwordx4 v[164:167], v2, s[52:55], s71 offen offset:1024 nt
  s_waitcnt vmcnt(4) lgkmcnt(0)
  v_cmp_ne_u32 vcc, 0, v29
  s_cbranch_vccnz L_ff_3h_26
  ds_read_b32 v29, v28
  buffer_load_dwordx4 v[168:171], v2, s[52:55], s71 offen offset:2048 nt
  s_waitcnt vmcnt(4) lgkmcnt(0)
  v_cmp_ne_u32 vcc, 0, v29
  s_cbranch_vccnz L_ff_3h_27
  ds_read_b32 v29, v28
  buffer_load_dwordx4 v[172:175], v2, s[52:55], s71 offen offset:3072 nt
  s_waitcnt vmcnt(4) lgkmcnt(0)
  v_cmp_ne_u32 vcc, 0, v29
  s_cbranch_vccnz L_ff_3h_28
  ds_read_b32 v29, v28
  buffer_load_dwordx4 v[176:179], v2, s[52:55], s72 offen offset:0 nt
  s_waitcnt vmcnt(4) lgkmcnt(0)
  v_cmp_ne_u32 vcc, 0, v29
  s_cbranch_vccnz L_ff_3h_29
  ds_read_b32 v29, v28
  buffer_load_dwordx4 v[180:183], v2, s[52:55], s72 offen offset:1024 nt
  s_waitcnt vmcnt(4) lgkmcnt(0)
  v_cmp_ne_u32 vcc, 0, v29
  s_cbranch_vccnz L_ff_3h_30
  ds_read_b32 v29, v28
  buffer_load_dwordx4 v[184:187], v2, s[52:55], s72 offen offset:2048 nt
  s_waitcnt vmcnt(4) lgkmcnt(0)
  v_cmp_ne_u32 vcc, 0, v29
  s_cbranch_vccnz L_ff_3h_31
  ds_read_b32 v29, v28
  buffer_load_dwordx4 v[188:191], v2, s[52:55], s72 offen offset:3072 nt
  s_waitcnt vmcnt(4) lgkmcnt(0)
  v_cmp_ne_u32 vcc, 0, v29
  s_cbranch_vccnz L_ff_3h_32
  ds_read_b32 v29, v28
  buffer_load_dwordx4 v[192:195], v2, s[52:55], s73 offen offset:0 nt
  s_waitcnt vmcnt(4) lgkmcnt(0)
  v_cmp_ne_u32 vcc, 0, v29
  s_cbranch_vccnz L_ff_3h_33
  ds_read_b32 v29, v28
  buffer_load_dwordx4 v[196:199], v2, s[52:55], s73 offen offset:1024 nt
  s_waitcnt vmcnt(4) lgkmcnt(0)
  v_cmp_ne_u32 vcc, 0, v29
  s_cbranch_vccnz L_ff_3h_34
  ds_read_b32 v29, v28
  buffer_load_dwordx4 v[200:203], v2, s[52:55], s73 offen offset:2048 nt
  s_waitcnt vmcnt(4) lgkmcnt(0)
  v_cmp_ne_u32 vcc, 0, v29
  s_cbranch_vccnz L_ff_3h_35
  ds_read_b32 v29, v28
  buffer_load_dwordx4 v[204:207], v2, s[52:55], s73 offen offset:3072 nt
  s_waitcnt vmcnt(4) lgkmcnt(0)
  v_cmp_ne_u32 vcc, 0, v29
  s_cbranch_vccnz L_ff_3h_36
  ds_read_b32 v29, v28
  buffer_load_dwordx4 v[208:211], v2, s[52:55], s74 offen offset:0 nt
  s_waitcnt vmcnt(4) lgkmcnt(0)
  v_cmp_ne_u32 vcc, 0, v29
  s_cbranch_vccnz L_ff_3h_37
  ds_read_b32 v29, v28
  buffer_load_dwordx4 v[212:215], v2, s[52:55], s74 offen offset:1024 nt
  s_waitcnt vmcnt(4) lgkmcnt(0)
  v_cmp_ne_u32 vcc, 0, v29
  s_cbranch_vccnz L_ff_3h_38
  ds_read_b32 v29, v28
  buffer_load_dwordx4 v[216:219], v2, s[52:55], s74 offen offset:2048 nt
  s_waitcnt vmcnt(4) lgkmcnt(0)
  v_cmp_ne_u32 vcc, 0, v29
  s_cbranch_vccnz L_ff_3h_39
  buffer_load_dwordx4 v[220:223], v2, s[52:55], s74 offen offset:3072 nt
  s_branch L_kvj_5
L_ff_3h_5:
  buffer_load_dwordx4 v[84:87], v1, s[48:51], s71 offen offset:64 nt
L_ff_3h_6:
  buffer_load_dwordx4 v[88:91], v1, s[48:51], s71 offen offset:128 nt
L_ff_3h_7:
  buffer_load_dwordx4 v[92:95], v1, s[48:51], s71 offen offset:192 nt
L_ff_3h_8:
  buffer_load_dwordx4 v[96:99], v1, s[48:51], s72 offen offset:0 nt
L_ff_3h_9:
  buffer_load_dwordx4 v[100:103], v1, s[48:51], s72 offen offset:64 nt
L_ff_3h_10:
  buffer_load_dwordx4 v[104:107], v1, s[48:51], s72 offen offset:128 nt
L_ff_3h_11:
  buffer_load_dwordx4 v[108:111], v1, s[48:51], s72 offen offset:192 nt
L_ff_3h_12:
  buffer_load_dwordx4 v[112:115], v1, s[48:51], s73 offen offset:0 nt
L_ff_3h_13:
  buffer_load_dwordx4 v[116:119], v1, s[48:51], s73 offen offset:64 nt
L_ff_3h_14:
  buffer_load_dwordx4 v[120:123], v1, s[48:51], s73 offen offset:128 nt
L_ff_3h_15:
  buffer_load_dwordx4 v[124:127], v1, s[48:51], s73 offen offset:192 nt
L_ff_3h_16:
  buffer_load_dwordx4 v[128:131], v1, s[48:51], s74 offen offset:0 nt
L_ff_3h_17:
  buffer_load_dwordx4 v[132:135], v1, s[48:51], s74 offen offset:64 nt
L_ff_3h_18:
  buffer_load_dwordx4 v[136:139], v1, s[48:51], s74 offen offset:128 nt
L_ff_3h_19:
  buffer_load_dwordx4 v[140:143], v1, s[48:51], s74 offen offset:192 nt
L_ff_3h_20:
  buffer_load_dwordx4 v[144:147], v2, s[52:55], s70 offen offset:0 nt
L_ff_3h_21:
  buffer_load_dwordx4 v[148:151], v2, s[52:55], s70 offen offset:1024 nt
L_ff_3h_22:
  buffer_load_dwordx4 v[152:155], v2, s[52:55], s70 offen offset:2048 nt
L_ff_3h_23:
  buffer_load_dwordx4 v[156:159], v2, s[52:55], s70 offen offset:3072 nt
L_ff_3h_24:
  buffer_load_dwordx4 v[160:163], v2, s[52:55], s71 offen offset:0 nt
L_ff_3h_25:
  buffer_load_dwordx4 v[164:167], v2, s[52:55], s71 offen offset:1024 nt
L_ff_3h_26:
  buffer_load_dwordx4 v[168:171], v2, s[52:55], s71 offen offset:2048 nt
L_ff_3h_27:
  buffer_load_dwordx4 v[172:175], v2, s[52:55], s71 offen offset:3072 nt
L_ff_3h_28:
  buffer_load_dwordx4 v[176:179], v2, s[52:55], s72 offen offset:0 nt
L_ff_3h_29:
  buffer_load_dwordx4 v[180:183], v2, s[52:55], s72 offen offset:1024 nt
L_ff_3h_30:
  buffer_load_dwordx4 v[184:187], v2, s[52:55], s72 offen offset:2048 nt
L_ff_3h_31:
  buffer_load_dwordx4 v[188:191], v2, s[52:55], s72 offen offset:3072 nt
L_ff_3h_32:
  buffer_load_dwordx4 v[192:195], v2, s[52:55], s73 offen offset:0 nt
L_ff_3h_33:
  buffer_load_dwordx4 v[196:199], v2, s[52:55], s73 offen offset:1024 nt
L_ff_3h_34:
  buffer_load_dwordx4 v[200:203], v2, s[52:55], s73 offen offset:2048 nt
L_ff_3h_35:
  buffer_load_dwordx4 v[204:207], v2, s[52:55], s73 offen offset:3072 nt
L_ff_3h_36:
  buffer_load_dwordx4 v[208:211], v2, s[52:55], s74 offen offset:0 nt
L_ff_3h_37:
  buffer_load_dwordx4 v[212:215], v2, s[52:55], s74 offen offset:1024 nt
L_ff_3h_38:
  buffer_load_dwordx4 v[216:219], v2, s[52:55], s74 offen offset:2048 nt
L_ff_3h_39:
  buffer_load_dwordx4 v[220:223], v2, s[52:55], s74 offen offset:3072 nt
  s_branch L_kvq_5
L_kvlo_3:
  s_add_u32 s68, s67, 0
  s_sub_u32 s8, s68, 4
  s_cmp_ge_u32 s68, 4
  s_cselect_b32 s68, s8, s68
  s_lshl_b32 s68, s68, 14
  s_add_u32 s70, s66, s68
  s_add_u32 s68, s67, 1
  s_sub_u32 s8, s68, 4
  s_cmp_ge_u32 s68, 4
  s_cselect_b32 s68, s8, s68
  s_lshl_b32 s68, s68, 14
  s_add_u32 s71, s66, s68
  s_add_u32 s68, s67, 2
  s_sub_u32 s8, s68, 4
  s_cmp_ge_u32 s68, 4
  s_cselect_b32 s68, s8, s68
  s_lshl_b32 s68, s68, 14
  s_add_u32 s72, s66, s68
  s_add_u32 s68, s67, 3
  s_sub_u32 s8, s68, 4
  s_cmp_ge_u32 s68, 4
  s_cselect_b32 s68, s8, s68
  s_lshl_b32 s68, s68, 14
  s_add_u32 s73, s66, s68
  s_waitcnt lgkmcnt(0)
  s_barrier
  s_load_dword s6, s[42:43], 0
  s_mov_b32 s44, s42
  s_mov_b32 s45, s43
  s_mov_b32 s46, 0x180000
  s_mov_b32 s47, 0x20000
  s_mov_b32 s48, s18
  s_mov_b32 s49, s19
  s_mov_b32 s50, 0x8000000
  s_mov_b32 s51, 0x20000
  s_mov_b32 s52, s20
  s_mov_b32 s53, s21
  s_mov_b32 s54, 0x8000000
  s_mov_b32 s55, 0x20000
  buffer_load_dwordx4 v[64:67], v1, s[48:51], s70 offen offset:0 nt
  buffer_load_dwordx4 v[68:71], v1, s[48:51], s70 offen offset:64 nt
  buffer_load_dwordx4 v[72:75], v1, s[48:51], s70 offen offset:128 nt
  buffer_load_dwordx4 v[76:79], v1, s[48:51], s70 offen offset:192 nt
  s_waitcnt lgkmcnt(0)
  s_mul_i32 s7, s6, 1664525
  s_add_u32 s7, s7, 1013904223
  s_and_b32 s7, s7, 0xbfffbfff
  s_cmp_lg_u32 s3, 3
  s_cbranch_scc1 L_nxt_20
  s_lshl_b32 s8, s4, 9
  s_lshl_b32 s9, s5, 4
  s_add_u32 s8, s8, s9
  s_add_u32 s8, s8, 0xc1000
  v_mov_b32 v8, s90
  v_mov_b32 v9, 0
  v_mov_b32 v10, 0
  v_mov_b32 v11, s7
  v_mov_b32 v12, 0
  s_mov_b64 exec, 1
  buffer_store_dwordx4 v[8:11], v12, s[44:47], s8 offen sc1
  s_mov_b64 exec, -1
L_nxt_20:
  ds_read_b32 v29, v28
  buffer_load_dwordx4 v[80:83], v1, s[48:51], s71 offen offset:0 nt
  s_waitcnt vmcnt(4) lgkmcnt(0)
  v_cmp_ne_u32 vcc, 0, v29
  s_cbranch_vccnz L_ff_3l_5
  ds_read_b32 v29, v28
  buffer_load_dwordx4 v[84:87], v1, s[48:51], s71 offen offset:64 nt
  s_waitcnt vmcnt(4) lgkmcnt(0)
  v_cmp_ne_u32 vcc, 0, v29
  s_cbranch_vccnz L_ff_3l_6
  ds_read_b32 v29, v28
  buffer_load_dwordx4 v[88:91], v1, s[48:51], s71 offen offset:128 nt
  s_waitcnt vmcnt(4) lgkmcnt(0)
  v_cmp_ne_u32 vcc, 0, v29
  s_cbranch_vccnz L_ff_3l_7
  ds_read_b32 v29, v28
  buffer_load_dwordx4 v[92:95], v1, s[48:51], s71 offen offset:192 nt
  s_waitcnt vmcnt(4) lgkmcnt(0)
  v_cmp_ne_u32 vcc, 0, v29
  s_cbranch_vccnz L_ff_3l_8
  ds_read_b32 v29, v28
  buffer_load_dwordx4 v[96:99], v1, s[48:51], s72 offen offset:0 nt
  s_waitcnt vmcnt(4) lgkmcnt(0)
  v_cmp_ne_u32 vcc, 0, v29
  s_cbranch_vccnz L_ff_3l_9
  ds_read_b32 v29, v28
  buffer_load_dwordx4 v[100:103], v1, s[48:51], s72 offen offset:64 nt
  s_waitcnt vmcnt(4) lgkmcnt(0)
  v_cmp_ne_u32 vcc, 0, v29
  s_cbranch_vccnz L_ff_3l_10
  ds_read_b32 v29, v28
  buffer_load_dwordx4 v[104:107], v1, s[48:51], s72 offen offset:128 nt
  s_waitcnt vmcnt(4) lgkmcnt(0)
  v_cmp_ne_u32 vcc, 0, v29
  s_cbranch_vccnz L_ff_3l_11
  ds_read_b32 v29, v28
  buffer_load_dwordx4 v[108:111], v1, s[48:51], s72 offen offset:192 nt
  s_waitcnt vmcnt(4) lgkmcnt(0)
  v_cmp_ne_u32 vcc, 0, v29
  s_cbranch_vccnz L_ff_3l_12
  ds_read_b32 v29, v28
  buffer_load_dwordx4 v[112:115], v1, s[48:51], s73 offen offset:0 nt
  s_waitcnt vmcnt(4) lgkmcnt(0)
  v_cmp_ne_u32 vcc, 0, v29
  s_cbranch_vccnz L_ff_3l_13
  ds_read_b32 v29, v28
  buffer_load_dwordx4 v[116:119], v1, s[48:51], s73 offen offset:64 nt
  s_waitcnt vmcnt(4) lgkmcnt(0)
  v_cmp_ne_u32 vcc, 0, v29
  s_cbranch_vccnz L_ff_3l_14
  ds_read_b32 v29, v28
  buffer_load_dwordx4 v[120:123], v1, s[48:51], s73 offen offset:128 nt
  s_waitcnt vmcnt(4) lgkmcnt(0)
  v_cmp_ne_u32 vcc, 0, v29
  s_cbranch_vccnz L_ff_3l_15
  ds_read_b32 v29, v28
  buffer_load_dwordx4 v[124:127], v1, s[48:51], s73 offen offset:192 nt
  s_waitcnt vmcnt(4) lgkmcnt(0)
  v_cmp_ne_u32 vcc, 0, v29
  s_cbranch_vccnz L_ff_3l_16
  ds_read_b32 v29, v28
  buffer_load_dwordx4 v[144:147], v2, s[52:55], s70 offen offset:0 nt
  s_waitcnt vmcnt(4) lgkmcnt(0)
  v_cmp_ne_u32 vcc, 0, v29
  s_cbranch_vccnz L_ff_3l_17
  ds_read_b32 v29, v28
  buffer_load_dwordx4 v[148:151], v2, s[52:55], s70 offen offset:1024 nt
  s_waitcnt vmcnt(4) lgkmcnt(0)
  v_cmp_ne_u32 vcc, 0, v29
  s_cbranch_vccnz L_ff_3l_18
  ds_read_b32 v29, v28
  buffer_load_dwordx4 v[152:155], v2, s[52:55], s70 offen offset:2048 nt
  s_waitcnt vmcnt(4) lgkmcnt(0)
  v_cmp_ne_u32 vcc, 0, v29
  s_cbranch_vccnz L_ff_3l_19
  ds_read_b32 v29, v28
  buffer_load_dwordx4 v[156:159], v2, s[52:55], s70 offen offset:3072 nt
  s_waitcnt vmcnt(4) lgkmcnt(0)
  v_cmp_ne_u32 vcc, 0, v29
  s_cbranch_vccnz L_ff_3l_20
  ds_read_b32 v29, v28
  buffer_load_dwordx4 v[160:163], v2, s[52:55], s71 offen offset:0 nt
  s_waitcnt vmcnt(4) lgkmcnt(0)
  v_cmp_ne_u32 vcc, 0, v29
  s_cbranch_vccnz L_ff_3l_21
  ds_read_b32 v29, v28
  buffer_load_dwordx4 v[164:167], v2, s[52:55], s71 offen offset:1024 nt
  s_waitcnt vmcnt(4) lgkmcnt(0)
  v_cmp_ne_u32 vcc, 0, v29
  s_cbranch_vccnz L_ff_3l_22
  ds_read_b32 v29, v28
  buffer_load_dwordx4 v[168:171], v2, s[52:55], s71 offen offset:2048 nt
  s_waitcnt vmcnt(4) lgkmcnt(0)
  v_cmp_ne_u32 vcc, 0, v29
  s_cbranch_vccnz L_ff_3l_23
  ds_read_b32 v29, v28
  buffer_load_dwordx4 v[172:175], v2, s[52:55], s71 offen offset:3072 nt
  s_waitcnt vmcnt(4) lgkmcnt(0)
  v_cmp_ne_u32 vcc, 0, v29
  s_cbranch_vccnz L_ff_3l_24
  ds_read_b32 v29, v28
  buffer_load_dwordx4 v[176:179], v2, s[52:55], s72 offen offset:0 nt
  s_waitcnt vmcnt(4) lgkmcnt(0)
  v_cmp_ne_u32 vcc, 0, v29
  s_cbranch_vccnz L_ff_3l_25
  ds_read_b32 v29, v28
  buffer_load_dwordx4 v[180:183], v2, s[52:55], s72 offen offset:1024 nt
  s_waitcnt vmcnt(4) lgkmcnt(0)
  v_cmp_ne_u32 vcc, 0, v29
  s_cbranch_vccnz L_ff_3l_26
  ds_read_b32 v29, v28
  buffer_load_dwordx4 v[184:187], v2, s[52:55], s72 offen offset:2048 nt
  s_waitcnt vmcnt(4) lgkmcnt(0)
  v_cmp_ne_u32 vcc, 0, v29
  s_cbranch_vccnz L_ff_3l_27
  ds_read_b32 v29, v28
  buffer_load_dwordx4 v[188:191], v2, s[52:55], s72 offen offset:3072 nt
  s_waitcnt vmcnt(4) lgkmcnt(0)
  v_cmp_ne_u32 vcc, 0, v29
  s_cbranch_vccnz L_ff_3l_28
  ds_read_b32 v29, v28
  buffer_load_dwordx4 v[192:195], v2, s[52:55], s73 offen offset:0 nt
  s_waitcnt vmcnt(4) lgkmcnt(0)
  v_cmp_ne_u32 vcc, 0, v29
  s_cbranch_vccnz L_ff_3l_29
  ds_read_b32 v29, v28
  buffer_load_dwordx4 v[196:199], v2, s[52:55], s73 offen offset:1024 nt
  s_waitcnt vmcnt(4) lgkmcnt(0)
  v_cmp_ne_u32 vcc, 0, v29
  s_cbranch_vccnz L_ff_3l_30
  ds_read_b32 v29, v28
  buffer_load_dwordx4 v[200:203], v2, s[52:55], s73 offen offset:2048 nt
  s_waitcnt vmcnt(4) lgkmcnt(0)
  v_cmp_ne_u32 vcc, 0, v29
  s_cbranch_vccnz L_ff_3l_31
  buffer_load_dwordx4 v[204:207], v2, s[52:55], s73 offen offset:3072 nt
  s_branch L_kvj_4
L_ff_3l_5:
  buffer_load_dwordx4 v[84:87], v1, s[48:51], s71 offen offset:64 nt
L_ff_3l_6:
  buffer_load_dwordx4 v[88:91], v1, s[48:51], s71 offen offset:128 nt
L_ff_3l_7:
  buffer_load_dwordx4 v[92:95], v1, s[48:51], s71 offen offset:192 nt
L_ff_3l_8:
  buffer_load_dwordx4 v[96:99], v1, s[48:51], s72 offen offset:0 nt
L_ff_3l_9:
  buffer_load_dwordx4 v[100:103], v1, s[48:51], s72 offen offset:64 nt
L_ff_3l_10:
  buffer_load_dwordx4 v[104:107], v1, s[48:51], s72 offen offset:128 nt
L_ff_3l_11:
  buffer_load_dwordx4 v[108:111], v1, s[48:51], s72 offen offset:192 nt
L_ff_3l_12:
  buffer_load_dwordx4 v[112:115], v1, s[48:51], s73 offen offset:0 nt
L_ff_3l_13:
  buffer_load_dwordx4 v[116:119], v1, s[48:51], s73 offen offset:64 nt
L_ff_3l_14:
  buffer_load_dwordx4 v[120:123], v1, s[48:51], s73 offen offset:128 nt
L_ff_3l_15:
  buffer_load_dwordx4 v[124:127], v1, s[48:51], s73 offen offset:192 nt
L_ff_3l_16:
  buffer_load_dwordx4 v[144:147], v2, s[52:55], s70 offen offset:0 nt
L_ff_3l_17:
  buffer_load_dwordx4 v[148:151], v2, s[52:55], s70 offen offset:1024 nt
L_ff_3l_18:
  buffer_load_dwordx4 v[152:155], v2, s[52:55], s70 offen offset:2048 nt
L_ff_3l_19:
  buffer_load_dwordx4 v[156:159], v2, s[52:55], s70 offen offset:3072 nt
L_ff_3l_20:
  buffer_load_dwordx4 v[160:163], v2, s[52:55], s71 offen offset:0 nt
L_ff_3l_21:
  buffer_load_dwordx4 v[164:167], v2, s[52:55], s71 offen offset:1024 nt
L_ff_3l_22:
  buffer_load_dwordx4 v[168:171], v2, s[52:55], s71 offen offset:2048 nt
L_ff_3l_23:
  buffer_load_dwordx4 v[172:175], v2, s[52:55], s71 offen offset:3072 nt
L_ff_3l_24:
  buffer_load_dwordx4 v[176:179], v2, s[52:55], s72 offen offset:0 nt
L_ff_3l_25:
  buffer_load_dwordx4 v[180:183], v2, s[52:55], s72 offen offset:1024 nt
L_ff_3l_26:
  buffer_load_dwordx4 v[184:187], v2, s[52:55], s72 offen offset:2048 nt
L_ff_3l_27:
  buffer_load_dwordx4 v[188:191], v2, s[52:55], s72 offen offset:3072 nt
L_ff_3l_28:
  buffer_load_dwordx4 v[192:195], v2, s[52:55], s73 offen offset:0 nt
L_ff_3l_29:
  buffer_load_dwordx4 v[196:199], v2, s[52:55], s73 offen offset:1024 nt
L_ff_3l_30:
  buffer_load_dwordx4 v[200:203], v2, s[52:55], s73 offen offset:2048 nt
L_ff_3l_31:
  buffer_load_dwordx4 v[204:207], v2, s[52:55], s73 offen offset:3072 nt
  s_branch L_kvq_4
L_kvj_2:
  s_mov_b32 s60, s36
  s_mov_b32 s61, s37
  s_mov_b32 s62, 0x300000
  s_mov_b32 s63, 0x20000
  s_lshl_b32 s8, s5, 2
  s_add_u32 s8, s8, s3
  s_mul_i32 s8, s8, 24576
  s_lshl_b32 s9, s4, 2
  s_add_u32 s9, s9, 19
  s_lshl_b32 s9, s9, 7
  s_add_u32 s8, s8, s9
  v_and_b32 v30, 3, v0
  v_mul_u32_u24 v30, 6144, v30
  buffer_load_dword v6, v30, s[60:63], s8 offen
  v_lshrrev_b32 v7, 4, v0
  v_lshlrev_b32 v7, 4, v7
  v_and_b32 v5, 3, v0
  v_lshlrev_b32 v5, 8, v5
  v_add_u32 v3, v5, v7
  v_and_b32 v5, 15, v0
  v_mul_u32_u24 v5, 576, v5
  s_mul_i32 s8, s3, 2304
  s_add_u32 s8, s8, 1536
  v_add3_u32 v4, v5, v7, s8
  v_and_b32 v14, 3, v0
  v_lshlrev_b32 v14, 4, v14
  s_lshl_b32 s8, s3, 2
  v_add_u32 v15, s8, v14
  s_mov_b32 s10, 0xf000f0
  s_mov_b32 s11, 0xf000f0
  s_mov_b32 s12, 0xf000f00
  s_mov_b32 s13, 0xf000f00
  s_mov_b32 s14, 0xf000f000
  s_mov_b32 s15, 0xf000f000
  s_lshl_b32 s8, s4, 2
  s_add_u32 s8, s8, s3
  s_lshl_b32 s8, s8, 1
  s_add_u32 s8, s8, s64
  s_lshl_b32 s8, s8, 4
  s_add_u32 s8, s8, s65
  s_mul_i32 s76, s8, 576
  s_add_u32 s76, s76, 0x10000
  ds_read_b32 v29, v28
  s_waitcnt lgkmcnt(0)
  v_cmp_ne_u32 vcc, 0, v29
  s_mov_b32 s77, 0
  s_cbranch_vccnz L_kvq2_2
  s_waitcnt vmcnt(7)
  v_perm_b32 v224, v148, v144, s80
  v_perm_b32 v228, v148, v144, s81
  v_perm_b32 v232, v149, v145, s80
  v_perm_b32 v236, v149, v145, s81
  v_perm_b32 v240, v150, v146, s80
  v_perm_b32 v244, v150, v146, s81
  v_perm_b32 v248, v151, v147, s80
  v_perm_b32 v252, v151, v147, s81
  s_waitcnt vmcnt(5)
  v_perm_b32 v225, v156, v152, s80
  v_perm_b32 v229, v156, v152, s81
  v_perm_b32 v233, v157, v153, s80
  v_perm_b32 v237, v157, v153, s81
  v_perm_b32 v241, v158, v154, s80
  v_perm_b32 v245, v158, v154, s81
  v_perm_b32 v249, v159, v155, s80
  v_perm_b32 v253, v159, v155, s81
  s_waitcnt vmcnt(3)
  v_perm_b32 v226, v164, v160, s80
  v_perm_b32 v230, v164, v160, s81
  v_perm_b32 v234, v165, v161, s80
  v_perm_b32 v238, v165, v161, s81
  v_perm_b32 v242, v166, v162, s80
  v_perm_b32 v246, v166, v162, s81
  v_perm_b32 v250, v167, v163, s80
  v_perm_b32 v254, v167, v163, s81
  s_waitcnt vmcnt(1)
  v_perm_b32 v227, v172, v168, s80
  v_perm_b32 v231, v172, v168, s81
  v_perm_b32 v235, v173, v169, s80
  v_perm_b32 v239, v173, v169, s81
  v_perm_b32 v243, v174, v170, s80
  v_perm_b32 v247, v174, v170, s81
  v_perm_b32 v251, v175, v171, s80
  v_perm_b32 v255, v175, v171, s81
  s_mov_b32 s77, 1
  v_mov_b32 v9, 1024
L_lw_21:
  ds_read_b32 v8, v9
  s_waitcnt lgkmcnt(0)
  v_cmp_ne_u32 vcc, 0, v8
  s_cbranch_vccnz L_lwd_22
  s_sub_u32 s84, s84, 1
  s_cbranch_scc0 L_lw_21
  s_mov_b32 s84, 0
L_lwd_22:
  s_branch L_kvq2_2
L_kvq_2:
  s_mov_b32 s60, s36
  s_mov_b32 s61, s37
  s_mov_b32 s62, 0x300000
  s_mov_b32 s63, 0x20000
  s_lshl_b32 s8, s5, 2
  s_add_u32 s8, s8, s3
  s_mul_i32 s8, s8, 24576
  s_lshl_b32 s9, s4, 2
  s_add_u32 s9, s9, 19
  s_lshl_b32 s9, s9, 7
  s_add_u32 s8, s8, s9
  v_and_b32 v30, 3, v0
  v_mul_u32_u24 v30, 6144, v30
  buffer_load_dword v6, v30, s[60:63], s8 offen
  v_lshrrev_b32 v7, 4, v0
  v_lshlrev_b32 v7, 4, v7
  v_and_b32 v5, 3, v0
  v_lshlrev_b32 v5, 8, v5
  v_add_u32 v3, v5, v7
  v_and_b32 v5, 15, v0
  v_mul_u32_u24 v5, 576, v5
  s_mul_i32 s8, s3, 2304
  s_add_u32 s8, s8, 1536
  v_add3_u32 v4, v5, v7, s8
  v_and_b32 v14, 3, v0
  v_lshlrev_b32 v14, 4, v14
  s_lshl_b32 s8, s3, 2
  v_add_u32 v15, s8, v14
  s_mov_b32 s10, 0xf000f0
  s_mov_b32 s11, 0xf000f0
  s_mov_b32 s12, 0xf000f00
  s_mov_b32 s13, 0xf000f00
  s_mov_b32 s14, 0xf000f000
  s_mov_b32 s15, 0xf000f000
  s_lshl_b32 s8, s4, 2
  s_add_u32 s8, s8, s3
  s_lshl_b32 s8, s8, 1
  s_add_u32 s8, s8, s64
  s_lshl_b32 s8, s8, 4
  s_add_u32 s8, s8, s65
  s_mul_i32 s76, s8, 576
  s_add_u32 s76, s76, 0x10000
  s_mov_b32 s77, 0
L_kvq2_2:
  ds_read_b32 v8, v28
  ds_read_b128 v[32:35], v3 offset:0
  ds_read_b128 v[36:39], v3 offset:64
  ds_read_b128 v[40:43], v3 offset:128
  ds_read_b128 v[44:47], v3 offset:192
  s_waitcnt lgkmcnt(4)
  v_readfirstlane_b32 s83, v8
  s_lshr_b32 s83, s83, 1
  s_waitcnt vmcnt(9)
  s_waitcnt lgkmcnt(3)
  v_mfma_f32_16x16x32_bf16 v[48:51], v[64:67], v[32:35], 0
  v_mfma_f32_16x16x32_bf16 v[52:55], v[80:83], v[32:35], 0
  s_waitcnt lgkmcnt(2)
  v_mfma_f32_16x16x32_bf16 v[48:51], v[68:71], v[36:39], v[48:51]
  v_mfma_f32_16x16x32_bf16 v[52:55], v[84:87], v[36:39], v[52:55]
  s_waitcnt lgkmcnt(1)
  v_mfma_f32_16x16x32_bf16 v[48:51], v[72:75], v[40:43], v[48:51]
  v_mfma_f32_16x16x32_bf16 v[52:55], v[88:91], v[40:43], v[52:55]
  s_waitcnt lgkmcnt(0)
  v_mfma_f32_16x16x32_bf16 v[48:51], v[76:79], v[44:47], v[48:51]
  v_mfma_f32_16x16x32_bf16 v[52:55], v[92:95], v[44:47], v[52:55]
  s_nop 7
  v_cndmask_b32 v8, v48, v52, s[10:11]
  v_cndmask_b32 v9, v49, v53, s[10:11]
  v_cndmask_b32 v10, v50, v54, s[10:11]
  v_cndmask_b32 v11, v51, v55, s[10:11]
  v_mov_b32 v12, 0xff800000
  v_cndmask_b32 v8, v8, v12, s[12:13]
  v_cndmask_b32 v9, v9, v12, s[12:13]
  v_cndmask_b32 v10, v10, v12, s[12:13]
  v_cndmask_b32 v11, v11, v12, s[12:13]
  v_cndmask_b32 v8, v8, v12, s[14:15]
  v_cndmask_b32 v9, v9, v12, s[14:15]
  v_cndmask_b32 v10, v10, v12, s[14:15]
  v_cndmask_b32 v11, v11, v12, s[14:15]
  v_cvt_pk_bf16_f32 v12, v8, v9
  v_cvt_pk_bf16_f32 v13, v10, v11
  v_lshlrev_b32 v8, 16, v12
  v_and_b32 v9, s82, v12
  v_lshlrev_b32 v10, 16, v13
  v_and_b32 v11, s82, v13
  s_mov_b32 s8, 0x3db504f3
  v_mul_f32 v8, s8, v8
  v_mul_f32 v9, s8, v9
  v_mul_f32 v10, s8, v10
  v_mul_f32 v11, s8, v11
  v_cvt_pk_bf16_f32 v12, v8, v9
  v_cvt_pk_bf16_f32 v13, v10, v11
  v_lshlrev_b32 v8, 16, v12
  v_and_b32 v9, s82, v12
  v_lshlrev_b32 v10, 16, v13
  v_and_b32 v11, s82, v13
  v_max3_f32 v12, v8, v9, v10
  v_max_f32 v12, v12, v11
  s_nop 1
  v_max_f32_dpp v12, v12, v12 row_ror:4 row_mask:0xf bank_mask:0xf
  s_nop 1
  v_max_f32_dpp v12, v12, v12 row_ror:8 row_mask:0xf bank_mask:0xf
  v_mov_b32 v13, v12
  s_nop 1
  v_permlane16_swap_b32 v12, v13
  v_max_f32 v12, v12, v13
  v_mov_b32 v13, v12
  s_nop 1
  v_permlane32_swap_b32 v12, v13
  v_max_f32 v12, v12, v13
  s_mov_b64 exec, 0xf
  ds_write_b32 v15, v12 offset:1280
  s_mov_b64 exec, -1
  s_lshl_b32 s8, s3, 2
  s_add_u32 s8, s8, 1040
  v_mov_b32 v16, s8
  v_mov_b32 v17, 1
  s_mov_b64 s[10:11], exec
  s_mov_b64 exec, 1
  ds_write_b32 v16, v17
  s_mov_b64 exec, s[10:11]
  v_mov_b32 v52, 1040
L_lw_23:
  ds_read_b128 v[48:51], v52
  ds_read_b128 v[56:59], v14 offset:1280
  s_waitcnt lgkmcnt(0)
  v_min3_u32 v48, v48, v49, v50
  v_min_u32 v48, v48, v51
  v_cmp_ne_u32 vcc, 0, v48
  s_cbranch_vccnz L_lwd_24
  s_sub_u32 s84, s84, 1
  s_cbranch_scc0 L_lw_23
  s_mov_b32 s84, 0
L_lwd_24:
  v_max3_f32 v12, v56, v57, v58
  v_max_f32 v12, v12, v59
  v_sub_f32 v8, v8, v12
  v_sub_f32 v9, v9, v12
  v_sub_f32 v10, v10, v12
  v_sub_f32 v11, v11, v12
  v_mul_f32 v8, s85, v8
  v_mul_f32 v9, s85, v9
  v_mul_f32 v10, s85, v10
  v_mul_f32 v11, s85, v11
  v_exp_f32 v8, v8
  v_exp_f32 v9, v9
  v_exp_f32 v10, v10
  v_exp_f32 v11, v11
  v_cvt_pk_bf16_f32 v16, v8, v9
  v_cvt_pk_bf16_f32 v17, v10, v11
  v_add_f32 v13, v8, v9
  v_add_f32 v30, v10, v11
  v_add_f32 v13, v13, v30
  v_mov_b32_dpp v18, v16 row_shl:4 row_mask:0xf bank_mask:0xf bound_ctrl:0
  v_mov_b32_dpp v19, v17 row_shl:4 row_mask:0xf bank_mask:0xf bound_ctrl:0
  s_cmp_eq_u32 s77, 1
  s_cbranch_scc1 L_kvpv_2
  v_add_f32_dpp v13, v13, v13 row_ror:4 row_mask:0xf bank_mask:0xf
  s_nop 1
  v_add_f32_dpp v13, v13, v13 row_ror:8 row_mask:0xf bank_mask:0xf
  v_mov_b32 v30, v13
  s_nop 1
  v_permlane16_swap_b32 v13, v30
  v_add_f32 v13, v13, v30
  v_mov_b32 v30, v13
  s_nop 1
  v_permlane32_swap_b32 v13, v30
  v_add_f32 v13, v13, v30
  s_mov_b64 exec, 0xf
  ds_write_b32 v15, v13 offset:1344
  s_mov_b64 exec, -1
  s_waitcnt vmcnt(7)
  v_perm_b32 v224, v148, v144, s80
  v_perm_b32 v228, v148, v144, s81
  v_perm_b32 v232, v149, v145, s80
  v_perm_b32 v236, v149, v145, s81
  v_perm_b32 v240, v150, v146, s80
  v_perm_b32 v244, v150, v146, s81
  v_perm_b32 v248, v151, v147, s80
  v_perm_b32 v252, v151, v147, s81
  s_waitcnt vmcnt(5)
  v_perm_b32 v225, v156, v152, s80
  v_perm_b32 v229, v156, v152, s81
  v_perm_b32 v233, v157, v153, s80
  v_perm_b32 v237, v157, v153, s81
  v_perm_b32 v241, v158, v154, s80
  v_perm_b32 v245, v158, v154, s81
  v_perm_b32 v249, v159, v155, s80
  v_perm_b32 v253, v159, v155, s81
  s_waitcnt vmcnt(3)
  v_perm_b32 v226, v164, v160, s80
  v_perm_b32 v230, v164, v160, s81
  v_perm_b32 v234, v165, v161, s80
  v_perm_b32 v238, v165, v161, s81
  v_perm_b32 v242, v166, v162, s80
  v_perm_b32 v246, v166, v162, s81
  v_perm_b32 v250, v167, v163, s80
  v_perm_b32 v254, v167, v163, s81
  s_waitcnt vmcnt(1)
  v_perm_b32 v227, v172, v168, s80
  v_perm_b32 v231, v172, v168, s81
  v_perm_b32 v235, v173, v169, s80
  v_perm_b32 v239, v173, v169, s81
  v_perm_b32 v243, v174, v170, s80
  v_perm_b32 v247, v174, v170, s81
  v_perm_b32 v251, v175, v171, s80
  v_perm_b32 v255, v175, v171, s81
  v_mfma_f32_16x16x32_bf16 v[64:67], v[224:227], v[16:19], 0
  v_mfma_f32_16x16x32_bf16 v[68:71], v[228:231], v[16:19], 0
  v_mfma_f32_16x16x32_bf16 v[72:75], v[232:235], v[16:19], 0
  v_mfma_f32_16x16x32_bf16 v[76:79], v[236:239], v[16:19], 0
  v_mfma_f32_16x16x32_bf16 v[80:83], v[240:243], v[16:19], 0
  v_mfma_f32_16x16x32_bf16 v[84:87], v[244:247], v[16:19], 0
  v_mfma_f32_16x16x32_bf16 v[88:91], v[248:251], v[16:19], 0
  v_mfma_f32_16x16x32_bf16 v[92:95], v[252:255], v[16:19], 0
  s_branch L_kvf
L_kvpv_2:
  v_mfma_f32_16x16x32_bf16 v[64:67], v[224:227], v[16:19], 0
  v_mfma_f32_16x16x32_bf16 v[68:71], v[228:231], v[16:19], 0
  v_mfma_f32_16x16x32_bf16 v[72:75], v[232:235], v[16:19], 0
  v_mfma_f32_16x16x32_bf16 v[76:79], v[236:239], v[16:19], 0
  v_mfma_f32_16x16x32_bf16 v[80:83], v[240:243], v[16:19], 0
  v_mfma_f32_16x16x32_bf16 v[84:87], v[244:247], v[16:19], 0
  v_mfma_f32_16x16x32_bf16 v[88:91], v[248:251], v[16:19], 0
  v_mfma_f32_16x16x32_bf16 v[92:95], v[252:255], v[16:19], 0
  v_add_f32_dpp v13, v13, v13 row_ror:4 row_mask:0xf bank_mask:0xf
  s_nop 1
  v_add_f32_dpp v13, v13, v13 row_ror:8 row_mask:0xf bank_mask:0xf
  v_mov_b32 v30, v13
  s_nop 1
  v_permlane16_swap_b32 v13, v30
  v_add_f32 v13, v13, v30
  v_mov_b32 v30, v13
  s_nop 1
  v_permlane32_swap_b32 v13, v30
  v_add_f32 v13, v13, v30
  s_mov_b64 exec, 0xf
  ds_write_b32 v15, v13 offset:1344
  s_mov_b64 exec, -1
  s_branch L_kvf
L_kvj_3:
  s_mov_b32 s60, s36
  s_mov_b32 s61, s37
  s_mov_b32 s62, 0x300000
  s_mov_b32 s63, 0x20000
  s_lshl_b32 s8, s5, 2
  s_add_u32 s8, s8, s3
  s_mul_i32 s8, s8, 24576
  s_lshl_b32 s9, s4, 2
  s_add_u32 s9, s9, 19
  s_lshl_b32 s9, s9, 7
  s_add_u32 s8, s8, s9
  v_and_b32 v30, 3, v0
  v_mul_u32_u24 v30, 6144, v30
  buffer_load_dword v6, v30, s[60:63], s8 offen
  v_lshrrev_b32 v7, 4, v0
  v_lshlrev_b32 v7, 4, v7
  v_and_b32 v5, 3, v0
  v_lshlrev_b32 v5, 8, v5
  v_add_u32 v3, v5, v7
  v_and_b32 v5, 15, v0
  v_mul_u32_u24 v5, 576, v5
  s_mul_i32 s8, s3, 2304
  s_add_u32 s8, s8, 1536
  v_add3_u32 v4, v5, v7, s8
  v_and_b32 v14, 3, v0
  v_lshlrev_b32 v14, 4, v14
  s_lshl_b32 s8, s3, 2
  v_add_u32 v15, s8, v14
  s_mov_b32 s10, 0xf000f0
  s_mov_b32 s11, 0xf000f0
  s_mov_b32 s12, 0xf000f00
  s_mov_b32 s13, 0xf000f00
  s_mov_b32 s14, 0xf000f000
  s_mov_b32 s15, 0xf000f000
  s_lshl_b32 s8, s4, 2
  s_add_u32 s8, s8, s3
  s_lshl_b32 s8, s8, 1
  s_add_u32 s8, s8, s64
  s_lshl_b32 s8, s8, 4
  s_add_u32 s8, s8, s65
  s_mul_i32 s76, s8, 576
  s_add_u32 s76, s76, 0x10000
  ds_read_b32 v29, v28
  s_waitcnt lgkmcnt(0)
  v_cmp_ne_u32 vcc, 0, v29
  s_mov_b32 s77, 0
  s_cbranch_vccnz L_kvq2_3
  s_waitcnt vmcnt(11)
  v_perm_b32 v224, v148, v144, s80
  v_perm_b32 v228, v148, v144, s81
  v_perm_b32 v232, v149, v145, s80
  v_perm_b32 v236, v149, v145, s81
  v_perm_b32 v240, v150, v146, s80
  v_perm_b32 v244, v150, v146, s81
  v_perm_b32 v248, v151, v147, s80
  v_perm_b32 v252, v151, v147, s81
  s_waitcnt vmcnt(9)
  v_perm_b32 v225, v156, v152, s80
  v_perm_b32 v229, v156, v152, s81
  v_perm_b32 v233, v157, v153, s80
  v_perm_b32 v237, v157, v153, s81
  v_perm_b32 v241, v158, v154, s80
  v_perm_b32 v245, v158, v154, s81
  v_perm_b32 v249, v159, v155, s80
  v_perm_b32 v253, v159, v155, s81
  s_waitcnt vmcnt(7)
  v_perm_b32 v226, v164, v160, s80
  v_perm_b32 v230, v164, v160, s81
  v_perm_b32 v234, v165, v161, s80
  v_perm_b32 v238, v165, v161, s81
  v_perm_b32 v242, v166, v162, s80
  v_perm_b32 v246, v166, v162, s81
  v_perm_b32 v250, v167, v163, s80
  v_perm_b32 v254, v167, v163, s81
  s_waitcnt vmcnt(5)
  v_perm_b32 v227, v172, v168, s80
  v_perm_b32 v231, v172, v168, s81
  v_perm_b32 v235, v173, v169, s80
  v_perm_b32 v239, v173, v169, s81
  v_perm_b32 v243, v174, v170, s80
  v_perm_b32 v247, v174, v170, s81
  v_perm_b32 v251, v175, v171, s80
  v_perm_b32 v255, v175, v171, s81
  s_waitcnt vmcnt(3)
  v_perm_b32 v144, v180, v176, s80
  v_perm_b32 v146, v180, v176, s81
  v_perm_b32 v148, v181, v177, s80
  v_perm_b32 v150, v181, v177, s81
  v_perm_b32 v152, v182, v178, s80
  v_perm_b32 v154, v182, v178, s81
  v_perm_b32 v156, v183, v179, s80
  v_perm_b32 v158, v183, v179, s81
  s_waitcnt vmcnt(1)
  v_perm_b32 v145, v188, v184, s80
  v_perm_b32 v147, v188, v184, s81
  v_perm_b32 v149, v189, v185, s80
  v_perm_b32 v151, v189, v185, s81
  v_perm_b32 v153, v190, v186, s80
  v_perm_b32 v155, v190, v186, s81
  v_perm_b32 v157, v191, v187, s80
  v_perm_b32 v159, v191, v187, s81
  s_mov_b32 s77, 1
  v_mov_b32 v9, 1024
L_lw_25:
  ds_read_b32 v8, v9
  s_waitcnt lgkmcnt(0)
  v_cmp_ne_u32 vcc, 0, v8
  s_cbranch_vccnz L_lwd_26
  s_sub_u32 s84, s84, 1
  s_cbranch_scc0 L_lw_25
  s_mov_b32 s84, 0
L_lwd_26:
  s_branch L_kvq2_3
L_kvq_3:
  s_mov_b32 s60, s36
  s_mov_b32 s61, s37
  s_mov_b32 s62, 0x300000
  s_mov_b32 s63, 0x20000
  s_lshl_b32 s8, s5, 2
  s_add_u32 s8, s8, s3
  s_mul_i32 s8, s8, 24576
  s_lshl_b32 s9, s4, 2
  s_add_u32 s9, s9, 19
  s_lshl_b32 s9, s9, 7
  s_add_u32 s8, s8, s9
  v_and_b32 v30, 3, v0
  v_mul_u32_u24 v30, 6144, v30
  buffer_load_dword v6, v30, s[60:63], s8 offen
  v_lshrrev_b32 v7, 4, v0
  v_lshlrev_b32 v7, 4, v7
  v_and_b32 v5, 3, v0
  v_lshlrev_b32 v5, 8, v5
  v_add_u32 v3, v5, v7
  v_and_b32 v5, 15, v0
  v_mul_u32_u24 v5, 576, v5
  s_mul_i32 s8, s3, 2304
  s_add_u32 s8, s8, 1536
  v_add3_u32 v4, v5, v7, s8
  v_and_b32 v14, 3, v0
  v_lshlrev_b32 v14, 4, v14
  s_lshl_b32 s8, s3, 2
  v_add_u32 v15, s8, v14
  s_mov_b32 s10, 0xf000f0
  s_mov_b32 s11, 0xf000f0
  s_mov_b32 s12, 0xf000f00
  s_mov_b32 s13, 0xf000f00
  s_mov_b32 s14, 0xf000f000
  s_mov_b32 s15, 0xf000f000
  s_lshl_b32 s8, s4, 2
  s_add_u32 s8, s8, s3
  s_lshl_b32 s8, s8, 1
  s_add_u32 s8, s8, s64
  s_lshl_b32 s8, s8, 4
  s_add_u32 s8, s8, s65
  s_mul_i32 s76, s8, 576
  s_add_u32 s76, s76, 0x10000
  s_mov_b32 s77, 0
L_kvq2_3:
  ds_read_b32 v8, v28
  ds_read_b128 v[32:35], v3 offset:0
  ds_read_b128 v[36:39], v3 offset:64
  ds_read_b128 v[40:43], v3 offset:128
  ds_read_b128 v[44:47], v3 offset:192
  s_waitcnt lgkmcnt(4)
  v_readfirstlane_b32 s83, v8
  s_lshr_b32 s83, s83, 1
  s_waitcnt vmcnt(13)
  s_waitcnt lgkmcnt(3)
  v_mfma_f32_16x16x32_bf16 v[48:51], v[64:67], v[32:35], 0
  v_mfma_f32_16x16x32_bf16 v[52:55], v[80:83], v[32:35], 0
  v_mfma_f32_16x16x32_bf16 v[56:59], v[96:99], v[32:35], 0
  s_waitcnt lgkmcnt(2)
  v_mfma_f32_16x16x32_bf16 v[48:51], v[68:71], v[36:39], v[48:51]
  v_mfma_f32_16x16x32_bf16 v[52:55], v[84:87], v[36:39], v[52:55]
  v_mfma_f32_16x16x32_bf16 v[56:59], v[100:103], v[36:39], v[56:59]
  s_waitcnt lgkmcnt(1)
  v_mfma_f32_16x16x32_bf16 v[48:51], v[72:75], v[40:43], v[48:51]
  v_mfma_f32_16x16x32_bf16 v[52:55], v[88:91], v[40:43], v[52:55]
  v_mfma_f32_16x16x32_bf16 v[56:59], v[104:107], v[40:43], v[56:59]
  s_waitcnt lgkmcnt(0)
  v_mfma_f32_16x16x32_bf16 v[48:51], v[76:79], v[44:47], v[48:51]
  v_mfma_f32_16x16x32_bf16 v[52:55], v[92:95], v[44:47], v[52:55]
  v_mfma_f32_16x16x32_bf16 v[56:59], v[108:111], v[44:47], v[56:59]
  s_nop 6
  v_cndmask_b32 v8, v48, v52, s[10:11]
  v_cndmask_b32 v9, v49, v53, s[10:11]
  v_cndmask_b32 v10, v50, v54, s[10:11]
  v_cndmask_b32 v11, v51, v55, s[10:11]
  v_cndmask_b32 v8, v8, v56, s[12:13]
  v_cndmask_b32 v9, v9, v57, s[12:13]
  v_cndmask_b32 v10, v10, v58, s[12:13]
  v_cndmask_b32 v11, v11, v59, s[12:13]
  v_mov_b32 v12, 0xff800000
  v_cndmask_b32 v8, v8, v12, s[14:15]
  v_cndmask_b32 v9, v9, v12, s[14:15]
  v_cndmask_b32 v10, v10, v12, s[14:15]
  v_cndmask_b32 v11, v11, v12, s[14:15]
  v_cvt_pk_bf16_f32 v12, v8, v9
  v_cvt_pk_bf16_f32 v13, v10, v11
  v_lshlrev_b32 v8, 16, v12
  v_and_b32 v9, s82, v12
  v_lshlrev_b32 v10, 16, v13
  v_and_b32 v11, s82, v13
  s_mov_b32 s8, 0x3db504f3
  v_mul_f32 v8, s8, v8
  v_mul_f32 v9, s8, v9
  v_mul_f32 v10, s8, v10
  v_mul_f32 v11, s8, v11
  v_cvt_pk_bf16_f32 v12, v8, v9
  v_cvt_pk_bf16_f32 v13, v10, v11
  v_lshlrev_b32 v8, 16, v12
  v_and_b32 v9, s82, v12
  v_lshlrev_b32 v10, 16, v13
  v_and_b32 v11, s82, v13
  v_max3_f32 v12, v8, v9, v10
  v_max_f32 v12, v12, v11
  s_nop 1
  v_max_f32_dpp v12, v12, v12 row_ror:4 row_mask:0xf bank_mask:0xf
  s_nop 1
  v_max_f32_dpp v12, v12, v12 row_ror:8 row_mask:0xf bank_mask:0xf
  v_mov_b32 v13, v12
  s_nop 1
  v_permlane16_swap_b32 v12, v13
  v_max_f32 v12, v12, v13
  v_mov_b32 v13, v12
  s_nop 1
  v_permlane32_swap_b32 v12, v13
  v_max_f32 v12, v12, v13
  s_mov_b64 exec, 0xf
  ds_write_b32 v15, v12 offset:1280
  s_mov_b64 exec, -1
  s_lshl_b32 s8, s3, 2
  s_add_u32 s8, s8, 1040
  v_mov_b32 v16, s8
  v_mov_b32 v17, 1
  s_mov_b64 s[10:11], exec
  s_mov_b64 exec, 1
  ds_write_b32 v16, v17
  s_mov_b64 exec, s[10:11]
  v_mov_b32 v52, 1040
L_lw_27:
  ds_read_b128 v[48:51], v52
  ds_read_b128 v[56:59], v14 offset:1280
  s_waitcnt lgkmcnt(0)
  v_min3_u32 v48, v48, v49, v50
  v_min_u32 v48, v48, v51
  v_cmp_ne_u32 vcc, 0, v48
  s_cbranch_vccnz L_lwd_28
  s_sub_u32 s84, s84, 1
  s_cbranch_scc0 L_lw_27
  s_mov_b32 s84, 0
L_lwd_28:
  v_max3_f32 v12, v56, v57, v58
  v_max_f32 v12, v12, v59
  v_sub_f32 v8, v8, v12
  v_sub_f32 v9, v9, v12
  v_sub_f32 v10, v10, v12
  v_sub_f32 v11, v11, v12
  v_mul_f32 v8, s85, v8
  v_mul_f32 v9, s85, v9
  v_mul_f32 v10, s85, v10
  v_mul_f32 v11, s85, v11
  v_exp_f32 v8, v8
  v_exp_f32 v9, v9
  v_exp_f32 v10, v10
  v_exp_f32 v11, v11
  v_cvt_pk_bf16_f32 v16, v8, v9
  v_cvt_pk_bf16_f32 v17, v10, v11
  v_add_f32 v13, v8, v9
  v_add_f32 v30, v10, v11
  v_add_f32 v13, v13, v30
  v_mov_b32_dpp v18, v16 row_shl:4 row_mask:0xf bank_mask:0xf bound_ctrl:0
  v_mov_b32_dpp v19, v17 row_shl:4 row_mask:0xf bank_mask:0xf bound_ctrl:0
  v_mov_b32_dpp v20, v16 row_shl:8 row_mask:0xf bank_mask:0xf bound_ctrl:0
  v_mov_b32_dpp v21, v17 row_shl:8 row_mask:0xf bank_mask:0xf bound_ctrl:0
  s_cmp_eq_u32 s77, 1
  s_cbranch_scc1 L_kvpv_3
  v_add_f32_dpp v13, v13, v13 row_ror:4 row_mask:0xf bank_mask:0xf
  s_nop 1
  v_add_f32_dpp v13, v13, v13 row_ror:8 row_mask:0xf bank_mask:0xf
  v_mov_b32 v30, v13
  s_nop 1
  v_permlane16_swap_b32 v13, v30
  v_add_f32 v13, v13, v30
  v_mov_b32 v30, v13
  s_nop 1
  v_permlane32_swap_b32 v13, v30
  v_add_f32 v13, v13, v30
  s_mov_b64 exec, 0xf
  ds_write_b32 v15, v13 offset:1344
  s_mov_b64 exec, -1
  s_waitcnt vmcnt(11)
  v_perm_b32 v224, v148, v144, s80
  v_perm_b32 v228, v148, v144, s81
  v_perm_b32 v232, v149, v145, s80
  v_perm_b32 v236, v149, v145, s81
  v_perm_b32 v240, v150, v146, s80
  v_perm_b32 v244, v150, v146, s81
  v_perm_b32 v248, v151, v147, s80
  v_perm_b32 v252, v151, v147, s81
  s_waitcnt vmcnt(9)
  v_perm_b32 v225, v156, v152, s80
  v_perm_b32 v229, v156, v152, s81
  v_perm_b32 v233, v157, v153, s80
  v_perm_b32 v237, v157, v153, s81
  v_perm_b32 v241, v158, v154, s80
  v_perm_b32 v245, v158, v154, s81
  v_perm_b32 v249, v159, v155, s80
  v_perm_b32 v253, v159, v155, s81
  s_waitcnt vmcnt(7)
  v_perm_b32 v226, v164, v160, s80
  v_perm_b32 v230, v164, v160, s81
  v_perm_b32 v234, v165, v161, s80
  v_perm_b32 v238, v165, v161, s81
  v_perm_b32 v242, v166, v162, s80
  v_perm_b32 v246, v166, v162, s81
  v_perm_b32 v250, v167, v163, s80
  v_perm_b32 v254, v167, v163, s81
  s_waitcnt vmcnt(5)
  v_perm_b32 v227, v172, v168, s80
  v_perm_b32 v231, v172, v168, s81
  v_perm_b32 v235, v173, v169, s80
  v_perm_b32 v239, v173, v169, s81
  v_perm_b32 v243, v174, v170, s80
  v_perm_b32 v247, v174, v170, s81
  v_perm_b32 v251, v175, v171, s80
  v_perm_b32 v255, v175, v171, s81
  v_mfma_f32_16x16x32_bf16 v[64:67], v[224:227], v[16:19], 0
  v_mfma_f32_16x16x32_bf16 v[68:71], v[228:231], v[16:19], 0
  v_mfma_f32_16x16x32_bf16 v[72:75], v[232:235], v[16:19], 0
  v_mfma_f32_16x16x32_bf16 v[76:79], v[236:239], v[16:19], 0
  v_mfma_f32_16x16x32_bf16 v[80:83], v[240:243], v[16:19], 0
  v_mfma_f32_16x16x32_bf16 v[84:87], v[244:247], v[16:19], 0
  v_mfma_f32_16x16x32_bf16 v[88:91], v[248:251], v[16:19], 0
  v_mfma_f32_16x16x32_bf16 v[92:95], v[252:255], v[16:19], 0
  s_waitcnt vmcnt(3)
  v_perm_b32 v144, v180, v176, s80
  v_perm_b32 v146, v180, v176, s81
  v_perm_b32 v148, v181, v177, s80
  v_perm_b32 v150, v181, v177, s81
  v_perm_b32 v152, v182, v178, s80
  v_perm_b32 v154, v182, v178, s81
  v_perm_b32 v156, v183, v179, s80
  v_perm_b32 v158, v183, v179, s81
  s_waitcnt vmcnt(1)
  v_perm_b32 v145, v188, v184, s80
  v_perm_b32 v147, v188, v184, s81
  v_perm_b32 v149, v189, v185, s80
  v_perm_b32 v151, v189, v185, s81
  v_perm_b32 v153, v190, v186, s80
  v_perm_b32 v155, v190, v186, s81
  v_perm_b32 v157, v191, v187, s80
  v_perm_b32 v159, v191, v187, s81
  v_mfma_f32_16x16x16_bf16 v[64:67], v[144:145], v[20:21], v[64:67]
  v_mfma_f32_16x16x16_bf16 v[68:71], v[146:147], v[20:21], v[68:71]
  v_mfma_f32_16x16x16_bf16 v[72:75], v[148:149], v[20:21], v[72:75]
  v_mfma_f32_16x16x16_bf16 v[76:79], v[150:151], v[20:21], v[76:79]
  v_mfma_f32_16x16x16_bf16 v[80:83], v[152:153], v[20:21], v[80:83]
  v_mfma_f32_16x16x16_bf16 v[84:87], v[154:155], v[20:21], v[84:87]
  v_mfma_f32_16x16x16_bf16 v[88:91], v[156:157], v[20:21], v[88:91]
  v_mfma_f32_16x16x16_bf16 v[92:95], v[158:159], v[20:21], v[92:95]
  s_branch L_kvf
L_kvpv_3:
  v_mfma_f32_16x16x32_bf16 v[64:67], v[224:227], v[16:19], 0
  v_mfma_f32_16x16x32_bf16 v[68:71], v[228:231], v[16:19], 0
  v_mfma_f32_16x16x32_bf16 v[72:75], v[232:235], v[16:19], 0
  v_mfma_f32_16x16x32_bf16 v[76:79], v[236:239], v[16:19], 0
  v_mfma_f32_16x16x32_bf16 v[80:83], v[240:243], v[16:19], 0
  v_mfma_f32_16x16x32_bf16 v[84:87], v[244:247], v[16:19], 0
  v_mfma_f32_16x16x32_bf16 v[88:91], v[248:251], v[16:19], 0
  v_mfma_f32_16x16x32_bf16 v[92:95], v[252:255], v[16:19], 0
  v_mfma_f32_16x16x16_bf16 v[64:67], v[144:145], v[20:21], v[64:67]
  v_mfma_f32_16x16x16_bf16 v[68:71], v[146:147], v[20:21], v[68:71]
  v_mfma_f32_16x16x16_bf16 v[72:75], v[148:149], v[20:21], v[72:75]
  v_mfma_f32_16x16x16_bf16 v[76:79], v[150:151], v[20:21], v[76:79]
  v_mfma_f32_16x16x16_bf16 v[80:83], v[152:153], v[20:21], v[80:83]
  v_mfma_f32_16x16x16_bf16 v[84:87], v[154:155], v[20:21], v[84:87]
  v_mfma_f32_16x16x16_bf16 v[88:91], v[156:157], v[20:21], v[88:91]
  v_mfma_f32_16x16x16_bf16 v[92:95], v[158:159], v[20:21], v[92:95]
  v_add_f32_dpp v13, v13, v13 row_ror:4 row_mask:0xf bank_mask:0xf
  s_nop 1
  v_add_f32_dpp v13, v13, v13 row_ror:8 row_mask:0xf bank_mask:0xf
  v_mov_b32 v30, v13
  s_nop 1
  v_permlane16_swap_b32 v13, v30
  v_add_f32 v13, v13, v30
  v_mov_b32 v30, v13
  s_nop 1
  v_permlane32_swap_b32 v13, v30
  v_add_f32 v13, v13, v30
  s_mov_b64 exec, 0xf
  ds_write_b32 v15, v13 offset:1344
  s_mov_b64 exec, -1
  s_branch L_kvf
L_kvj_4:
  s_mov_b32 s60, s36
  s_mov_b32 s61, s37
  s_mov_b32 s62, 0x300000
  s_mov_b32 s63, 0x20000
  s_lshl_b32 s8, s5, 2
  s_add_u32 s8, s8, s3
  s_mul_i32 s8, s8, 24576
  s_lshl_b32 s9, s4, 2
  s_add_u32 s9, s9, 19
  s_lshl_b32 s9, s9, 7
  s_add_u32 s8, s8, s9
  v_and_b32 v30, 3, v0
  v_mul_u32_u24 v30, 6144, v30
  buffer_load_dword v6, v30, s[60:63], s8 offen
  v_lshrrev_b32 v7, 4, v0
  v_lshlrev_b32 v7, 4, v7
  v_and_b32 v5, 3, v0
  v_lshlrev_b32 v5, 8, v5
  v_add_u32 v3, v5, v7
  v_and_b32 v5, 15, v0
  v_mul_u32_u24 v5, 576, v5
  s_mul_i32 s8, s3, 2304
  s_add_u32 s8, s8, 1536
  v_add3_u32 v4, v5, v7, s8
  v_and_b32 v14, 3, v0
  v_lshlrev_b32 v14, 4, v14
  s_lshl_b32 s8, s3, 2
  v_add_u32 v15, s8, v14
  s_mov_b32 s10, 0xf000f0
  s_mov_b32 s11, 0xf000f0
  s_mov_b32 s12, 0xf000f00
  s_mov_b32 s13, 0xf000f00
  s_mov_b32 s14, 0xf000f000
  s_mov_b32 s15, 0xf000f000
  s_lshl_b32 s8, s4, 2
  s_add_u32 s8, s8, s3
  s_lshl_b32 s8, s8, 1
  s_add_u32 s8, s8, s64
  s_lshl_b32 s8, s8, 4
  s_add_u32 s8, s8, s65
  s_mul_i32 s76, s8, 576
  s_add_u32 s76, s76, 0x10000
  ds_read_b32 v29, v28
  s_waitcnt lgkmcnt(0)
  v_cmp_ne_u32 vcc, 0, v29
  s_mov_b32 s77, 0
  s_cbranch_vccnz L_kvq2_4
  s_waitcnt vmcnt(15)
  v_perm_b32 v224, v148, v144, s80
  v_perm_b32 v228, v148, v144, s81
  v_perm_b32 v232, v149, v145, s80
  v_perm_b32 v236, v149, v145, s81
  v_perm_b32 v240, v150, v146, s80
  v_perm_b32 v244, v150, v146, s81
  v_perm_b32 v248, v151, v147, s80
  v_perm_b32 v252, v151, v147, s81
  s_waitcnt vmcnt(13)
  v_perm_b32 v225, v156, v152, s80
  v_perm_b32 v229, v156, v152, s81
  v_perm_b32 v233, v157, v153, s80
  v_perm_b32 v237, v157, v153, s81
  v_perm_b32 v241, v158, v154, s80
  v_perm_b32 v245, v158, v154, s81
  v_perm_b32 v249, v159, v155, s80
  v_perm_b32 v253, v159, v155, s81
  s_waitcnt vmcnt(11)
  v_perm_b32 v226, v164, v160, s80
  v_perm_b32 v230, v164, v160, s81
  v_perm_b32 v234, v165, v161, s80
  v_perm_b32 v238, v165, v161, s81
  v_perm_b32 v242, v166, v162, s80
  v_perm_b32 v246, v166, v162, s81
  v_perm_b32 v250, v167, v163, s80
  v_perm_b32 v254, v167, v163, s81
  s_waitcnt vmcnt(9)
  v_perm_b32 v227, v172, v168, s80
  v_perm_b32 v231, v172, v168, s81
  v_perm_b32 v235, v173, v169, s80
  v_perm_b32 v239, v173, v169, s81
  v_perm_b32 v243, v174, v170, s80
  v_perm_b32 v247, v174, v170, s81
  v_perm_b32 v251, v175, v171, s80
  v_perm_b32 v255, v175, v171, s81
  s_waitcnt vmcnt(7)
  v_perm_b32 v144, v180, v176, s80
  v_perm_b32 v148, v180, v176, s81
  v_perm_b32 v152, v181, v177, s80
  v_perm_b32 v156, v181, v177, s81
  v_perm_b32 v160, v182, v178, s80
  v_perm_b32 v164, v182, v178, s81
  v_perm_b32 v168, v183, v179, s80
  v_perm_b32 v172, v183, v179, s81
  s_waitcnt vmcnt(5)
  v_perm_b32 v145, v188, v184, s80
  v_perm_b32 v149, v188, v184, s81
  v_perm_b32 v153, v189, v185, s80
  v_perm_b32 v157, v189, v185, s81
  v_perm_b32 v161, v190, v186, s80
  v_perm_b32 v165, v190, v186, s81
  v_perm_b32 v169, v191, v187, s80
  v_perm_b32 v173, v191, v187, s81
  s_waitcnt vmcnt(3)
  v_perm_b32 v146, v196, v192, s80
  v_perm_b32 v150, v196, v192, s81
  v_perm_b32 v154, v197, v193, s80
  v_perm_b32 v158, v197, v193, s81
  v_perm_b32 v162, v198, v194, s80
  v_perm_b32 v166, v198, v194, s81
  v_perm_b32 v170, v199, v195, s80
  v_perm_b32 v174, v199, v195, s81
  s_waitcnt vmcnt(1)
  v_perm_b32 v147, v204, v200, s80
  v_perm_b32 v151, v204, v200, s81
  v_perm_b32 v155, v205, v201, s80
  v_perm_b32 v159, v205, v201, s81
  v_perm_b32 v163, v206, v202, s80
  v_perm_b32 v167, v206, v202, s81
  v_perm_b32 v171, v207, v203, s80
  v_perm_b32 v175, v207, v203, s81
  s_mov_b32 s77, 1
  v_mov_b32 v9, 1024
L_lw_29:
  ds_read_b32 v8, v9
  s_waitcnt lgkmcnt(0)
  v_cmp_ne_u32 vcc, 0, v8
  s_cbranch_vccnz L_lwd_30
  s_sub_u32 s84, s84, 1
  s_cbranch_scc0 L_lw_29
  s_mov_b32 s84, 0
L_lwd_30:
  s_branch L_kvq2_4
L_kvq_4:
  s_mov_b32 s60, s36
  s_mov_b32 s61, s37
  s_mov_b32 s62, 0x300000
  s_mov_b32 s63, 0x20000
  s_lshl_b32 s8, s5, 2
  s_add_u32 s8, s8, s3
  s_mul_i32 s8, s8, 24576
  s_lshl_b32 s9, s4, 2
  s_add_u32 s9, s9, 19
  s_lshl_b32 s9, s9, 7
  s_add_u32 s8, s8, s9
  v_and_b32 v30, 3, v0
  v_mul_u32_u24 v30, 6144, v30
  buffer_load_dword v6, v30, s[60:63], s8 offen
  v_lshrrev_b32 v7, 4, v0
  v_lshlrev_b32 v7, 4, v7
  v_and_b32 v5, 3, v0
  v_lshlrev_b32 v5, 8, v5
  v_add_u32 v3, v5, v7
  v_and_b32 v5, 15, v0
  v_mul_u32_u24 v5, 576, v5
  s_mul_i32 s8, s3, 2304
  s_add_u32 s8, s8, 1536
  v_add3_u32 v4, v5, v7, s8
  v_and_b32 v14, 3, v0
  v_lshlrev_b32 v14, 4, v14
  s_lshl_b32 s8, s3, 2
  v_add_u32 v15, s8, v14
  s_mov_b32 s10, 0xf000f0
  s_mov_b32 s11, 0xf000f0
  s_mov_b32 s12, 0xf000f00
  s_mov_b32 s13, 0xf000f00
  s_mov_b32 s14, 0xf000f000
  s_mov_b32 s15, 0xf000f000
  s_lshl_b32 s8, s4, 2
  s_add_u32 s8, s8, s3
  s_lshl_b32 s8, s8, 1
  s_add_u32 s8, s8, s64
  s_lshl_b32 s8, s8, 4
  s_add_u32 s8, s8, s65
  s_mul_i32 s76, s8, 576
  s_add_u32 s76, s76, 0x10000
  s_mov_b32 s77, 0
L_kvq2_4:
  ds_read_b32 v8, v28
  ds_read_b128 v[32:35], v3 offset:0
  ds_read_b128 v[36:39], v3 offset:64
  ds_read_b128 v[40:43], v3 offset:128
  ds_read_b128 v[44:47], v3 offset:192
  s_waitcnt lgkmcnt(4)
  v_readfirstlane_b32 s83, v8
  s_lshr_b32 s83, s83, 1
  s_waitcnt vmcnt(17)
  s_waitcnt lgkmcnt(3)
  v_mfma_f32_16x16x32_bf16 v[48:51], v[64:67], v[32:35], 0
  v_mfma_f32_16x16x32_bf16 v[52:55], v[80:83], v[32:35], 0
  v_mfma_f32_16x16x32_bf16 v[56:59], v[96:99], v[32:35], 0
  v_mfma_f32_16x16x32_bf16 v[60:63], v[112:115], v[32:35], 0
  s_waitcnt lgkmcnt(2)
  v_mfma_f32_16x16x32_bf16 v[48:51], v[68:71], v[36:39], v[48:51]
  v_mfma_f32_16x16x32_bf16 v[52:55], v[84:87], v[36:39], v[52:55]
  v_mfma_f32_16x16x32_bf16 v[56:59], v[100:103], v[36:39], v[56:59]
  v_mfma_f32_16x16x32_bf16 v[60:63], v[116:119], v[36:39], v[60:63]
  s_waitcnt lgkmcnt(1)
  v_mfma_f32_16x16x32_bf16 v[48:51], v[72:75], v[40:43], v[48:51]
  v_mfma_f32_16x16x32_bf16 v[52:55], v[88:91], v[40:43], v[52:55]
  v_mfma_f32_16x16x32_bf16 v[56:59], v[104:107], v[40:43], v[56:59]
  v_mfma_f32_16x16x32_bf16 v[60:63], v[120:123], v[40:43], v[60:63]
  s_waitcnt lgkmcnt(0)
  v_mfma_f32_16x16x32_bf16 v[48:51], v[76:79], v[44:47], v[48:51]
  v_mfma_f32_16x16x32_bf16 v[52:55], v[92:95], v[44:47], v[52:55]
  v_mfma_f32_16x16x32_bf16 v[56:59], v[108:111], v[44:47], v[56:59]
  v_mfma_f32_16x16x32_bf16 v[60:63], v[124:127], v[44:47], v[60:63]
  s_nop 5
  v_cndmask_b32 v8, v48, v52, s[10:11]
  v_cndmask_b32 v9, v49, v53, s[10:11]
  v_cndmask_b32 v10, v50, v54, s[10:11]
  v_cndmask_b32 v11, v51, v55, s[10:11]
  v_cndmask_b32 v8, v8, v56, s[12:13]
  v_cndmask_b32 v9, v9, v57, s[12:13]
  v_cndmask_b32 v10, v10, v58, s[12:13]
  v_cndmask_b32 v11, v11, v59, s[12:13]
  v_cndmask_b32 v8, v8, v60, s[14:15]
  v_cndmask_b32 v9, v9, v61, s[14:15]
  v_cndmask_b32 v10, v10, v62, s[14:15]
  v_cndmask_b32 v11, v11, v63, s[14:15]
  v_cvt_pk_bf16_f32 v12, v8, v9
  v_cvt_pk_bf16_f32 v13, v10, v11
  v_lshlrev_b32 v8, 16, v12
  v_and_b32 v9, s82, v12
  v_lshlrev_b32 v10, 16, v13
  v_and_b32 v11, s82, v13
  s_mov_b32 s8, 0x3db504f3
  v_mul_f32 v8, s8, v8
  v_mul_f32 v9, s8, v9
  v_mul_f32 v10, s8, v10
  v_mul_f32 v11, s8, v11
  v_cvt_pk_bf16_f32 v12, v8, v9
  v_cvt_pk_bf16_f32 v13, v10, v11
  v_lshlrev_b32 v8, 16, v12
  v_and_b32 v9, s82, v12
  v_lshlrev_b32 v10, 16, v13
  v_and_b32 v11, s82, v13
  v_max3_f32 v12, v8, v9, v10
  v_max_f32 v12, v12, v11
  s_nop 1
  v_max_f32_dpp v12, v12, v12 row_ror:4 row_mask:0xf bank_mask:0xf
  s_nop 1
  v_max_f32_dpp v12, v12, v12 row_ror:8 row_mask:0xf bank_mask:0xf
  v_mov_b32 v13, v12
  s_nop 1
  v_permlane16_swap_b32 v12, v13
  v_max_f32 v12, v12, v13
  v_mov_b32 v13, v12
  s_nop 1
  v_permlane32_swap_b32 v12, v13
  v_max_f32 v12, v12, v13
  s_mov_b64 exec, 0xf
  ds_write_b32 v15, v12 offset:1280
  s_mov_b64 exec, -1
  s_lshl_b32 s8, s3, 2
  s_add_u32 s8, s8, 1040
  v_mov_b32 v16, s8
  v_mov_b32 v17, 1
  s_mov_b64 s[10:11], exec
  s_mov_b64 exec, 1
  ds_write_b32 v16, v17
  s_mov_b64 exec, s[10:11]
  v_mov_b32 v52, 1040
L_lw_31:
  ds_read_b128 v[48:51], v52
  ds_read_b128 v[56:59], v14 offset:1280
  s_waitcnt lgkmcnt(0)
  v_min3_u32 v48, v48, v49, v50
  v_min_u32 v48, v48, v51
  v_cmp_ne_u32 vcc, 0, v48
  s_cbranch_vccnz L_lwd_32
  s_sub_u32 s84, s84, 1
  s_cbranch_scc0 L_lw_31
  s_mov_b32 s84, 0
L_lwd_32:
  v_max3_f32 v12, v56, v57, v58
  v_max_f32 v12, v12, v59
  v_sub_f32 v8, v8, v12
  v_sub_f32 v9, v9, v12
  v_sub_f32 v10, v10, v12
  v_sub_f32 v11, v11, v12
  v_mul_f32 v8, s85, v8
  v_mul_f32 v9, s85, v9
  v_mul_f32 v10, s85, v10
  v_mul_f32 v11, s85, v11
  v_exp_f32 v8, v8
  v_exp_f32 v9, v9
  v_exp_f32 v10, v10
  v_exp_f32 v11, v11
  v_cvt_pk_bf16_f32 v16, v8, v9
  v_cvt_pk_bf16_f32 v17, v10, v11
  v_add_f32 v13, v8, v9
  v_add_f32 v30, v10, v11
  v_add_f32 v13, v13, v30
  v_mov_b32_dpp v18, v16 row_shl:4 row_mask:0xf bank_mask:0xf bound_ctrl:0
  v_mov_b32_dpp v19, v17 row_shl:4 row_mask:0xf bank_mask:0xf bound_ctrl:0
  v_mov_b32_dpp v20, v16 row_shl:8 row_mask:0xf bank_mask:0xf bound_ctrl:0
  v_mov_b32_dpp v21, v17 row_shl:8 row_mask:0xf bank_mask:0xf bound_ctrl:0
  v_mov_b32_dpp v22, v16 row_shl:12 row_mask:0xf bank_mask:0xf bound_ctrl:0
  v_mov_b32_dpp v23, v17 row_shl:12 row_mask:0xf bank_mask:0xf bound_ctrl:0
  s_cmp_eq_u32 s77, 1
  s_cbranch_scc1 L_kvpv_4
  v_add_f32_dpp v13, v13, v13 row_ror:4 row_mask:0xf bank_mask:0xf
  s_nop 1
  v_add_f32_dpp v13, v13, v13 row_ror:8 row_mask:0xf bank_mask:0xf
  v_mov_b32 v30, v13
  s_nop 1
  v_permlane16_swap_b32 v13, v30
  v_add_f32 v13, v13, v30
  v_mov_b32 v30, v13
  s_nop 1
  v_permlane32_swap_b32 v13, v30
  v_add_f32 v13, v13, v30
  s_mov_b64 exec, 0xf
  ds_write_b32 v15, v13 offset:1344
  s_mov_b64 exec, -1
  s_waitcnt vmcnt(15)
  v_perm_b32 v224, v148, v144, s80
  v_perm_b32 v228, v148, v144, s81
  v_perm_b32 v232, v149, v145, s80
  v_perm_b32 v236, v149, v145, s81
  v_perm_b32 v240, v150, v146, s80
  v_perm_b32 v244, v150, v146, s81
  v_perm_b32 v248, v151, v147, s80
  v_perm_b32 v252, v151, v147, s81
  s_waitcnt vmcnt(13)
  v_perm_b32 v225, v156, v152, s80
  v_perm_b32 v229, v156, v152, s81
  v_perm_b32 v233, v157, v153, s80
  v_perm_b32 v237, v157, v153, s81
  v_perm_b32 v241, v158, v154, s80
  v_perm_b32 v245, v158, v154, s81
  v_perm_b32 v249, v159, v155, s80
  v_perm_b32 v253, v159, v155, s81
  s_waitcnt vmcnt(11)
  v_perm_b32 v226, v164, v160, s80
  v_perm_b32 v230, v164, v160, s81
  v_perm_b32 v234, v165, v161, s80
  v_perm_b32 v238, v165, v161, s81
  v_perm_b32 v242, v166, v162, s80
  v_perm_b32 v246, v166, v162, s81
  v_perm_b32 v250, v167, v163, s80
  v_perm_b32 v254, v167, v163, s81
  s_waitcnt vmcnt(9)
  v_perm_b32 v227, v172, v168, s80
  v_perm_b32 v231, v172, v168, s81
  v_perm_b32 v235, v173, v169, s80
  v_perm_b32 v239, v173, v169, s81
  v_perm_b32 v243, v174, v170, s80
  v_perm_b32 v247, v174, v170, s81
  v_perm_b32 v251, v175, v171, s80
  v_perm_b32 v255, v175, v171, s81
  v_mfma_f32_16x16x32_bf16 v[64:67], v[224:227], v[16:19], 0
  v_mfma_f32_16x16x32_bf16 v[68:71], v[228:231], v[16:19], 0
  v_mfma_f32_16x16x32_bf16 v[72:75], v[232:235], v[16:19], 0
  v_mfma_f32_16x16x32_bf16 v[76:79], v[236:239], v[16:19], 0
  v_mfma_f32_16x16x32_bf16 v[80:83], v[240:243], v[16:19], 0
  v_mfma_f32_16x16x32_bf16 v[84:87], v[244:247], v[16:19], 0
  v_mfma_f32_16x16x32_bf16 v[88:91], v[248:251], v[16:19], 0
  v_mfma_f32_16x16x32_bf16 v[92:95], v[252:255], v[16:19], 0
  s_waitcnt vmcnt(7)
  v_perm_b32 v144, v180, v176, s80
  v_perm_b32 v148, v180, v176, s81
  v_perm_b32 v152, v181, v177, s80
  v_perm_b32 v156, v181, v177, s81
  v_perm_b32 v160, v182, v178, s80
  v_perm_b32 v164, v182, v178, s81
  v_perm_b32 v168, v183, v179, s80
  v_perm_b32 v172, v183, v179, s81
  s_waitcnt vmcnt(5)
  v_perm_b32 v145, v188, v184, s80
  v_perm_b32 v149, v188, v184, s81
  v_perm_b32 v153, v189, v185, s80
  v_perm_b32 v157, v189, v185, s81
  v_perm_b32 v161, v190, v186, s80
  v_perm_b32 v165, v190, v186, s81
  v_perm_b32 v169, v191, v187, s80
  v_perm_b32 v173, v191, v187, s81
  s_waitcnt vmcnt(3)
  v_perm_b32 v146, v196, v192, s80
  v_perm_b32 v150, v196, v192, s81
  v_perm_b32 v154, v197, v193, s80
  v_perm_b32 v158, v197, v193, s81
  v_perm_b32 v162, v198, v194, s80
  v_perm_b32 v166, v198, v194, s81
  v_perm_b32 v170, v199, v195, s80
  v_perm_b32 v174, v199, v195, s81
  s_waitcnt vmcnt(1)
  v_perm_b32 v147, v204, v200, s80
  v_perm_b32 v151, v204, v200, s81
  v_perm_b32 v155, v205, v201, s80
  v_perm_b32 v159, v205, v201, s81
  v_perm_b32 v163, v206, v202, s80
  v_perm_b32 v167, v206, v202, s81
  v_perm_b32 v171, v207, v203, s80
  v_perm_b32 v175, v207, v203, s81
  v_mfma_f32_16x16x32_bf16 v[64:67], v[144:147], v[20:23], v[64:67]
  v_mfma_f32_16x16x32_bf16 v[68:71], v[148:151], v[20:23], v[68:71]
  v_mfma_f32_16x16x32_bf16 v[72:75], v[152:155], v[20:23], v[72:75]
  v_mfma_f32_16x16x32_bf16 v[76:79], v[156:159], v[20:23], v[76:79]
  v_mfma_f32_16x16x32_bf16 v[80:83], v[160:163], v[20:23], v[80:83]
  v_mfma_f32_16x16x32_bf16 v[84:87], v[164:167], v[20:23], v[84:87]
  v_mfma_f32_16x16x32_bf16 v[88:91], v[168:171], v[20:23], v[88:91]
  v_mfma_f32_16x16x32_bf16 v[92:95], v[172:175], v[20:23], v[92:95]
  s_branch L_kvf
L_kvpv_4:
  v_mfma_f32_16x16x32_bf16 v[64:67], v[224:227], v[16:19], 0
  v_mfma_f32_16x16x32_bf16 v[68:71], v[228:231], v[16:19], 0
  v_mfma_f32_16x16x32_bf16 v[72:75], v[232:235], v[16:19], 0
  v_mfma_f32_16x16x32_bf16 v[76:79], v[236:239], v[16:19], 0
  v_mfma_f32_16x16x32_bf16 v[80:83], v[240:243], v[16:19], 0
  v_mfma_f32_16x16x32_bf16 v[84:87], v[244:247], v[16:19], 0
  v_mfma_f32_16x16x32_bf16 v[88:91], v[248:251], v[16:19], 0
  v_mfma_f32_16x16x32_bf16 v[92:95], v[252:255], v[16:19], 0
  v_mfma_f32_16x16x32_bf16 v[64:67], v[144:147], v[20:23], v[64:67]
  v_mfma_f32_16x16x32_bf16 v[68:71], v[148:151], v[20:23], v[68:71]
  v_mfma_f32_16x16x32_bf16 v[72:75], v[152:155], v[20:23], v[72:75]
  v_mfma_f32_16x16x32_bf16 v[76:79], v[156:159], v[20:23], v[76:79]
  v_mfma_f32_16x16x32_bf16 v[80:83], v[160:163], v[20:23], v[80:83]
  v_mfma_f32_16x16x32_bf16 v[84:87], v[164:167], v[20:23], v[84:87]
  v_mfma_f32_16x16x32_bf16 v[88:91], v[168:171], v[20:23], v[88:91]
  v_mfma_f32_16x16x32_bf16 v[92:95], v[172:175], v[20:23], v[92:95]
  v_add_f32_dpp v13, v13, v13 row_ror:4 row_mask:0xf bank_mask:0xf
  s_nop 1
  v_add_f32_dpp v13, v13, v13 row_ror:8 row_mask:0xf bank_mask:0xf
  v_mov_b32 v30, v13
  s_nop 1
  v_permlane16_swap_b32 v13, v30
  v_add_f32 v13, v13, v30
  v_mov_b32 v30, v13
  s_nop 1
  v_permlane32_swap_b32 v13, v30
  v_add_f32 v13, v13, v30
  s_mov_b64 exec, 0xf
  ds_write_b32 v15, v13 offset:1344
  s_mov_b64 exec, -1
  s_branch L_kvf
L_kvj_5:
  s_mov_b32 s60, s36
  s_mov_b32 s61, s37
  s_mov_b32 s62, 0x300000
  s_mov_b32 s63, 0x20000
  s_lshl_b32 s8, s5, 2
  s_add_u32 s8, s8, s3
  s_mul_i32 s8, s8, 24576
  s_lshl_b32 s9, s4, 2
  s_add_u32 s9, s9, 19
  s_lshl_b32 s9, s9, 7
  s_add_u32 s8, s8, s9
  v_and_b32 v30, 3, v0
  v_mul_u32_u24 v30, 6144, v30
  buffer_load_dword v6, v30, s[60:63], s8 offen
  v_lshrrev_b32 v7, 4, v0
  v_lshlrev_b32 v7, 4, v7
  v_and_b32 v5, 3, v0
  v_lshlrev_b32 v5, 8, v5
  v_add_u32 v3, v5, v7
  v_and_b32 v5, 15, v0
  v_mul_u32_u24 v5, 576, v5
  s_mul_i32 s8, s3, 2304
  s_add_u32 s8, s8, 1536
  v_add3_u32 v4, v5, v7, s8
  v_and_b32 v14, 3, v0
  v_lshlrev_b32 v14, 4, v14
  s_lshl_b32 s8, s3, 2
  v_add_u32 v15, s8, v14
  s_mov_b32 s10, 0xf000f0
  s_mov_b32 s11, 0xf000f0
  s_mov_b32 s12, 0xf000f00
  s_mov_b32 s13, 0xf000f00
  s_mov_b32 s14, 0xf000f000
  s_mov_b32 s15, 0xf000f000
  s_lshl_b32 s8, s4, 2
  s_add_u32 s8, s8, s3
  s_lshl_b32 s8, s8, 1
  s_add_u32 s8, s8, s64
  s_lshl_b32 s8, s8, 4
  s_add_u32 s8, s8, s65
  s_mul_i32 s76, s8, 576
  s_add_u32 s76, s76, 0x10000
  ds_read_b32 v29, v28
  s_waitcnt lgkmcnt(0)
  v_cmp_ne_u32 vcc, 0, v29
  s_mov_b32 s77, 0
  s_cbranch_vccnz L_kvq2_5
  s_waitcnt vmcnt(19)
  v_perm_b32 v224, v148, v144, s80
  v_perm_b32 v228, v148, v144, s81
  v_perm_b32 v232, v149, v145, s80
  v_perm_b32 v236, v149, v145, s81
  v_perm_b32 v240, v150, v146, s80
  v_perm_b32 v244, v150, v146, s81
  v_perm_b32 v248, v151, v147, s80
  v_perm_b32 v252, v151, v147, s81
  s_waitcnt vmcnt(17)
  v_perm_b32 v225, v156, v152, s80
  v_perm_b32 v229, v156, v152, s81
  v_perm_b32 v233, v157, v153, s80
  v_perm_b32 v237, v157, v153, s81
  v_perm_b32 v241, v158, v154, s80
  v_perm_b32 v245, v158, v154, s81
  v_perm_b32 v249, v159, v155, s80
  v_perm_b32 v253, v159, v155, s81
  s_waitcnt vmcnt(15)
  v_perm_b32 v226, v164, v160, s80
  v_perm_b32 v230, v164, v160, s81
  v_perm_b32 v234, v165, v161, s80
  v_perm_b32 v238, v165, v161, s81
  v_perm_b32 v242, v166, v162, s80
  v_perm_b32 v246, v166, v162, s81
  v_perm_b32 v250, v167, v163, s80
  v_perm_b32 v254, v167, v163, s81
  s_waitcnt vmcnt(13)
  v_perm_b32 v227, v172, v168, s80
  v_perm_b32 v231, v172, v168, s81
  v_perm_b32 v235, v173, v169, s80
  v_perm_b32 v239, v173, v169, s81
  v_perm_b32 v243, v174, v170, s80
  v_perm_b32 v247, v174, v170, s81
  v_perm_b32 v251, v175, v171, s80
  v_perm_b32 v255, v175, v171, s81
  s_waitcnt vmcnt(11)
  v_perm_b32 v144, v180, v176, s80
  v_perm_b32 v148, v180, v176, s81
  v_perm_b32 v152, v181, v177, s80
  v_perm_b32 v156, v181, v177, s81
  v_perm_b32 v160, v182, v178, s80
  v_perm_b32 v164, v182, v178, s81
  v_perm_b32 v168, v183, v179, s80
  v_perm_b32 v172, v183, v179, s81
  s_waitcnt vmcnt(9)
  v_perm_b32 v145, v188, v184, s80
  v_perm_b32 v149, v188, v184, s81
  v_perm_b32 v153, v189, v185, s80
  v_perm_b32 v157, v189, v185, s81
  v_perm_b32 v161, v190, v186, s80
  v_perm_b32 v165, v190, v186, s81
  v_perm_b32 v169, v191, v187, s80
  v_perm_b32 v173, v191, v187, s81
  s_waitcnt vmcnt(7)
  v_perm_b32 v146, v196, v192, s80
  v_perm_b32 v150, v196, v192, s81
  v_perm_b32 v154, v197, v193, s80
  v_perm_b32 v158, v197, v193, s81
  v_perm_b32 v162, v198, v194, s80
  v_perm_b32 v166, v198, v194, s81
  v_perm_b32 v170, v199, v195, s80
  v_perm_b32 v174, v199, v195, s81
  s_waitcnt vmcnt(5)
  v_perm_b32 v147, v204, v200, s80
  v_perm_b32 v151, v204, v200, s81
  v_perm_b32 v155, v205, v201, s80
  v_perm_b32 v159, v205, v201, s81
  v_perm_b32 v163, v206, v202, s80
  v_perm_b32 v167, v206, v202, s81
  v_perm_b32 v171, v207, v203, s80
  v_perm_b32 v175, v207, v203, s81
  s_waitcnt vmcnt(3)
  v_perm_b32 v176, v212, v208, s80
  v_perm_b32 v178, v212, v208, s81
  v_perm_b32 v180, v213, v209, s80
  v_perm_b32 v182, v213, v209, s81
  v_perm_b32 v184, v214, v210, s80
  v_perm_b32 v186, v214, v210, s81
  v_perm_b32 v188, v215, v211, s80
  v_perm_b32 v190, v215, v211, s81
  s_waitcnt vmcnt(1)
  v_perm_b32 v177, v220, v216, s80
  v_perm_b32 v179, v220, v216, s81
  v_perm_b32 v181, v221, v217, s80
  v_perm_b32 v183, v221, v217, s81
  v_perm_b32 v185, v222, v218, s80
  v_perm_b32 v187, v222, v218, s81
  v_perm_b32 v189, v223, v219, s80
  v_perm_b32 v191, v223, v219, s81
  s_mov_b32 s77, 1
  v_mov_b32 v9, 1024
L_lw_33:
  ds_read_b32 v8, v9
  s_waitcnt lgkmcnt(0)
  v_cmp_ne_u32 vcc, 0, v8
  s_cbranch_vccnz L_lwd_34
  s_sub_u32 s84, s84, 1
  s_cbranch_scc0 L_lw_33
  s_mov_b32 s84, 0
L_lwd_34:
  s_branch L_kvq2_5
L_kvq_5:
  s_mov_b32 s60, s36
  s_mov_b32 s61, s37
  s_mov_b32 s62, 0x300000
  s_mov_b32 s63, 0x20000
  s_lshl_b32 s8, s5, 2
  s_add_u32 s8, s8, s3
  s_mul_i32 s8, s8, 24576
  s_lshl_b32 s9, s4, 2
  s_add_u32 s9, s9, 19
  s_lshl_b32 s9, s9, 7
  s_add_u32 s8, s8, s9
  v_and_b32 v30, 3, v0
  v_mul_u32_u24 v30, 6144, v30
  buffer_load_dword v6, v30, s[60:63], s8 offen
  v_lshrrev_b32 v7, 4, v0
  v_lshlrev_b32 v7, 4, v7
  v_and_b32 v5, 3, v0
  v_lshlrev_b32 v5, 8, v5
  v_add_u32 v3, v5, v7
  v_and_b32 v5, 15, v0
  v_mul_u32_u24 v5, 576, v5
  s_mul_i32 s8, s3, 2304
  s_add_u32 s8, s8, 1536
  v_add3_u32 v4, v5, v7, s8
  v_and_b32 v14, 3, v0
  v_lshlrev_b32 v14, 4, v14
  s_lshl_b32 s8, s3, 2
  v_add_u32 v15, s8, v14
  s_mov_b32 s10, 0xf000f0
  s_mov_b32 s11, 0xf000f0
  s_mov_b32 s12, 0xf000f00
  s_mov_b32 s13, 0xf000f00
  s_mov_b32 s14, 0xf000f000
  s_mov_b32 s15, 0xf000f000
  s_lshl_b32 s8, s4, 2
  s_add_u32 s8, s8, s3
  s_lshl_b32 s8, s8, 1
  s_add_u32 s8, s8, s64
  s_lshl_b32 s8, s8, 4
  s_add_u32 s8, s8, s65
  s_mul_i32 s76, s8, 576
  s_add_u32 s76, s76, 0x10000
  s_mov_b32 s77, 0
L_kvq2_5:
  ds_read_b32 v8, v28
  ds_read_b128 v[32:35], v3 offset:0
  ds_read_b128 v[36:39], v3 offset:64
  ds_read_b128 v[40:43], v3 offset:128
  ds_read_b128 v[44:47], v3 offset:192
  s_waitcnt lgkmcnt(4)
  v_readfirstlane_b32 s83, v8
  s_lshr_b32 s83, s83, 1
  s_waitcnt vmcnt(21)
  s_waitcnt lgkmcnt(3)
  v_mfma_f32_16x16x32_bf16 v[48:51], v[64:67], v[32:35], 0
  v_mfma_f32_16x16x32_bf16 v[52:55], v[80:83], v[32:35], 0
  v_mfma_f32_16x16x32_bf16 v[56:59], v[96:99], v[32:35], 0
  v_mfma_f32_16x16x32_bf16 v[60:63], v[112:115], v[32:35], 0
  v_mfma_f32_16x16x32_bf16 v[24:27], v[128:131], v[32:35], 0
  s_waitcnt lgkmcnt(2)
  v_mfma_f32_16x16x32_bf16 v[48:51], v[68:71], v[36:39], v[48:51]
  v_mfma_f32_16x16x32_bf16 v[52:55], v[84:87], v[36:39], v[52:55]
  v_mfma_f32_16x16x32_bf16 v[56:59], v[100:103], v[36:39], v[56:59]
  v_mfma_f32_16x16x32_bf16 v[60:63], v[116:119], v[36:39], v[60:63]
  v_mfma_f32_16x16x32_bf16 v[24:27], v[132:135], v[36:39], v[24:27]
  s_waitcnt lgkmcnt(1)
  v_mfma_f32_16x16x32_bf16 v[48:51], v[72:75], v[40:43], v[48:51]
  v_mfma_f32_16x16x32_bf16 v[52:55], v[88:91], v[40:43], v[52:55]
  v_mfma_f32_16x16x32_bf16 v[56:59], v[104:107], v[40:43], v[56:59]
  v_mfma_f32_16x16x32_bf16 v[60:63], v[120:123], v[40:43], v[60:63]
  v_mfma_f32_16x16x32_bf16 v[24:27], v[136:139], v[40:43], v[24:27]
  s_waitcnt lgkmcnt(0)
  v_mfma_f32_16x16x32_bf16 v[48:51], v[76:79], v[44:47], v[48:51]
  v_mfma_f32_16x16x32_bf16 v[52:55], v[92:95], v[44:47], v[52:55]
  v_mfma_f32_16x16x32_bf16 v[56:59], v[108:111], v[44:47], v[56:59]
  v_mfma_f32_16x16x32_bf16 v[60:63], v[124:127], v[44:47], v[60:63]
  v_mfma_f32_16x16x32_bf16 v[24:27], v[140:143], v[44:47], v[24:27]
  s_nop 4
  v_cndmask_b32 v8, v48, v52, s[10:11]
  v_cndmask_b32 v9, v49, v53, s[10:11]
  v_cndmask_b32 v10, v50, v54, s[10:11]
  v_cndmask_b32 v11, v51, v55, s[10:11]
  v_cndmask_b32 v8, v8, v56, s[12:13]
  v_cndmask_b32 v9, v9, v57, s[12:13]
  v_cndmask_b32 v10, v10, v58, s[12:13]
  v_cndmask_b32 v11, v11, v59, s[12:13]
  v_cndmask_b32 v8, v8, v60, s[14:15]
  v_cndmask_b32 v9, v9, v61, s[14:15]
  v_cndmask_b32 v10, v10, v62, s[14:15]
  v_cndmask_b32 v11, v11, v63, s[14:15]
  v_cvt_pk_bf16_f32 v12, v8, v9
  v_cvt_pk_bf16_f32 v13, v10, v11
  v_lshlrev_b32 v8, 16, v12
  v_and_b32 v9, s82, v12
  v_lshlrev_b32 v10, 16, v13
  v_and_b32 v11, s82, v13
  v_cvt_pk_bf16_f32 v12, v24, v25
  v_cvt_pk_bf16_f32 v13, v26, v27
  v_lshlrev_b32 v24, 16, v12
  v_and_b32 v25, s82, v12
  v_lshlrev_b32 v26, 16, v13
  v_and_b32 v27, s82, v13
  s_mov_b32 s8, 0x3db504f3
  v_mul_f32 v8, s8, v8
  v_mul_f32 v9, s8, v9
  v_mul_f32 v10, s8, v10
  v_mul_f32 v11, s8, v11
  v_mul_f32 v24, s8, v24
  v_mul_f32 v25, s8, v25
  v_mul_f32 v26, s8, v26
  v_mul_f32 v27, s8, v27
  v_cvt_pk_bf16_f32 v12, v8, v9
  v_cvt_pk_bf16_f32 v13, v10, v11
  v_lshlrev_b32 v8, 16, v12
  v_and_b32 v9, s82, v12
  v_lshlrev_b32 v10, 16, v13
  v_and_b32 v11, s82, v13
  v_cvt_pk_bf16_f32 v12, v24, v25
  v_cvt_pk_bf16_f32 v13, v26, v27
  v_lshlrev_b32 v24, 16, v12
  v_and_b32 v25, s82, v12
  v_lshlrev_b32 v26, 16, v13
  v_and_b32 v27, s82, v13
  v_max3_f32 v12, v8, v9, v10
  v_max_f32 v12, v12, v11
  v_max3_f32 v12, v12, v24, v25
  v_max3_f32 v12, v12, v26, v27
  s_nop 1
  v_max_f32_dpp v12, v12, v12 row_ror:4 row_mask:0xf bank_mask:0xf
  s_nop 1
  v_max_f32_dpp v12, v12, v12 row_ror:8 row_mask:0xf bank_mask:0xf
  v_mov_b32 v13, v12
  s_nop 1
  v_permlane16_swap_b32 v12, v13
  v_max_f32 v12, v12, v13
  v_mov_b32 v13, v12
  s_nop 1
  v_permlane32_swap_b32 v12, v13
  v_max_f32 v12, v12, v13
  s_mov_b64 exec, 0xf
  ds_write_b32 v15, v12 offset:1280
  s_mov_b64 exec, -1
  s_lshl_b32 s8, s3, 2
  s_add_u32 s8, s8, 1040
  v_mov_b32 v16, s8
  v_mov_b32 v17, 1
  s_mov_b64 s[10:11], exec
  s_mov_b64 exec, 1
  ds_write_b32 v16, v17
  s_mov_b64 exec, s[10:11]
  v_mov_b32 v52, 1040
L_lw_35:
  ds_read_b128 v[48:51], v52
  ds_read_b128 v[56:59], v14 offset:1280
  s_waitcnt lgkmcnt(0)
  v_min3_u32 v48, v48, v49, v50
  v_min_u32 v48, v48, v51
  v_cmp_ne_u32 vcc, 0, v48
  s_cbranch_vccnz L_lwd_36
  s_sub_u32 s84, s84, 1
  s_cbranch_scc0 L_lw_35
  s_mov_b32 s84, 0
L_lwd_36:
  v_max3_f32 v12, v56, v57, v58
  v_max_f32 v12, v12, v59
  v_sub_f32 v8, v8, v12
  v_sub_f32 v9, v9, v12
  v_sub_f32 v10, v10, v12
  v_sub_f32 v11, v11, v12
  v_sub_f32 v24, v24, v12
  v_sub_f32 v25, v25, v12
  v_sub_f32 v26, v26, v12
  v_sub_f32 v27, v27, v12
  v_mul_f32 v8, s85, v8
  v_mul_f32 v9, s85, v9
  v_mul_f32 v10, s85, v10
  v_mul_f32 v11, s85, v11
  v_mul_f32 v24, s85, v24
  v_mul_f32 v25, s85, v25
  v_mul_f32 v26, s85, v26
  v_mul_f32 v27, s85, v27
  v_exp_f32 v8, v8
  v_exp_f32 v9, v9
  v_exp_f32 v10, v10
  v_exp_f32 v11, v11
  v_exp_f32 v24, v24
  v_exp_f32 v25, v25
  v_exp_f32 v26, v26
  v_exp_f32 v27, v27
  v_cvt_pk_bf16_f32 v16, v8, v9
  v_cvt_pk_bf16_f32 v17, v10, v11
  v_add_f32 v13, v8, v9
  v_add_f32 v30, v10, v11
  v_add_f32 v13, v13, v30
  v_add_f32 v30, v24, v25
  v_add_f32 v5, v26, v27
  v_add_f32 v30, v30, v5
  v_cvt_pk_bf16_f32 v24, v24, v25
  v_cvt_pk_bf16_f32 v25, v26, v27
  s_mov_b32 s10, 0x000f000f
  s_mov_b32 s11, 0x000f000f
  v_cndmask_b32 v30, 0, v30, s[10:11]
  v_add_f32 v13, v13, v30
  v_mov_b32_dpp v18, v16 row_shl:4 row_mask:0xf bank_mask:0xf bound_ctrl:0
  v_mov_b32_dpp v19, v17 row_shl:4 row_mask:0xf bank_mask:0xf bound_ctrl:0
  v_mov_b32_dpp v20, v16 row_shl:8 row_mask:0xf bank_mask:0xf bound_ctrl:0
  v_mov_b32_dpp v21, v17 row_shl:8 row_mask:0xf bank_mask:0xf bound_ctrl:0
  v_mov_b32_dpp v22, v16 row_shl:12 row_mask:0xf bank_mask:0xf bound_ctrl:0
  v_mov_b32_dpp v23, v17 row_shl:12 row_mask:0xf bank_mask:0xf bound_ctrl:0
  s_cmp_eq_u32 s77, 1
  s_cbranch_scc1 L_kvpv_5
  v_add_f32_dpp v13, v13, v13 row_ror:4 row_mask:0xf bank_mask:0xf
  s_nop 1
  v_add_f32_dpp v13, v13, v13 row_ror:8 row_mask:0xf bank_mask:0xf
  v_mov_b32 v30, v13
  s_nop 1
  v_permlane16_swap_b32 v13, v30
  v_add_f32 v13, v13, v30
  v_mov_b32 v30, v13
  s_nop 1
  v_permlane32_swap_b32 v13, v30
  v_add_f32 v13, v13, v30
  s_mov_b64 exec, 0xf
  ds_write_b32 v15, v13 offset:1344
  s_mov_b64 exec, -1
  s_waitcnt vmcnt(19)
  v_perm_b32 v224, v148, v144, s80
  v_perm_b32 v228, v148, v144, s81
  v_perm_b32 v232, v149, v145, s80
  v_perm_b32 v236, v149, v145, s81
  v_perm_b32 v240, v150, v146, s80
  v_perm_b32 v244, v150, v146, s81
  v_perm_b32 v248, v151, v147, s80
  v_perm_b32 v252, v151, v147, s81
  s_waitcnt vmcnt(17)
  v_perm_b32 v225, v156, v152, s80
  v_perm_b32 v229, v156, v152, s81
  v_perm_b32 v233, v157, v153, s80
  v_perm_b32 v237, v157, v153, s81
  v_perm_b32 v241, v158, v154, s80
  v_perm_b32 v245, v158, v154, s81
  v_perm_b32 v249, v159, v155, s80
  v_perm_b32 v253, v159, v155, s81
  s_waitcnt vmcnt(15)
  v_perm_b32 v226, v164, v160, s80
  v_perm_b32 v230, v164, v160, s81
  v_perm_b32 v234, v165, v161, s80
  v_perm_b32 v238, v165, v161, s81
  v_perm_b32 v242, v166, v162, s80
  v_perm_b32 v246, v166, v162, s81
  v_perm_b32 v250, v167, v163, s80
  v_perm_b32 v254, v167, v163, s81
  s_waitcnt vmcnt(13)
  v_perm_b32 v227, v172, v168, s80
  v_perm_b32 v231, v172, v168, s81
  v_perm_b32 v235, v173, v169, s80
  v_perm_b32 v239, v173, v169, s81
  v_perm_b32 v243, v174, v170, s80
  v_perm_b32 v247, v174, v170, s81
  v_perm_b32 v251, v175, v171, s80
  v_perm_b32 v255, v175, v171, s81
  v_mfma_f32_16x16x32_bf16 v[64:67], v[224:227], v[16:19], 0
  v_mfma_f32_16x16x32_bf16 v[68:71], v[228:231], v[16:19], 0
  v_mfma_f32_16x16x32_bf16 v[72:75], v[232:235], v[16:19], 0
  v_mfma_f32_16x16x32_bf16 v[76:79], v[236:239], v[16:19], 0
  v_mfma_f32_16x16x32_bf16 v[80:83], v[240:243], v[16:19], 0
  v_mfma_f32_16x16x32_bf16 v[84:87], v[244:247], v[16:19], 0
  v_mfma_f32_16x16x32_bf16 v[88:91], v[248:251], v[16:19], 0
  v_mfma_f32_16x16x32_bf16 v[92:95], v[252:255], v[16:19], 0
  s_waitcnt vmcnt(11)
  v_perm_b32 v144, v180, v176, s80
  v_perm_b32 v148, v180, v176, s81
  v_perm_b32 v152, v181, v177, s80
  v_perm_b32 v156, v181, v177, s81
  v_perm_b32 v160, v182, v178, s80
  v_perm_b32 v164, v182, v178, s81
  v_perm_b32 v168, v183, v179, s80
  v_perm_b32 v172, v183, v179, s81
  s_waitcnt vmcnt(9)
  v_perm_b32 v145, v188, v184, s80
  v_perm_b32 v149, v188, v184, s81
  v_perm_b32 v153, v189, v185, s80
  v_perm_b32 v157, v189, v185, s81
  v_perm_b32 v161, v190, v186, s80
  v_perm_b32 v165, v190, v186, s81
  v_perm_b32 v169, v191, v187, s80
  v_perm_b32 v173, v191, v187, s81
  s_waitcnt vmcnt(7)
  v_perm_b32 v146, v196, v192, s80
  v_perm_b32 v150, v196, v192, s81
  v_perm_b32 v154, v197, v193, s80
  v_perm_b32 v158, v197, v193, s81
  v_perm_b32 v162, v198, v194, s80
  v_perm_b32 v166, v198, v194, s81
  v_perm_b32 v170, v199, v195, s80
  v_perm_b32 v174, v199, v195, s81
  s_waitcnt vmcnt(5)
  v_perm_b32 v147, v204, v200, s80
  v_perm_b32 v151, v204, v200, s81
  v_perm_b32 v155, v205, v201, s80
  v_perm_b32 v159, v205, v201, s81
  v_perm_b32 v163, v206, v202, s80
  v_perm_b32 v167, v206, v202, s81
  v_perm_b32 v171, v207, v203, s80
  v_perm_b32 v175, v207, v203, s81
  v_mfma_f32_16x16x32_bf16 v[64:67], v[144:147], v[20:23], v[64:67]
  v_mfma_f32_16x16x32_bf16 v[68:71], v[148:151], v[20:23], v[68:71]
  v_mfma_f32_16x16x32_bf16 v[72:75], v[152:155], v[20:23], v[72:75]
  v_mfma_f32_16x16x32_bf16 v[76:79], v[156:159], v[20:23], v[76:79]
  v_mfma_f32_16x16x32_bf16 v[80:83], v[160:163], v[20:23], v[80:83]
  v_mfma_f32_16x16x32_bf16 v[84:87], v[164:167], v[20:23], v[84:87]
  v_mfma_f32_16x16x32_bf16 v[88:91], v[168:171], v[20:23], v[88:91]
  v_mfma_f32_16x16x32_bf16 v[92:95], v[172:175], v[20:23], v[92:95]
  s_waitcnt vmcnt(3)
  v_perm_b32 v176, v212, v208, s80
  v_perm_b32 v178, v212, v208, s81
  v_perm_b32 v180, v213, v209, s80
  v_perm_b32 v182, v213, v209, s81
  v_perm_b32 v184, v214, v210, s80
  v_perm_b32 v186, v214, v210, s81
  v_perm_b32 v188, v215, v211, s80
  v_perm_b32 v190, v215, v211, s81
  s_waitcnt vmcnt(1)
  v_perm_b32 v177, v220, v216, s80
  v_perm_b32 v179, v220, v216, s81
  v_perm_b32 v181, v221, v217, s80
  v_perm_b32 v183, v221, v217, s81
  v_perm_b32 v185, v222, v218, s80
  v_perm_b32 v187, v222, v218, s81
  v_perm_b32 v189, v223, v219, s80
  v_perm_b32 v191, v223, v219, s81
  v_mfma_f32_16x16x16_bf16 v[64:67], v[176:177], v[24:25], v[64:67]
  v_mfma_f32_16x16x16_bf16 v[68:71], v[178:179], v[24:25], v[68:71]
  v_mfma_f32_16x16x16_bf16 v[72:75], v[180:181], v[24:25], v[72:75]
  v_mfma_f32_16x16x16_bf16 v[76:79], v[182:183], v[24:25], v[76:79]
  v_mfma_f32_16x16x16_bf16 v[80:83], v[184:185], v[24:25], v[80:83]
  v_mfma_f32_16x16x16_bf16 v[84:87], v[186:187], v[24:25], v[84:87]
  v_mfma_f32_16x16x16_bf16 v[88:91], v[188:189], v[24:25], v[88:91]
  v_mfma_f32_16x16x16_bf16 v[92:95], v[190:191], v[24:25], v[92:95]
  s_branch L_kvf
L_kvpv_5:
  v_mfma_f32_16x16x32_bf16 v[64:67], v[224:227], v[16:19], 0
  v_mfma_f32_16x16x32_bf16 v[68:71], v[228:231], v[16:19], 0
  v_mfma_f32_16x16x32_bf16 v[72:75], v[232:235], v[16:19], 0
  v_mfma_f32_16x16x32_bf16 v[76:79], v[236:239], v[16:19], 0
  v_mfma_f32_16x16x32_bf16 v[80:83], v[240:243], v[16:19], 0
  v_mfma_f32_16x16x32_bf16 v[84:87], v[244:247], v[16:19], 0
  v_mfma_f32_16x16x32_bf16 v[88:91], v[248:251], v[16:19], 0
  v_mfma_f32_16x16x32_bf16 v[92:95], v[252:255], v[16:19], 0
  v_mfma_f32_16x16x32_bf16 v[64:67], v[144:147], v[20:23], v[64:67]
  v_mfma_f32_16x16x32_bf16 v[68:71], v[148:151], v[20:23], v[68:71]
  v_mfma_f32_16x16x32_bf16 v[72:75], v[152:155], v[20:23], v[72:75]
  v_mfma_f32_16x16x32_bf16 v[76:79], v[156:159], v[20:23], v[76:79]
  v_mfma_f32_16x16x32_bf16 v[80:83], v[160:163], v[20:23], v[80:83]
  v_mfma_f32_16x16x32_bf16 v[84:87], v[164:167], v[20:23], v[84:87]
  v_mfma_f32_16x16x32_bf16 v[88:91], v[168:171], v[20:23], v[88:91]
  v_mfma_f32_16x16x32_bf16 v[92:95], v[172:175], v[20:23], v[92:95]
  v_mfma_f32_16x16x16_bf16 v[64:67], v[176:177], v[24:25], v[64:67]
  v_mfma_f32_16x16x16_bf16 v[68:71], v[178:179], v[24:25], v[68:71]
  v_mfma_f32_16x16x16_bf16 v[72:75], v[180:181], v[24:25], v[72:75]
  v_mfma_f32_16x16x16_bf16 v[76:79], v[182:183], v[24:25], v[76:79]
  v_mfma_f32_16x16x16_bf16 v[80:83], v[184:185], v[24:25], v[80:83]
  v_mfma_f32_16x16x16_bf16 v[84:87], v[186:187], v[24:25], v[84:87]
  v_mfma_f32_16x16x16_bf16 v[88:91], v[188:189], v[24:25], v[88:91]
  v_mfma_f32_16x16x16_bf16 v[92:95], v[190:191], v[24:25], v[92:95]
  v_add_f32_dpp v13, v13, v13 row_ror:4 row_mask:0xf bank_mask:0xf
  s_nop 1
  v_add_f32_dpp v13, v13, v13 row_ror:8 row_mask:0xf bank_mask:0xf
  v_mov_b32 v30, v13
  s_nop 1
  v_permlane16_swap_b32 v13, v30
  v_add_f32 v13, v13, v30
  v_mov_b32 v30, v13
  s_nop 1
  v_permlane32_swap_b32 v13, v30
  v_add_f32 v13, v13, v30
  s_mov_b64 exec, 0xf
  ds_write_b32 v15, v13 offset:1344
  s_mov_b64 exec, -1
  s_branch L_kvf
L_kvf:
  s_mul_i32 s8, s3, 576
  s_add_u32 s8, s8, 1536
  v_and_b32 v24, 31, v0
  v_lshlrev_b32 v24, 4, v24
  v_add_u32 v24, s8, v24
  s_lshl_b32 s9, s3, 4
  s_add_u32 s9, s9, 1280
  v_mov_b32 v25, s9
  v_lshlrev_b32 v57, 4, v0
  v_mov_b32 v54, 0
  v_mov_b32 v55, s7
  v_readlane_b32 s78, v12, s3
  s_nop 1
  v_mov_b32 v56, s78
  v_mov_b32 v16, 1056
  s_lshl_b32 s8, s3, 2
  v_add_u32 v16, s8, v16
  v_mov_b32 v17, 1
  s_mov_b32 exec_lo, 0x000f000f
  s_mov_b32 exec_hi, 0x000f000f
  ds_write_b128 v4, v[64:67] offset:0
  ds_write_b128 v4, v[68:71] offset:64
  ds_write_b128 v4, v[72:75] offset:128
  ds_write_b128 v4, v[76:79] offset:192
  ds_write_b128 v4, v[80:83] offset:256
  ds_write_b128 v4, v[84:87] offset:320
  ds_write_b128 v4, v[88:91] offset:384
  ds_write_b128 v4, v[92:95] offset:448
  s_mov_b64 exec, 1
  ds_write_b32 v16, v17
  s_mov_b64 exec, -1
  v_mov_b32 v12, 1056
L_lw_37:
  ds_read_b128 v[8:11], v12
  ds_read_b128 v[32:35], v24 offset:0
  ds_read_b128 v[36:39], v24 offset:2304
  ds_read_b128 v[40:43], v24 offset:4608
  ds_read_b128 v[44:47], v24 offset:6912
  ds_read_b128 v[48:51], v25 offset:64
  s_waitcnt lgkmcnt(0)
  v_min3_u32 v8, v8, v9, v10
  v_min_u32 v8, v8, v11
  v_cmp_ne_u32 vcc, 0, v8
  s_cbranch_vccnz L_lwd_38
  s_sub_u32 s84, s84, 1
  s_cbranch_scc0 L_lw_37
  s_mov_b32 s84, 0
L_lwd_38:
  v_add_f32 v32, v32, v36
  v_add_f32 v40, v40, v44
  v_add_f32 v33, v33, v37
  v_add_f32 v41, v41, v45
  v_add_f32 v34, v34, v38
  v_add_f32 v42, v42, v46
  v_add_f32 v35, v35, v39
  v_add_f32 v43, v43, v47
  v_add_f32 v48, v48, v49
  v_add_f32 v50, v50, v51
  v_add_f32 v32, v32, v40
  v_add_f32 v33, v33, v41
  v_add_f32 v34, v34, v42
  v_add_f32 v35, v35, v43
  v_add_f32 v48, v48, v50
  v_cvt_pk_bf16_f32 v52, v32, v33
  v_cvt_pk_bf16_f32 v53, v34, v35
  s_mov_b32 s10, 0
  s_mov_b32 s11, 1
  v_cndmask_b32 v52, v52, v56, s[10:11]
  v_cndmask_b32 v53, v53, v48, s[10:11]
  s_mov_b32 s10, -1
  s_mov_b32 s11, 1
  s_mov_b64 exec, s[10:11]
  s_cmp_eq_u32 s83, 0
  s_cbranch_scc1 L_slow_39
  buffer_store_dwordx4 v[52:55], v57, s[44:47], s76 offen
  s_branch L_sd_40
L_slow_39:
  buffer_store_dwordx4 v[52:55], v57, s[44:47], s76 offen sc1
L_sd_40:
  s_mov_b64 exec, 1
  ds_write_b32 v16, v17 offset:160
  s_mov_b64 exec, -1
  s_endpgm
L_tile:
  s_sub_u32 s64, s3, 4
  s_mul_i32 s8, s64, 640
  s_add_u32 s8, s8, 10752
  v_lshrrev_b32 v8, 5, v0
  v_and_b32 v9, 31, v0
  v_mul_u32_u24 v10, 384, v8
  v_lshlrev_b32 v11, 3, v9
  v_add3_u32 v3, v10, v11, s8
  v_and_b32 v10, 1, v0
  v_mul_u32_u24 v10, 384, v10
  v_bfe_u32 v11, v0, 1, 1
  v_lshlrev_b32 v11, 6, v11
  v_lshrrev_b32 v12, 4, v0
  v_lshlrev_b32 v12, 4, v12
  v_add3_u32 v7, v10, v11, v12
  v_add_u32 v4, s8, v7
  v_lshrrev_b32 v10, 4, v9
  v_lshlrev_b32 v10, 9, v10
  v_lshlrev_b32 v11, 8, v8
  v_and_b32 v12, 15, v0
  v_lshlrev_b32 v12, 4, v12
  v_add3_u32 v5, v10, v11, v12
  s_lshl_b32 s8, s64, 9
  s_add_u32 s8, s8, 13312
  v_and_b32 v10, 7, v0
  v_lshlrev_b32 v10, 5, v10
  v_add_u32 v6, s8, v10
  s_waitcnt lgkmcnt(0)
  s_barrier
  s_load_dword s6, s[42:43], 0
  s_mov_b32 s44, s42
  s_mov_b32 s45, s43
  s_mov_b32 s46, 0x180000
  s_mov_b32 s47, 0x20000
  s_cmp_lt_u32 s5, 4
  s_cbranch_scc1 L_mf
  s_cmp_lt_u32 s5, 4
  s_cbranch_scc1 L_bb
  s_cmp_lt_u32 s5, 12
  s_cbranch_scc1 L_wq
  s_cmp_lt_u32 s5, 20
  s_cbranch_scc1 L_wo
  s_cmp_lt_u32 s5, 24
  s_cbranch_scc1 L_mr
  s_cmp_lt_u32 s5, 31
  s_cbranch_scc1 L_ffn
  s_waitcnt lgkmcnt(0)
  s_mul_i32 s7, s6, 1664525
  s_add_u32 s7, s7, 1013904223
  s_and_b32 s7, s7, 0xbfffbfff
  s_mov_b32 s8, 12
  s_cmp_ge_u32 s64, 2
  s_cbranch_scc1 L_pf2
  s_branch L_qpoll
L_bb:
  s_waitcnt lgkmcnt(0)
  s_mul_i32 s7, s6, 1664525
  s_add_u32 s7, s7, 1013904223
  s_and_b32 s7, s7, 0xbfffbfff
  s_cmp_eq_u32 s64, 0
  s_cbranch_scc1 L_qpoll
  s_branch L_tail
L_mf:
  s_mov_b32 s56, s34
  s_mov_b32 s57, s35
  s_mov_b32 s58, 0x800
  s_mov_b32 s59, 0x20000
  s_mov_b32 s48, s36
  s_mov_b32 s49, s37
  s_mov_b32 s50, 0x300000
  s_mov_b32 s51, 0x20000
  s_and_b32 s8, s5, 1
  s_lshl_b32 s65, s4, 1
  s_add_u32 s65, s65, s8
  s_lshr_b32 s69, s5, 1
  v_lshrrev_b32 v8, 5, v0
  v_and_b32 v9, 31, v0
  v_lshlrev_b32 v10, 10, v8
  v_lshlrev_b32 v11, 3, v9
  s_lshl_b32 s8, s64, 8
  v_add3_u32 v12, v10, v11, s8
  buffer_load_dwordx2 v[24:25], v12, s[56:59], 0 offen
  v_bfe_u32 v10, v0, 2, 2
  v_lshlrev_b32 v10, 5, v10
  v_lshrrev_b32 v11, 4, v0
  v_lshlrev_b32 v11, 3, v11
  v_add_u32 v10, v10, v11
  v_mul_u32_u24 v10, 6144, v10
  v_and_b32 v11, 3, v0
  v_lshlrev_b32 v11, 4, v11
  v_add_u32 v2, v10, v11
  s_mul_i32 s67, s64, 786432
  s_lshl_b32 s8, s65, 7
  s_add_u32 s67, s67, s8
  s_lshl_b32 s8, s69, 6
  s_add_u32 s67, s67, s8
  buffer_load_dwordx4 v[64:67], v2, s[48:51], s67 offen nt
  s_add_u32 s68, s67, 6144
  buffer_load_dwordx4 v[68:71], v2, s[48:51], s68 offen nt
  s_add_u32 s68, s67, 12288
  buffer_load_dwordx4 v[72:75], v2, s[48:51], s68 offen nt
  s_add_u32 s68, s67, 18432
  buffer_load_dwordx4 v[76:79], v2, s[48:51], s68 offen nt
  s_add_u32 s68, s67, 24576
  buffer_load_dwordx4 v[80:83], v2, s[48:51], s68 offen nt
  s_add_u32 s68, s67, 30720
  buffer_load_dwordx4 v[84:87], v2, s[48:51], s68 offen nt
  s_add_u32 s68, s67, 36864
  buffer_load_dwordx4 v[88:91], v2, s[48:51], s68 offen nt
  s_add_u32 s68, s67, 43008
  buffer_load_dwordx4 v[92:95], v2, s[48:51], s68 offen nt
  s_lshl_b32 s8, s64, 2
  s_add_u32 s8, s8, 1136
  v_mov_b32 v8, s8
  v_mov_b32 v9, 1
  s_mov_b64 s[10:11], exec
  s_mov_b64 exec, 1
  ds_write_b32 v8, v9
  s_mov_b64 exec, s[10:11]
  s_waitcnt lgkmcnt(0)
  s_mul_i32 s7, s6, 1664525
  s_add_u32 s7, s7, 1013904223
  s_and_b32 s7, s7, 0xbfffbfff
  v_and_b32 v200, 31, v0
  v_lshlrev_b32 v200, 4, v200
  v_add_u32 v201, 13312, v200
  s_lshl_b32 s66, s65, 9
  s_add_u32 s66, s66, 0x1000
  s_lshl_b32 s8, s69, 7
  s_add_u32 s66, s66, s8
  s_mul_i32 s8, s64, 640
  s_add_u32 s8, s8, 10752
  v_and_b32 v10, 1, v0
  v_mul_u32_u24 v10, 384, v10
  v_bfe_u32 v11, v0, 1, 2
  v_lshlrev_b32 v11, 6, v11
  v_lshrrev_b32 v13, 4, v0
  v_lshlrev_b32 v13, 4, v13
  v_add3_u32 v4, v10, v11, v13
  v_add_u32 v4, s8, v4
  s_lshl_b32 s8, s64, 9
  s_add_u32 s8, s8, 13312
  v_and_b32 v10, 3, v0
  v_lshlrev_b32 v10, 5, v10
  v_lshrrev_b32 v13, 4, v0
  v_lshlrev_b32 v13, 7, v13
  v_add3_u32 v6, v10, v13, s8
  s_mov_b32 s72, 0x0f00000f
  s_mov_b32 s73, 0
  s_mov_b32 s74, 0x00ff00ff
  s_mov_b32 s75, 0
  s_waitcnt vmcnt(8)
  v_lshlrev_b32 v8, 16, v24
  v_and_b32 v9, s82, v24
  v_lshlrev_b32 v10, 16, v25
  v_and_b32 v11, s82, v25
  v_mul_f32 v16, s85, v8
  v_mul_f32 v17, s85, v9
  v_mul_f32 v18, s85, v10
  v_mul_f32 v19, s85, v11
  v_exp_f32 v16, -v16
  v_exp_f32 v17, -v17
  v_exp_f32 v18, -v18
  v_exp_f32 v19, -v19
  v_add_f32 v16, 1.0, v16
  v_add_f32 v17, 1.0, v17
  v_add_f32 v18, 1.0, v18
  v_add_f32 v19, 1.0, v19
  v_rcp_f32 v16, v16
  v_rcp_f32 v17, v17
  v_rcp_f32 v18, v18
  v_rcp_f32 v19, v19
  v_mul_f32 v8, v8, v16
  v_mul_f32 v9, v9, v17
  v_mul_f32 v10, v10, v18
  v_mul_f32 v11, v11, v19
  v_cvt_pk_bf16_f32 v12, v8, v9
  v_cvt_pk_bf16_f32 v13, v10, v11
  ds_write_b64 v3, v[12:13]
  s_waitcnt vmcnt(0)
  v_perm_b32 v128, v68, v64, s80
  v_perm_b32 v132, v68, v64, s81
  v_perm_b32 v129, v76, v72, s80
  v_perm_b32 v133, v76, v72, s81
  v_perm_b32 v130, v84, v80, s80
  v_perm_b32 v134, v84, v80, s81
  v_perm_b32 v131, v92, v88, s80
  v_perm_b32 v135, v92, v88, s81
  v_perm_b32 v136, v69, v65, s80
  v_perm_b32 v140, v69, v65, s81
  v_perm_b32 v137, v77, v73, s80
  v_perm_b32 v141, v77, v73, s81
  v_perm_b32 v138, v85, v81, s80
  v_perm_b32 v142, v85, v81, s81
  v_perm_b32 v139, v93, v89, s80
  v_perm_b32 v143, v93, v89, s81
  v_perm_b32 v144, v70, v66, s80
  v_perm_b32 v148, v70, v66, s81
  v_perm_b32 v145, v78, v74, s80
  v_perm_b32 v149, v78, v74, s81
  v_perm_b32 v146, v86, v82, s80
  v_perm_b32 v150, v86, v82, s81
  v_perm_b32 v147, v94, v90, s80
  v_perm_b32 v151, v94, v90, s81
  v_perm_b32 v152, v71, v67, s80
  v_perm_b32 v156, v71, v67, s81
  v_perm_b32 v153, v79, v75, s80
  v_perm_b32 v157, v79, v75, s81
  v_perm_b32 v154, v87, v83, s80
  v_perm_b32 v158, v87, v83, s81
  v_perm_b32 v155, v95, v91, s80
  v_perm_b32 v159, v95, v91, s81
  s_waitcnt lgkmcnt(0)
  ds_read_b128 v[8:11], v4 offset:0
  s_waitcnt lgkmcnt(0)
  v_mfma_f32_16x16x32_bf16 v[32:35], v[8:11], v[128:131], 0
  v_mfma_f32_16x16x32_bf16 v[36:39], v[8:11], v[132:135], 0
  v_mfma_f32_16x16x32_bf16 v[40:43], v[8:11], v[136:139], 0
  v_mfma_f32_16x16x32_bf16 v[44:47], v[8:11], v[140:143], 0
  v_mfma_f32_16x16x32_bf16 v[48:51], v[8:11], v[144:147], 0
  v_mfma_f32_16x16x32_bf16 v[52:55], v[8:11], v[148:151], 0
  v_mfma_f32_16x16x32_bf16 v[56:59], v[8:11], v[152:155], 0
  v_mfma_f32_16x16x32_bf16 v[60:63], v[8:11], v[156:159], 0
  s_nop 0
  v_add_f32_dpp v16, v34, v32 row_shl:4 row_mask:0xf bank_mask:0xf
  v_add_f32_dpp v24, v35, v33 row_shl:4 row_mask:0xf bank_mask:0xf
  v_add_f32_dpp v17, v38, v36 row_shl:4 row_mask:0xf bank_mask:0xf
  v_add_f32_dpp v25, v39, v37 row_shl:4 row_mask:0xf bank_mask:0xf
  v_add_f32_dpp v18, v42, v40 row_shl:4 row_mask:0xf bank_mask:0xf
  v_add_f32_dpp v26, v43, v41 row_shl:4 row_mask:0xf bank_mask:0xf
  v_add_f32_dpp v19, v46, v44 row_shl:4 row_mask:0xf bank_mask:0xf
  v_add_f32_dpp v27, v47, v45 row_shl:4 row_mask:0xf bank_mask:0xf
  v_add_f32_dpp v20, v50, v48 row_shl:4 row_mask:0xf bank_mask:0xf
  v_add_f32_dpp v28, v51, v49 row_shl:4 row_mask:0xf bank_mask:0xf
  v_add_f32_dpp v21, v54, v52 row_shl:4 row_mask:0xf bank_mask:0xf
  v_add_f32_dpp v29, v55, v53 row_shl:4 row_mask:0xf bank_mask:0xf
  v_add_f32_dpp v22, v58, v56 row_shl:4 row_mask:0xf bank_mask:0xf
  v_add_f32_dpp v30, v59, v57 row_shl:4 row_mask:0xf bank_mask:0xf
  v_add_f32_dpp v23, v62, v60 row_shl:4 row_mask:0xf bank_mask:0xf
  v_add_f32_dpp v31, v63, v61 row_shl:4 row_mask:0xf bank_mask:0xf
  s_mov_b64 exec, s[72:73]
  ds_write_b128 v6, v[16:19]
  ds_write_b128 v6, v[20:23] offset:16
  ds_write_b128 v6, v[24:27] offset:256
  ds_write_b128 v6, v[28:31] offset:272
  s_mov_b64 exec, -1
  s_lshl_b32 s8, s64, 2
  s_add_u32 s8, s8, 1072
  v_mov_b32 v8, s8
  v_mov_b32 v9, 1
  s_mov_b64 s[10:11], exec
  s_mov_b64 exec, 1
  ds_write_b32 v8, v9
  s_mov_b64 exec, s[10:11]
  s_cmp_lg_u32 s64, 0
  s_cbranch_scc1 L_tail
  v_mov_b32 v18, 0
  v_mov_b32 v19, s7
  v_mov_b32 v12, 1072
L_lw_41:
  ds_read_b128 v[8:11], v12
  ds_read_b128 v[32:35], v201 offset:0
  ds_read_b128 v[36:39], v201 offset:512
  ds_read_b128 v[40:43], v201 offset:1024
  ds_read_b128 v[44:47], v201 offset:1536
  s_waitcnt lgkmcnt(0)
  v_min3_u32 v8, v8, v9, v10
  v_min_u32 v8, v8, v11
  v_cmp_ne_u32 vcc, 0, v8
  s_cbranch_vccnz L_lwd_42
  s_sub_u32 s84, s84, 1
  s_cbranch_scc0 L_lw_41
  s_mov_b32 s84, 0
L_lwd_42:
  v_add_f32 v32, v32, v36
  v_add_f32 v40, v40, v44
  v_add_f32 v33, v33, v37
  v_add_f32 v41, v41, v45
  v_add_f32 v34, v34, v38
  v_add_f32 v42, v42, v46
  v_add_f32 v35, v35, v39
  v_add_f32 v43, v43, v47
  v_add_f32 v32, v32, v40
  v_add_f32 v33, v33, v41
  v_add_f32 v34, v34, v42
  v_add_f32 v35, v35, v43
  v_add_f32_dpp v32, v32, v32 row_shl:8 row_mask:0xf bank_mask:0xf
  v_add_f32_dpp v33, v33, v33 row_shl:8 row_mask:0xf bank_mask:0xf
  v_add_f32_dpp v34, v34, v34 row_shl:8 row_mask:0xf bank_mask:0xf
  v_add_f32_dpp v35, v35, v35 row_shl:8 row_mask:0xf bank_mask:0xf
  v_cvt_pk_bf16_f32 v16, v32, v33
  v_cvt_pk_bf16_f32 v17, v34, v35
  s_mov_b64 exec, s[74:75]
  buffer_store_dwordx4 v[16:19], v200, s[44:47], s66 offen sc1
  s_mov_b64 exec, -1
  v_mov_b32 v8, 1168
  v_mov_b32 v9, 1
  s_mov_b64 s[10:11], exec
  s_mov_b64 exec, 1
  ds_write_b32 v8, v9
  s_mov_b64 exec, s[10:11]
  s_branch L_qpoll
L_mr:
  s_mov_b32 s56, s34
  s_mov_b32 s57, s35
  s_mov_b32 s58, 0x800
  s_mov_b32 s59, 0x20000
  s_mov_b32 s48, s36
  s_mov_b32 s49, s37
  s_mov_b32 s50, 0x300000
  s_mov_b32 s51, 0x20000
  s_lshl_b32 s65, s4, 2
  s_add_u32 s65, s65, s5
  s_sub_u32 s65, s65, 4
  v_lshrrev_b32 v8, 5, v0
  v_and_b32 v9, 31, v0
  v_lshlrev_b32 v10, 10, v8
  v_lshlrev_b32 v11, 3, v9
  s_lshl_b32 s8, s64, 8
  v_add3_u32 v12, v10, v11, s8
  buffer_load_dwordx2 v[24:25], v12, s[56:59], 0 offen
  v_bfe_u32 v10, v0, 3, 1
  v_lshlrev_b32 v10, 5, v10
  v_lshrrev_b32 v11, 4, v0
  v_lshlrev_b32 v11, 3, v11
  v_add_u32 v10, v10, v11
  v_mul_u32_u24 v10, 6144, v10
  v_and_b32 v11, 7, v0
  v_lshlrev_b32 v11, 4, v11
  v_add_u32 v2, v10, v11
  s_mul_i32 s67, s64, 786432
  s_lshl_b32 s8, s65, 7
  s_add_u32 s67, s67, s8
  s_waitcnt lgkmcnt(0)
  s_mul_i32 s7, s6, 1664525
  s_add_u32 s7, s7, 1013904223
  s_and_b32 s7, s7, 0xbfffbfff
  s_cmp_lg_u32 s64, 0
  s_cbranch_scc1 L_qd_45
  v_lshrrev_b32 v8, 4, v0
  v_lshlrev_b32 v8, 9, v8
  v_and_b32 v9, 15, v0
  v_lshlrev_b32 v9, 4, v9
  v_add_u32 v8, v8, v9
  s_and_b32 s8, s5, 1
  s_lshl_b32 s8, s8, 8
  s_lshl_b32 s66, s4, 12
  s_add_u32 s66, s66, s8
  s_add_u32 s66, s66, 0x8000
  v_lshlrev_b32 v9, 3, v0
  v_mov_b32 v10, 1024
  buffer_load_dwordx4 v[32:35], v8, s[44:47], s66 offen offset:0 sc1
  buffer_load_dwordx4 v[36:39], v8, s[44:47], s66 offen offset:2048 sc1
  buffer_load_dwordx4 v[40:43], v8, s[44:47], s66 offen offset:0 sc1
  buffer_load_dwordx4 v[44:47], v8, s[44:47], s66 offen offset:2048 sc1
  buffer_load_dwordx4 v[48:51], v8, s[44:47], s66 offen offset:0 sc1
  buffer_load_dwordx4 v[52:55], v8, s[44:47], s66 offen offset:2048 sc1
  buffer_load_dwordx4 v[56:59], v8, s[44:47], s66 offen offset:0 sc1
  buffer_load_dwordx4 v[60:63], v8, s[44:47], s66 offen offset:2048 sc1
L_pp_46:
  s_waitcnt vmcnt(6)
  v_xor_b32 v12, s7, v35
  v_xor_b32 v13, s7, v39
  v_or_b32 v12, v12, v13
  v_cmp_ne_u32 vcc, 0, v12
  s_cbranch_vccz L_ppd_48
  buffer_load_dwordx4 v[32:35], v8, s[44:47], s66 offen offset:0 sc1
  buffer_load_dwordx4 v[36:39], v8, s[44:47], s66 offen offset:2048 sc1
  s_waitcnt vmcnt(6)
  v_xor_b32 v12, s7, v43
  v_xor_b32 v13, s7, v47
  v_or_b32 v12, v12, v13
  v_cmp_ne_u32 vcc, 0, v12
  s_cbranch_vccz L_ppd_49
  buffer_load_dwordx4 v[40:43], v8, s[44:47], s66 offen offset:0 sc1
  buffer_load_dwordx4 v[44:47], v8, s[44:47], s66 offen offset:2048 sc1
  s_waitcnt vmcnt(6)
  v_xor_b32 v12, s7, v51
  v_xor_b32 v13, s7, v55
  v_or_b32 v12, v12, v13
  v_cmp_ne_u32 vcc, 0, v12
  s_cbranch_vccz L_ppd_50
  buffer_load_dwordx4 v[48:51], v8, s[44:47], s66 offen offset:0 sc1
  buffer_load_dwordx4 v[52:55], v8, s[44:47], s66 offen offset:2048 sc1
  s_waitcnt vmcnt(6)
  v_xor_b32 v12, s7, v59
  v_xor_b32 v13, s7, v63
  v_or_b32 v12, v12, v13
  v_cmp_ne_u32 vcc, 0, v12
  s_cbranch_vccz L_ppd_51
  buffer_load_dwordx4 v[56:59], v8, s[44:47], s66 offen offset:0 sc1
  buffer_load_dwordx4 v[60:63], v8, s[44:47], s66 offen offset:2048 sc1
  s_sub_u32 s84, s84, 1
  s_cbranch_scc0 L_pp_46
  s_mov_b32 s84, 0
L_ppd_48:
  ds_write_b64 v9, v[32:33] offset:0
  ds_write_b64 v9, v[36:37] offset:512
  v_or_b32 v11, v34, v38
  s_branch L_ppf_47
L_ppd_49:
  ds_write_b64 v9, v[40:41] offset:0
  ds_write_b64 v9, v[44:45] offset:512
  v_or_b32 v11, v42, v46
  s_branch L_ppf_47
L_ppd_50:
  ds_write_b64 v9, v[48:49] offset:0
  ds_write_b64 v9, v[52:53] offset:512
  v_or_b32 v11, v50, v54
  s_branch L_ppf_47
L_ppd_51:
  ds_write_b64 v9, v[56:57] offset:0
  ds_write_b64 v9, v[60:61] offset:512
  v_or_b32 v11, v58, v62
L_ppf_47:
  v_cmp_ne_u32 vcc, 0, v11
  s_cmp_lg_u64 vcc, 0
  s_cselect_b32 s9, 2, 1
  v_mov_b32 v11, s9
  s_mov_b64 exec, 1
  ds_write_b32 v10, v11
  s_mov_b64 exec, -1
L_qd_45:
  v_mov_b32 v9, 1024
L_lw_52:
  ds_read_b32 v8, v9
  s_waitcnt lgkmcnt(0)
  v_cmp_ne_u32 vcc, 0, v8
  s_cbranch_vccnz L_lwd_53
  s_sub_u32 s84, s84, 1
  s_cbranch_scc0 L_lw_52
  s_mov_b32 s84, 0
L_lwd_53:
  buffer_load_dwordx4 v[64:67], v2, s[48:51], s67 offen nt
  s_add_u32 s68, s67, 6144
  buffer_load_dwordx4 v[68:71], v2, s[48:51], s68 offen nt
  s_add_u32 s68, s67, 12288
  buffer_load_dwordx4 v[72:75], v2, s[48:51], s68 offen nt
  s_add_u32 s68, s67, 18432
  buffer_load_dwordx4 v[76:79], v2, s[48:51], s68 offen nt
  s_add_u32 s68, s67, 24576
  buffer_load_dwordx4 v[80:83], v2, s[48:51], s68 offen nt
  s_add_u32 s68, s67, 30720
  buffer_load_dwordx4 v[84:87], v2, s[48:51], s68 offen nt
  s_add_u32 s68, s67, 36864
  buffer_load_dwordx4 v[88:91], v2, s[48:51], s68 offen nt
  s_add_u32 s68, s67, 43008
  buffer_load_dwordx4 v[92:95], v2, s[48:51], s68 offen nt
  s_add_u32 s68, s67, 393216
  buffer_load_dwordx4 v[96:99], v2, s[48:51], s68 offen nt
  s_add_u32 s68, s67, 399360
  buffer_load_dwordx4 v[100:103], v2, s[48:51], s68 offen nt
  s_add_u32 s68, s67, 405504
  buffer_load_dwordx4 v[104:107], v2, s[48:51], s68 offen nt
  s_add_u32 s68, s67, 411648
  buffer_load_dwordx4 v[108:111], v2, s[48:51], s68 offen nt
  s_add_u32 s68, s67, 417792
  buffer_load_dwordx4 v[112:115], v2, s[48:51], s68 offen nt
  s_add_u32 s68, s67, 423936
  buffer_load_dwordx4 v[116:119], v2, s[48:51], s68 offen nt
  s_add_u32 s68, s67, 430080
  buffer_load_dwordx4 v[120:123], v2, s[48:51], s68 offen nt
  s_add_u32 s68, s67, 436224
  buffer_load_dwordx4 v[124:127], v2, s[48:51], s68 offen nt
  v_and_b32 v200, 31, v0
  v_lshlrev_b32 v200, 4, v200
  v_add_u32 v201, 13312, v200
  s_lshl_b32 s66, s65, 9
  s_add_u32 s66, s66, 0x1000
  s_waitcnt vmcnt(16)
  v_lshlrev_b32 v8, 16, v24
  v_and_b32 v9, s82, v24
  v_lshlrev_b32 v10, 16, v25
  v_and_b32 v11, s82, v25
  v_mul_f32 v16, s85, v8
  v_mul_f32 v17, s85, v9
  v_mul_f32 v18, s85, v10
  v_mul_f32 v19, s85, v11
  v_exp_f32 v16, -v16
  v_exp_f32 v17, -v17
  v_exp_f32 v18, -v18
  v_exp_f32 v19, -v19
  v_add_f32 v16, 1.0, v16
  v_add_f32 v17, 1.0, v17
  v_add_f32 v18, 1.0, v18
  v_add_f32 v19, 1.0, v19
  v_rcp_f32 v16, v16
  v_rcp_f32 v17, v17
  v_rcp_f32 v18, v18
  v_rcp_f32 v19, v19
  v_mul_f32 v8, v8, v16
  v_mul_f32 v9, v9, v17
  v_mul_f32 v10, v10, v18
  v_mul_f32 v11, v11, v19
  v_cvt_pk_bf16_f32 v12, v8, v9
  v_cvt_pk_bf16_f32 v13, v10, v11
  ds_write_b64 v3, v[12:13]
  s_waitcnt vmcnt(8)
  v_perm_b32 v128, v68, v64, s80
  v_perm_b32 v132, v68, v64, s81
  v_perm_b32 v129, v76, v72, s80
  v_perm_b32 v133, v76, v72, s81
  v_perm_b32 v130, v84, v80, s80
  v_perm_b32 v134, v84, v80, s81
  v_perm_b32 v131, v92, v88, s80
  v_perm_b32 v135, v92, v88, s81
  v_perm_b32 v136, v69, v65, s80
  v_perm_b32 v140, v69, v65, s81
  v_perm_b32 v137, v77, v73, s80
  v_perm_b32 v141, v77, v73, s81
  v_perm_b32 v138, v85, v81, s80
  v_perm_b32 v142, v85, v81, s81
  v_perm_b32 v139, v93, v89, s80
  v_perm_b32 v143, v93, v89, s81
  v_perm_b32 v144, v70, v66, s80
  v_perm_b32 v148, v70, v66, s81
  v_perm_b32 v145, v78, v74, s80
  v_perm_b32 v149, v78, v74, s81
  v_perm_b32 v146, v86, v82, s80
  v_perm_b32 v150, v86, v82, s81
  v_perm_b32 v147, v94, v90, s80
  v_perm_b32 v151, v94, v90, s81
  v_perm_b32 v152, v71, v67, s80
  v_perm_b32 v156, v71, v67, s81
  v_perm_b32 v153, v79, v75, s80
  v_perm_b32 v157, v79, v75, s81
  v_perm_b32 v154, v87, v83, s80
  v_perm_b32 v158, v87, v83, s81
  v_perm_b32 v155, v95, v91, s80
  v_perm_b32 v159, v95, v91, s81
  s_waitcnt vmcnt(0)
  v_perm_b32 v160, v100, v96, s80
  v_perm_b32 v164, v100, v96, s81
  v_perm_b32 v161, v108, v104, s80
  v_perm_b32 v165, v108, v104, s81
  v_perm_b32 v162, v116, v112, s80
  v_perm_b32 v166, v116, v112, s81
  v_perm_b32 v163, v124, v120, s80
  v_perm_b32 v167, v124, v120, s81
  v_perm_b32 v168, v101, v97, s80
  v_perm_b32 v172, v101, v97, s81
  v_perm_b32 v169, v109, v105, s80
  v_perm_b32 v173, v109, v105, s81
  v_perm_b32 v170, v117, v113, s80
  v_perm_b32 v174, v117, v113, s81
  v_perm_b32 v171, v125, v121, s80
  v_perm_b32 v175, v125, v121, s81
  v_perm_b32 v176, v102, v98, s80
  v_perm_b32 v180, v102, v98, s81
  v_perm_b32 v177, v110, v106, s80
  v_perm_b32 v181, v110, v106, s81
  v_perm_b32 v178, v118, v114, s80
  v_perm_b32 v182, v118, v114, s81
  v_perm_b32 v179, v126, v122, s80
  v_perm_b32 v183, v126, v122, s81
  v_perm_b32 v184, v103, v99, s80
  v_perm_b32 v188, v103, v99, s81
  v_perm_b32 v185, v111, v107, s80
  v_perm_b32 v189, v111, v107, s81
  v_perm_b32 v186, v119, v115, s80
  v_perm_b32 v190, v119, v115, s81
  v_perm_b32 v187, v127, v123, s80
  v_perm_b32 v191, v127, v123, s81
  s_waitcnt lgkmcnt(0)
  ds_read_b128 v[8:11], v4 offset:0
  ds_read_b128 v[12:15], v4 offset:128
  s_waitcnt lgkmcnt(1)
  v_mfma_f32_16x16x32_bf16 v[32:35], v[8:11], v[128:131], 0
  v_mfma_f32_16x16x32_bf16 v[36:39], v[8:11], v[132:135], 0
  v_mfma_f32_16x16x32_bf16 v[40:43], v[8:11], v[136:139], 0
  v_mfma_f32_16x16x32_bf16 v[44:47], v[8:11], v[140:143], 0
  v_mfma_f32_16x16x32_bf16 v[48:51], v[8:11], v[144:147], 0
  v_mfma_f32_16x16x32_bf16 v[52:55], v[8:11], v[148:151], 0
  v_mfma_f32_16x16x32_bf16 v[56:59], v[8:11], v[152:155], 0
  v_mfma_f32_16x16x32_bf16 v[60:63], v[8:11], v[156:159], 0
  s_waitcnt lgkmcnt(0)
  v_mfma_f32_16x16x32_bf16 v[32:35], v[12:15], v[160:163], v[32:35]
  v_mfma_f32_16x16x32_bf16 v[36:39], v[12:15], v[164:167], v[36:39]
  v_mfma_f32_16x16x32_bf16 v[40:43], v[12:15], v[168:171], v[40:43]
  v_mfma_f32_16x16x32_bf16 v[44:47], v[12:15], v[172:175], v[44:47]
  v_mfma_f32_16x16x32_bf16 v[48:51], v[12:15], v[176:179], v[48:51]
  v_mfma_f32_16x16x32_bf16 v[52:55], v[12:15], v[180:183], v[52:55]
  v_mfma_f32_16x16x32_bf16 v[56:59], v[12:15], v[184:187], v[56:59]
  v_mfma_f32_16x16x32_bf16 v[60:63], v[12:15], v[188:191], v[60:63]
  s_nop 0
  v_add_f32_dpp v16, v34, v32 row_shl:8 row_mask:0xf bank_mask:0xf
  v_add_f32_dpp v24, v35, v33 row_shl:8 row_mask:0xf bank_mask:0xf
  v_add_f32_dpp v17, v38, v36 row_shl:8 row_mask:0xf bank_mask:0xf
  v_add_f32_dpp v25, v39, v37 row_shl:8 row_mask:0xf bank_mask:0xf
  v_add_f32_dpp v18, v42, v40 row_shl:8 row_mask:0xf bank_mask:0xf
  v_add_f32_dpp v26, v43, v41 row_shl:8 row_mask:0xf bank_mask:0xf
  v_add_f32_dpp v19, v46, v44 row_shl:8 row_mask:0xf bank_mask:0xf
  v_add_f32_dpp v27, v47, v45 row_shl:8 row_mask:0xf bank_mask:0xf
  v_add_f32_dpp v20, v50, v48 row_shl:8 row_mask:0xf bank_mask:0xf
  v_add_f32_dpp v28, v51, v49 row_shl:8 row_mask:0xf bank_mask:0xf
  v_add_f32_dpp v21, v54, v52 row_shl:8 row_mask:0xf bank_mask:0xf
  v_add_f32_dpp v29, v55, v53 row_shl:8 row_mask:0xf bank_mask:0xf
  v_add_f32_dpp v22, v58, v56 row_shl:8 row_mask:0xf bank_mask:0xf
  v_add_f32_dpp v30, v59, v57 row_shl:8 row_mask:0xf bank_mask:0xf
  v_add_f32_dpp v23, v62, v60 row_shl:8 row_mask:0xf bank_mask:0xf
  v_add_f32_dpp v31, v63, v61 row_shl:8 row_mask:0xf bank_mask:0xf
  s_mov_b64 exec, 0xff
  ds_write_b128 v6, v[16:19]
  ds_write_b128 v6, v[20:23] offset:16
  ds_write_b128 v6, v[24:27] offset:256
  ds_write_b128 v6, v[28:31] offset:272
  s_mov_b64 exec, -1
  s_lshl_b32 s8, s64, 2
  s_add_u32 s8, s8, 1072
  v_mov_b32 v8, s8
  v_mov_b32 v9, 1
  s_mov_b64 s[10:11], exec
  s_mov_b64 exec, 1
  ds_write_b32 v8, v9
  s_mov_b64 exec, s[10:11]
  s_cmp_lg_u32 s64, 0
  s_cbranch_scc1 L_tail
  v_mov_b32 v18, 0
  v_mov_b32 v19, s7
  v_mov_b32 v12, 1072
L_lw_54:
  ds_read_b128 v[8:11], v12
  ds_read_b128 v[32:35], v201 offset:0
  ds_read_b128 v[36:39], v201 offset:512
  ds_read_b128 v[40:43], v201 offset:1024
  ds_read_b128 v[44:47], v201 offset:1536
  s_waitcnt lgkmcnt(0)
  v_min3_u32 v8, v8, v9, v10
  v_min_u32 v8, v8, v11
  v_cmp_ne_u32 vcc, 0, v8
  s_cbranch_vccnz L_lwd_55
  s_sub_u32 s84, s84, 1
  s_cbranch_scc0 L_lw_54
  s_mov_b32 s84, 0
L_lwd_55:
  v_add_f32 v32, v32, v36
  v_add_f32 v40, v40, v44
  v_add_f32 v33, v33, v37
  v_add_f32 v41, v41, v45
  v_add_f32 v34, v34, v38
  v_add_f32 v42, v42, v46
  v_add_f32 v35, v35, v39
  v_add_f32 v43, v43, v47
  v_add_f32 v32, v32, v40
  v_add_f32 v33, v33, v41
  v_add_f32 v34, v34, v42
  v_add_f32 v35, v35, v43
  v_cvt_pk_bf16_f32 v16, v32, v33
  v_cvt_pk_bf16_f32 v17, v34, v35
  s_mov_b32 exec_hi, 0
  buffer_store_dwordx4 v[16:19], v200, s[44:47], s66 offen sc1
  s_mov_b32 exec_hi, -1
  s_branch L_tdone
L_wq:
  s_mov_b32 s56, s16
  s_mov_b32 s57, s17
  s_mov_b32 s58, 0x800
  s_mov_b32 s59, 0x20000
  s_mov_b32 s48, s22
  s_mov_b32 s49, s23
  s_mov_b32 s50, 0x400000
  s_mov_b32 s51, 0x20000
  v_lshrrev_b32 v8, 5, v0
  v_and_b32 v9, 31, v0
  v_lshlrev_b32 v10, 10, v8
  v_lshlrev_b32 v11, 3, v9
  s_lshl_b32 s8, s64, 8
  v_add3_u32 v12, v10, v11, s8
  v_lshlrev_b32 v11, 5, v9
  v_add_u32 v13, v10, v11
  buffer_load_dwordx2 v[14:15], v12, s[56:59], 0 offen
  buffer_load_dwordx4 v[16:19], v13, s[56:59], 0 offen
  buffer_load_dwordx4 v[20:23], v13, s[56:59], 0 offen offset:16
  v_bfe_u32 v10, v0, 3, 1
  v_lshlrev_b32 v10, 5, v10
  v_lshrrev_b32 v11, 4, v0
  v_lshlrev_b32 v11, 3, v11
  v_add_u32 v10, v10, v11
  v_mul_u32_u24 v10, 8192, v10
  v_and_b32 v11, 7, v0
  v_lshlrev_b32 v11, 4, v11
  v_add_u32 v2, v10, v11
  s_sub_u32 s69, s5, 4
  s_mul_i32 s65, s64, 1048576
  s_lshl_b32 s8, s4, 10
  s_lshl_b32 s9, s69, 7
  s_add_u32 s65, s65, s8
  s_add_u32 s65, s65, s9
  buffer_load_dwordx4 v[64:67], v2, s[48:51], s65 offen nt
  s_add_u32 s66, s65, 8192
  buffer_load_dwordx4 v[68:71], v2, s[48:51], s66 offen nt
  s_add_u32 s66, s65, 16384
  buffer_load_dwordx4 v[72:75], v2, s[48:51], s66 offen nt
  s_add_u32 s66, s65, 24576
  buffer_load_dwordx4 v[76:79], v2, s[48:51], s66 offen nt
  s_add_u32 s66, s65, 32768
  buffer_load_dwordx4 v[80:83], v2, s[48:51], s66 offen nt
  s_add_u32 s66, s65, 40960
  buffer_load_dwordx4 v[84:87], v2, s[48:51], s66 offen nt
  s_add_u32 s66, s65, 49152
  buffer_load_dwordx4 v[88:91], v2, s[48:51], s66 offen nt
  s_add_u32 s66, s65, 57344
  buffer_load_dwordx4 v[92:95], v2, s[48:51], s66 offen nt
  s_add_u32 s66, s65, 524288
  buffer_load_dwordx4 v[96:99], v2, s[48:51], s66 offen nt
  s_add_u32 s66, s65, 532480
  buffer_load_dwordx4 v[100:103], v2, s[48:51], s66 offen nt
  s_add_u32 s66, s65, 540672
  buffer_load_dwordx4 v[104:107], v2, s[48:51], s66 offen nt
  s_add_u32 s66, s65, 548864
  buffer_load_dwordx4 v[108:111], v2, s[48:51], s66 offen nt
  s_add_u32 s66, s65, 557056
  buffer_load_dwordx4 v[112:115], v2, s[48:51], s66 offen nt
  s_add_u32 s66, s65, 565248
  buffer_load_dwordx4 v[116:119], v2, s[48:51], s66 offen nt
  s_add_u32 s66, s65, 573440
  buffer_load_dwordx4 v[120:123], v2, s[48:51], s66 offen nt
  s_add_u32 s66, s65, 581632
  buffer_load_dwordx4 v[124:127], v2, s[48:51], s66 offen nt
  s_lshl_b32 s8, s64, 2
  s_add_u32 s8, s8, 1136
  v_mov_b32 v8, s8
  v_mov_b32 v9, 1
  s_mov_b64 s[10:11], exec
  s_mov_b64 exec, 1
  ds_write_b32 v8, v9
  s_mov_b64 exec, s[10:11]
  s_waitcnt vmcnt(16)
  v_lshlrev_b32 v32, 16, v16
  v_and_b32 v33, s82, v16
  v_lshlrev_b32 v34, 16, v17
  v_and_b32 v35, s82, v17
  v_lshlrev_b32 v36, 16, v18
  v_and_b32 v37, s82, v18
  v_lshlrev_b32 v38, 16, v19
  v_and_b32 v39, s82, v19
  v_lshlrev_b32 v40, 16, v20
  v_and_b32 v41, s82, v20
  v_lshlrev_b32 v42, 16, v21
  v_and_b32 v43, s82, v21
  v_lshlrev_b32 v44, 16, v22
  v_and_b32 v45, s82, v22
  v_lshlrev_b32 v46, 16, v23
  v_and_b32 v47, s82, v23
  v_add_f32 v48, v32, v33
  v_add_f32 v48, v48, v34
  v_add_f32 v48, v48, v35
  v_add_f32 v48, v48, v36
  v_add_f32 v48, v48, v37
  v_add_f32 v48, v48, v38
  v_add_f32 v48, v48, v39
  v_add_f32 v48, v48, v40
  v_add_f32 v48, v48, v41
  v_add_f32 v48, v48, v42
  v_add_f32 v48, v48, v43
  v_add_f32 v48, v48, v44
  v_add_f32 v48, v48, v45
  v_add_f32 v48, v48, v46
  v_add_f32 v48, v48, v47
  s_nop 1
  v_add_f32_dpp v48, v48, v48 row_ror:8 row_mask:0xf bank_mask:0xf
  s_nop 1
  v_add_f32_dpp v48, v48, v48 row_ror:4 row_mask:0xf bank_mask:0xf
  s_nop 1
  v_add_f32_dpp v48, v48, v48 row_ror:2 row_mask:0xf bank_mask:0xf
  s_nop 1
  v_add_f32_dpp v48, v48, v48 row_ror:1 row_mask:0xf bank_mask:0xf
  v_mov_b32 v49, v48
  s_nop 1
  v_permlane16_swap_b32 v48, v49
  v_add_f32 v48, v48, v49
  v_mul_f32 v48, 0x3b000000, v48
  v_sub_f32 v32, v32, v48
  v_sub_f32 v33, v33, v48
  v_sub_f32 v34, v34, v48
  v_sub_f32 v35, v35, v48
  v_sub_f32 v36, v36, v48
  v_sub_f32 v37, v37, v48
  v_sub_f32 v38, v38, v48
  v_sub_f32 v39, v39, v48
  v_sub_f32 v40, v40, v48
  v_sub_f32 v41, v41, v48
  v_sub_f32 v42, v42, v48
  v_sub_f32 v43, v43, v48
  v_sub_f32 v44, v44, v48
  v_sub_f32 v45, v45, v48
  v_sub_f32 v46, v46, v48
  v_sub_f32 v47, v47, v48
  v_mul_f32 v50, v32, v32
  v_fmac_f32 v50, v33, v33
  v_fmac_f32 v50, v34, v34
  v_fmac_f32 v50, v35, v35
  v_fmac_f32 v50, v36, v36
  v_fmac_f32 v50, v37, v37
  v_fmac_f32 v50, v38, v38
  v_fmac_f32 v50, v39, v39
  v_fmac_f32 v50, v40, v40
  v_fmac_f32 v50, v41, v41
  v_fmac_f32 v50, v42, v42
  v_fmac_f32 v50, v43, v43
  v_fmac_f32 v50, v44, v44
  v_fmac_f32 v50, v45, v45
  v_fmac_f32 v50, v46, v46
  v_fmac_f32 v50, v47, v47
  s_nop 1
  v_add_f32_dpp v50, v50, v50 row_ror:8 row_mask:0xf bank_mask:0xf
  s_nop 1
  v_add_f32_dpp v50, v50, v50 row_ror:4 row_mask:0xf bank_mask:0xf
  s_nop 1
  v_add_f32_dpp v50, v50, v50 row_ror:2 row_mask:0xf bank_mask:0xf
  s_nop 1
  v_add_f32_dpp v50, v50, v50 row_ror:1 row_mask:0xf bank_mask:0xf
  v_mov_b32 v49, v50
  s_nop 1
  v_permlane16_swap_b32 v50, v49
  v_add_f32 v50, v50, v49
  v_mul_f32 v50, 0x3b000000, v50
  v_cvt_pk_bf16_f32 v49, v48, v48
  v_lshlrev_b32 v48, 16, v49
  v_cvt_pk_bf16_f32 v49, v50, v50
  v_lshlrev_b32 v50, 16, v49
  v_add_f32 v50, 0x3727c5ac, v50
  v_cvt_pk_bf16_f32 v49, v50, v50
  v_lshlrev_b32 v50, 16, v49
  v_sqrt_f32 v50, v50
  s_nop 0
  v_cvt_pk_bf16_f32 v49, v50, v50
  v_lshlrev_b32 v50, 16, v49
  v_rcp_f32 v50, v50
  v_lshlrev_b32 v8, 16, v14
  v_and_b32 v9, s82, v14
  v_lshlrev_b32 v10, 16, v15
  v_and_b32 v11, s82, v15
  v_sub_f32 v8, v8, v48
  v_sub_f32 v9, v9, v48
  v_sub_f32 v10, v10, v48
  v_sub_f32 v11, v11, v48
  v_cvt_pk_bf16_f32 v12, v8, v9
  v_cvt_pk_bf16_f32 v13, v10, v11
  v_lshlrev_b32 v8, 16, v12
  v_and_b32 v9, s82, v12
  v_lshlrev_b32 v10, 16, v13
  v_and_b32 v11, s82, v13
  v_mul_f32 v8, v8, v50
  v_mul_f32 v9, v9, v50
  v_mul_f32 v10, v10, v50
  v_mul_f32 v11, v11, v50
  v_cvt_pk_bf16_f32 v12, v8, v9
  v_cvt_pk_bf16_f32 v13, v10, v11
  v_lshlrev_b32 v8, 16, v12
  v_and_b32 v9, s82, v12
  v_lshlrev_b32 v10, 16, v13
  v_and_b32 v11, s82, v13
  s_lshl_b32 s66, s64, 10
  s_add_u32 s66, s66, 0x1000
  s_add_u32 s67, s66, 4096
  v_and_b32 v203, 31, v0
  v_lshlrev_b32 v203, 4, v203
  s_lshl_b32 s91, s4, 9
  s_add_u32 s91, s91, 0xc1000
  v_and_b32 v200, 31, v0
  v_lshlrev_b32 v200, 4, v200
  v_add_u32 v201, 13312, v200
  s_lshl_b32 s68, s4, 12
  s_lshl_b32 s8, s69, 9
  s_add_u32 s68, s68, s8
  s_add_u32 s68, s68, 0x8000
  s_waitcnt lgkmcnt(0)
  s_mul_i32 s7, s6, 1664525
  s_add_u32 s7, s7, 1013904223
  s_and_b32 s7, s7, 0xbfffbfff
  s_waitcnt vmcnt(8)
  v_perm_b32 v128, v68, v64, s80
  v_perm_b32 v132, v68, v64, s81
  v_perm_b32 v129, v76, v72, s80
  v_perm_b32 v133, v76, v72, s81
  v_perm_b32 v130, v84, v80, s80
  v_perm_b32 v134, v84, v80, s81
  v_perm_b32 v131, v92, v88, s80
  v_perm_b32 v135, v92, v88, s81
  v_perm_b32 v136, v69, v65, s80
  v_perm_b32 v140, v69, v65, s81
  v_perm_b32 v137, v77, v73, s80
  v_perm_b32 v141, v77, v73, s81
  v_perm_b32 v138, v85, v81, s80
  v_perm_b32 v142, v85, v81, s81
  v_perm_b32 v139, v93, v89, s80
  v_perm_b32 v143, v93, v89, s81
  v_perm_b32 v144, v70, v66, s80
  v_perm_b32 v148, v70, v66, s81
  v_perm_b32 v145, v78, v74, s80
  v_perm_b32 v149, v78, v74, s81
  v_perm_b32 v146, v86, v82, s80
  v_perm_b32 v150, v86, v82, s81
  v_perm_b32 v147, v94, v90, s80
  v_perm_b32 v151, v94, v90, s81
  v_perm_b32 v152, v71, v67, s80
  v_perm_b32 v156, v71, v67, s81
  v_perm_b32 v153, v79, v75, s80
  v_perm_b32 v157, v79, v75, s81
  v_perm_b32 v154, v87, v83, s80
  v_perm_b32 v158, v87, v83, s81
  v_perm_b32 v155, v95, v91, s80
  v_perm_b32 v159, v95, v91, s81
  s_waitcnt vmcnt(0)
  v_perm_b32 v160, v100, v96, s80
  v_perm_b32 v164, v100, v96, s81
  v_perm_b32 v161, v108, v104, s80
  v_perm_b32 v165, v108, v104, s81
  v_perm_b32 v162, v116, v112, s80
  v_perm_b32 v166, v116, v112, s81
  v_perm_b32 v163, v124, v120, s80
  v_perm_b32 v167, v124, v120, s81
  v_perm_b32 v168, v101, v97, s80
  v_perm_b32 v172, v101, v97, s81
  v_perm_b32 v169, v109, v105, s80
  v_perm_b32 v173, v109, v105, s81
  v_perm_b32 v170, v117, v113, s80
  v_perm_b32 v174, v117, v113, s81
  v_perm_b32 v171, v125, v121, s80
  v_perm_b32 v175, v125, v121, s81
  v_perm_b32 v176, v102, v98, s80
  v_perm_b32 v180, v102, v98, s81
  v_perm_b32 v177, v110, v106, s80
  v_perm_b32 v181, v110, v106, s81
  v_perm_b32 v178, v118, v114, s80
  v_perm_b32 v182, v118, v114, s81
  v_perm_b32 v179, v126, v122, s80
  v_perm_b32 v183, v126, v122, s81
  v_perm_b32 v184, v103, v99, s80
  v_perm_b32 v188, v103, v99, s81
  v_perm_b32 v185, v111, v107, s80
  v_perm_b32 v189, v111, v107, s81
  v_perm_b32 v186, v119, v115, s80
  v_perm_b32 v190, v119, v115, s81
  v_perm_b32 v187, v127, v123, s80
  v_perm_b32 v191, v127, v123, s81
L_poll_56:
  buffer_load_dwordx4 v[32:35], v203, s[44:47], s91 offen sc1
  buffer_load_dwordx4 v[20:23], v5, s[44:47], s66 offen offset:0 sc1
  buffer_load_dwordx4 v[24:27], v5, s[44:47], s67 offen offset:0 sc1
  s_waitcnt vmcnt(0)
  v_xor_b32 v12, s7, v23
  v_xor_b32 v13, s7, v27
  v_or_b32 v12, v12, v13
  v_cmp_ne_u32 vcc, 0, v12
  s_cbranch_vccz L_pdone_57
  s_sub_u32 s84, s84, 1
  s_cbranch_scc0 L_poll_56
  s_mov_b32 s84, 0
L_pdone_57:
  v_lshlrev_b32 v16, 16, v20
  v_and_b32 v17, s82, v20
  v_lshlrev_b32 v18, 16, v21
  v_and_b32 v19, s82, v21
  v_lshlrev_b32 v28, 16, v24
  v_and_b32 v29, s82, v24
  v_lshlrev_b32 v30, 16, v25
  v_and_b32 v31, s82, v25
  v_add_f32 v28, 1.0, v28
  v_add_f32 v29, 1.0, v29
  v_add_f32 v30, 1.0, v30
  v_add_f32 v31, 1.0, v31
  v_cvt_pk_bf16_f32 v12, v28, v29
  v_cvt_pk_bf16_f32 v13, v30, v31
  v_lshlrev_b32 v28, 16, v12
  v_and_b32 v29, s82, v12
  v_lshlrev_b32 v30, 16, v13
  v_and_b32 v31, s82, v13
  v_mul_f32 v8, v8, v28
  v_mul_f32 v9, v9, v29
  v_mul_f32 v10, v10, v30
  v_mul_f32 v11, v11, v31
  v_cvt_pk_bf16_f32 v12, v8, v9
  v_cvt_pk_bf16_f32 v13, v10, v11
  v_lshlrev_b32 v8, 16, v12
  v_and_b32 v9, s82, v12
  v_lshlrev_b32 v10, 16, v13
  v_and_b32 v11, s82, v13
  v_add_f32 v8, v8, v16
  v_add_f32 v9, v9, v17
  v_add_f32 v10, v10, v18
  v_add_f32 v11, v11, v19
  v_cvt_pk_bf16_f32 v12, v8, v9
  v_cvt_pk_bf16_f32 v13, v10, v11
  ds_write_b64 v3, v[12:13]
  v_xor_b32 v14, s7, v35
  v_xor_b32 v15, s90, v32
  v_or_b32 v14, v14, v15
  v_cmp_ne_u32 vcc, 0, v14
  s_cmp_eq_u64 vcc, 0
  s_cselect_b32 s83, 1, 0
  ds_read_b128 v[8:11], v4 offset:0
  ds_read_b128 v[12:15], v4 offset:128
  s_waitcnt lgkmcnt(1)
  v_mfma_f32_16x16x32_bf16 v[32:35], v[8:11], v[128:131], 0
  v_mfma_f32_16x16x32_bf16 v[36:39], v[8:11], v[132:135], 0
  v_mfma_f32_16x16x32_bf16 v[40:43], v[8:11], v[136:139], 0
  v_mfma_f32_16x16x32_bf16 v[44:47], v[8:11], v[140:143], 0
  v_mfma_f32_16x16x32_bf16 v[48:51], v[8:11], v[144:147], 0
  v_mfma_f32_16x16x32_bf16 v[52:55], v[8:11], v[148:151], 0
  v_mfma_f32_16x16x32_bf16 v[56:59], v[8:11], v[152:155], 0
  v_mfma_f32_16x16x32_bf16 v[60:63], v[8:11], v[156:159], 0
  s_waitcnt lgkmcnt(0)
  v_mfma_f32_16x16x32_bf16 v[32:35], v[12:15], v[160:163], v[32:35]
  v_mfma_f32_16x16x32_bf16 v[36:39], v[12:15], v[164:167], v[36:39]
  v_mfma_f32_16x16x32_bf16 v[40:43], v[12:15], v[168:171], v[40:43]
  v_mfma_f32_16x16x32_bf16 v[44:47], v[12:15], v[172:175], v[44:47]
  v_mfma_f32_16x16x32_bf16 v[48:51], v[12:15], v[176:179], v[48:51]
  v_mfma_f32_16x16x32_bf16 v[52:55], v[12:15], v[180:183], v[52:55]
  v_mfma_f32_16x16x32_bf16 v[56:59], v[12:15], v[184:187], v[56:59]
  v_mfma_f32_16x16x32_bf16 v[60:63], v[12:15], v[188:191], v[60:63]
  s_nop 0
  v_add_f32_dpp v16, v34, v32 row_shl:8 row_mask:0xf bank_mask:0xf
  v_add_f32_dpp v24, v35, v33 row_shl:8 row_mask:0xf bank_mask:0xf
  v_add_f32_dpp v17, v38, v36 row_shl:8 row_mask:0xf bank_mask:0xf
  v_add_f32_dpp v25, v39, v37 row_shl:8 row_mask:0xf bank_mask:0xf
  v_add_f32_dpp v18, v42, v40 row_shl:8 row_mask:0xf bank_mask:0xf
  v_add_f32_dpp v26, v43, v41 row_shl:8 row_mask:0xf bank_mask:0xf
  v_add_f32_dpp v19, v46, v44 row_shl:8 row_mask:0xf bank_mask:0xf
  v_add_f32_dpp v27, v47, v45 row_shl:8 row_mask:0xf bank_mask:0xf
  v_add_f32_dpp v20, v50, v48 row_shl:8 row_mask:0xf bank_mask:0xf
  v_add_f32_dpp v28, v51, v49 row_shl:8 row_mask:0xf bank_mask:0xf
  v_add_f32_dpp v21, v54, v52 row_shl:8 row_mask:0xf bank_mask:0xf
  v_add_f32_dpp v29, v55, v53 row_shl:8 row_mask:0xf bank_mask:0xf
  v_add_f32_dpp v22, v58, v56 row_shl:8 row_mask:0xf bank_mask:0xf
  v_add_f32_dpp v30, v59, v57 row_shl:8 row_mask:0xf bank_mask:0xf
  v_add_f32_dpp v23, v62, v60 row_shl:8 row_mask:0xf bank_mask:0xf
  v_add_f32_dpp v31, v63, v61 row_shl:8 row_mask:0xf bank_mask:0xf
  s_mov_b64 exec, 0xff
  ds_write_b128 v6, v[16:19]
  ds_write_b128 v6, v[20:23] offset:16
  ds_write_b128 v6, v[24:27] offset:256
  ds_write_b128 v6, v[28:31] offset:272
  s_mov_b64 exec, -1
  s_lshl_b32 s8, s64, 2
  s_add_u32 s8, s8, 1072
  v_mov_b32 v8, s8
  v_mov_b32 v9, 1
  s_mov_b64 s[10:11], exec
  s_mov_b64 exec, 1
  ds_write_b32 v8, v9
  s_mov_b64 exec, s[10:11]
  s_cmp_lg_u32 s64, 0
  s_cbranch_scc1 L_tail
  v_mov_b32 v18, s83
  v_mov_b32 v19, s7
  v_mov_b32 v12, 1072
L_lw_59:
  ds_read_b128 v[8:11], v12
  ds_read_b128 v[32:35], v201 offset:0
  ds_read_b128 v[36:39], v201 offset:512
  ds_read_b128 v[40:43], v201 offset:1024
  ds_read_b128 v[44:47], v201 offset:1536
  s_waitcnt lgkmcnt(0)
  v_min3_u32 v8, v8, v9, v10
  v_min_u32 v8, v8, v11
  v_cmp_ne_u32 vcc, 0, v8
  s_cbranch_vccnz L_lwd_60
  s_sub_u32 s84, s84, 1
  s_cbranch_scc0 L_lw_59
  s_mov_b32 s84, 0
L_lwd_60:
  v_add_f32 v32, v32, v36
  v_add_f32 v40, v40, v44
  v_add_f32 v33, v33, v37
  v_add_f32 v41, v41, v45
  v_add_f32 v34, v34, v38
  v_add_f32 v42, v42, v46
  v_add_f32 v35, v35, v39
  v_add_f32 v43, v43, v47
  v_add_f32 v32, v32, v40
  v_add_f32 v33, v33, v41
  v_add_f32 v34, v34, v42
  v_add_f32 v35, v35, v43
  v_cvt_pk_bf16_f32 v16, v32, v33
  v_cvt_pk_bf16_f32 v17, v34, v35
  s_mov_b32 exec_hi, 0
  s_cmp_eq_u32 s83, 0
  s_cbranch_scc1 L_slow_61
  buffer_store_dwordx4 v[16:19], v200, s[44:47], s68 offen
  s_branch L_sd_62
L_slow_61:
  buffer_store_dwordx4 v[16:19], v200, s[44:47], s68 offen sc1
L_sd_62:
  s_mov_b32 exec_hi, -1
  v_mov_b32 v8, 1168
  v_mov_b32 v9, 1
  s_mov_b64 s[10:11], exec
  s_mov_b64 exec, 1
  ds_write_b32 v8, v9
  s_mov_b64 exec, s[10:11]
  s_branch L_qpoll
L_wo:
  s_mov_b32 s48, s24
  s_mov_b32 s49, s25
  s_mov_b32 s50, 0x400000
  s_mov_b32 s51, 0x20000
  v_bfe_u32 v10, v0, 4, 1
  v_lshlrev_b32 v10, 6, v10
  v_bfe_u32 v11, v0, 3, 1
  v_lshlrev_b32 v11, 1, v11
  v_lshrrev_b32 v12, 5, v0
  v_add3_u32 v10, v10, v11, v12
  v_lshlrev_b32 v10, 10, v10
  v_and_b32 v11, 7, v0
  v_lshlrev_b32 v11, 4, v11
  v_add_u32 v2, v10, v11
  s_sub_u32 s65, s5, 12
  s_lshr_b32 s65, s65, 1
  s_and_b32 s69, s5, 1
  s_lshl_b32 s68, s4, 2
  s_add_u32 s68, s68, s65
  s_lshl_b32 s67, s68, 17
  s_lshl_b32 s8, s69, 9
  s_add_u32 s67, s67, s8
  s_lshl_b32 s8, s64, 7
  s_add_u32 s67, s67, s8
  buffer_load_dwordx4 v[64:67], v2, s[48:51], s67 offen nt
  s_add_u32 s70, s67, 8192
  buffer_load_dwordx4 v[68:71], v2, s[48:51], s70 offen nt
  s_add_u32 s70, s67, 16384
  buffer_load_dwordx4 v[72:75], v2, s[48:51], s70 offen nt
  s_add_u32 s70, s67, 24576
  buffer_load_dwordx4 v[76:79], v2, s[48:51], s70 offen nt
  s_waitcnt vmcnt(3)
  s_add_u32 s70, s67, 32768
  buffer_load_dwordx4 v[80:83], v2, s[48:51], s70 offen nt
  s_waitcnt vmcnt(3)
  s_add_u32 s70, s67, 40960
  buffer_load_dwordx4 v[84:87], v2, s[48:51], s70 offen nt
  s_waitcnt vmcnt(3)
  s_add_u32 s70, s67, 49152
  buffer_load_dwordx4 v[88:91], v2, s[48:51], s70 offen nt
  s_waitcnt vmcnt(3)
  s_add_u32 s70, s67, 57344
  buffer_load_dwordx4 v[92:95], v2, s[48:51], s70 offen nt
  s_waitcnt vmcnt(3)
  s_add_u32 s70, s67, 4096
  buffer_load_dwordx4 v[96:99], v2, s[48:51], s70 offen nt
  s_waitcnt vmcnt(3)
  s_add_u32 s70, s67, 12288
  buffer_load_dwordx4 v[100:103], v2, s[48:51], s70 offen nt
  s_waitcnt vmcnt(3)
  s_add_u32 s70, s67, 20480
  buffer_load_dwordx4 v[104:107], v2, s[48:51], s70 offen nt
  s_waitcnt vmcnt(3)
  s_add_u32 s70, s67, 28672
  buffer_load_dwordx4 v[108:111], v2, s[48:51], s70 offen nt
  s_waitcnt vmcnt(3)
  s_add_u32 s70, s67, 36864
  buffer_load_dwordx4 v[112:115], v2, s[48:51], s70 offen nt
  s_waitcnt vmcnt(3)
  s_add_u32 s70, s67, 45056
  buffer_load_dwordx4 v[116:119], v2, s[48:51], s70 offen nt
  s_waitcnt vmcnt(3)
  s_add_u32 s70, s67, 53248
  buffer_load_dwordx4 v[120:123], v2, s[48:51], s70 offen nt
  s_waitcnt vmcnt(3)
  s_add_u32 s70, s67, 61440
  buffer_load_dwordx4 v[124:127], v2, s[48:51], s70 offen nt
  s_waitcnt lgkmcnt(0)
  s_mul_i32 s7, s6, 1664525
  s_add_u32 s7, s7, 1013904223
  s_and_b32 s7, s7, 0xbfffbfff
  s_cmp_lg_u32 s64, 0
  s_cbranch_scc1 L_qd_63
  v_lshrrev_b32 v8, 4, v0
  v_lshlrev_b32 v8, 9, v8
  v_and_b32 v9, 15, v0
  v_lshlrev_b32 v9, 4, v9
  v_add_u32 v8, v8, v9
  s_and_b32 s8, s5, 1
  s_lshl_b32 s8, s8, 8
  s_lshl_b32 s66, s4, 12
  s_add_u32 s66, s66, s8
  s_add_u32 s66, s66, 0x8000
  v_lshlrev_b32 v9, 3, v0
  v_mov_b32 v10, 1024
  buffer_load_dwordx4 v[32:35], v8, s[44:47], s66 offen offset:0 sc1
  buffer_load_dwordx4 v[36:39], v8, s[44:47], s66 offen offset:2048 sc1
  buffer_load_dwordx4 v[40:43], v8, s[44:47], s66 offen offset:0 sc1
  buffer_load_dwordx4 v[44:47], v8, s[44:47], s66 offen offset:2048 sc1
  buffer_load_dwordx4 v[48:51], v8, s[44:47], s66 offen offset:0 sc1
  buffer_load_dwordx4 v[52:55], v8, s[44:47], s66 offen offset:2048 sc1
  buffer_load_dwordx4 v[56:59], v8, s[44:47], s66 offen offset:0 sc1
  buffer_load_dwordx4 v[60:63], v8, s[44:47], s66 offen offset:2048 sc1
L_pp_64:
  s_waitcnt vmcnt(6)
  v_xor_b32 v12, s7, v35
  v_xor_b32 v13, s7, v39
  v_or_b32 v12, v12, v13
  v_cmp_ne_u32 vcc, 0, v12
  s_cbranch_vccz L_ppd_66
  buffer_load_dwordx4 v[32:35], v8, s[44:47], s66 offen offset:0 sc1
  buffer_load_dwordx4 v[36:39], v8, s[44:47], s66 offen offset:2048 sc1
  s_waitcnt vmcnt(6)
  v_xor_b32 v12, s7, v43
  v_xor_b32 v13, s7, v47
  v_or_b32 v12, v12, v13
  v_cmp_ne_u32 vcc, 0, v12
  s_cbranch_vccz L_ppd_67
  buffer_load_dwordx4 v[40:43], v8, s[44:47], s66 offen offset:0 sc1
  buffer_load_dwordx4 v[44:47], v8, s[44:47], s66 offen offset:2048 sc1
  s_waitcnt vmcnt(6)
  v_xor_b32 v12, s7, v51
  v_xor_b32 v13, s7, v55
  v_or_b32 v12, v12, v13
  v_cmp_ne_u32 vcc, 0, v12
  s_cbranch_vccz L_ppd_68
  buffer_load_dwordx4 v[48:51], v8, s[44:47], s66 offen offset:0 sc1
  buffer_load_dwordx4 v[52:55], v8, s[44:47], s66 offen offset:2048 sc1
  s_waitcnt vmcnt(6)
  v_xor_b32 v12, s7, v59
  v_xor_b32 v13, s7, v63
  v_or_b32 v12, v12, v13
  v_cmp_ne_u32 vcc, 0, v12
  s_cbranch_vccz L_ppd_69
  buffer_load_dwordx4 v[56:59], v8, s[44:47], s66 offen offset:0 sc1
  buffer_load_dwordx4 v[60:63], v8, s[44:47], s66 offen offset:2048 sc1
  s_sub_u32 s84, s84, 1
  s_cbranch_scc0 L_pp_64
  s_mov_b32 s84, 0
L_ppd_66:
  ds_write_b64 v9, v[32:33] offset:0
  ds_write_b64 v9, v[36:37] offset:512
  v_or_b32 v11, v34, v38
  s_branch L_ppf_65
L_ppd_67:
  ds_write_b64 v9, v[40:41] offset:0
  ds_write_b64 v9, v[44:45] offset:512
  v_or_b32 v11, v42, v46
  s_branch L_ppf_65
L_ppd_68:
  ds_write_b64 v9, v[48:49] offset:0
  ds_write_b64 v9, v[52:53] offset:512
  v_or_b32 v11, v50, v54
  s_branch L_ppf_65
L_ppd_69:
  ds_write_b64 v9, v[56:57] offset:0
  ds_write_b64 v9, v[60:61] offset:512
  v_or_b32 v11, v58, v62
L_ppf_65:
  v_cmp_ne_u32 vcc, 0, v11
  s_cmp_lg_u64 vcc, 0
  s_cselect_b32 s9, 2, 1
  v_mov_b32 v11, s9
  s_mov_b64 exec, 1
  ds_write_b32 v10, v11
  s_mov_b64 exec, -1
L_qd_63:
  s_waitcnt vmcnt(8)
  v_perm_b32 v128, v68, v64, s80
  v_perm_b32 v132, v68, v64, s81
  v_perm_b32 v129, v76, v72, s80
  v_perm_b32 v133, v76, v72, s81
  v_perm_b32 v130, v84, v80, s80
  v_perm_b32 v134, v84, v80, s81
  v_perm_b32 v131, v92, v88, s80
  v_perm_b32 v135, v92, v88, s81
  v_perm_b32 v136, v69, v65, s80
  v_perm_b32 v140, v69, v65, s81
  v_perm_b32 v137, v77, v73, s80
  v_perm_b32 v141, v77, v73, s81
  v_perm_b32 v138, v85, v81, s80
  v_perm_b32 v142, v85, v81, s81
  v_perm_b32 v139, v93, v89, s80
  v_perm_b32 v143, v93, v89, s81
  v_perm_b32 v144, v70, v66, s80
  v_perm_b32 v148, v70, v66, s81
  v_perm_b32 v145, v78, v74, s80
  v_perm_b32 v149, v78, v74, s81
  v_perm_b32 v146, v86, v82, s80
  v_perm_b32 v150, v86, v82, s81
  v_perm_b32 v147, v94, v90, s80
  v_perm_b32 v151, v94, v90, s81
  v_perm_b32 v152, v71, v67, s80
  v_perm_b32 v156, v71, v67, s81
  v_perm_b32 v153, v79, v75, s80
  v_perm_b32 v157, v79, v75, s81
  v_perm_b32 v154, v87, v83, s80
  v_perm_b32 v158, v87, v83, s81
  v_perm_b32 v155, v95, v91, s80
  v_perm_b32 v159, v95, v91, s81
  s_waitcnt vmcnt(0)
  v_perm_b32 v160, v100, v96, s80
  v_perm_b32 v164, v100, v96, s81
  v_perm_b32 v161, v108, v104, s80
  v_perm_b32 v165, v108, v104, s81
  v_perm_b32 v162, v116, v112, s80
  v_perm_b32 v166, v116, v112, s81
  v_perm_b32 v163, v124, v120, s80
  v_perm_b32 v167, v124, v120, s81
  v_perm_b32 v168, v101, v97, s80
  v_perm_b32 v172, v101, v97, s81
  v_perm_b32 v169, v109, v105, s80
  v_perm_b32 v173, v109, v105, s81
  v_perm_b32 v170, v117, v113, s80
  v_perm_b32 v174, v117, v113, s81
  v_perm_b32 v171, v125, v121, s80
  v_perm_b32 v175, v125, v121, s81
  v_perm_b32 v176, v102, v98, s80
  v_perm_b32 v180, v102, v98, s81
  v_perm_b32 v177, v110, v106, s80
  v_perm_b32 v181, v110, v106, s81
  v_perm_b32 v178, v118, v114, s80
  v_perm_b32 v182, v118, v114, s81
  v_perm_b32 v179, v126, v122, s80
  v_perm_b32 v183, v126, v122, s81
  v_perm_b32 v184, v103, v99, s80
  v_perm_b32 v188, v103, v99, s81
  v_perm_b32 v185, v111, v107, s80
  v_perm_b32 v189, v111, v107, s81
  v_perm_b32 v186, v119, v115, s80
  v_perm_b32 v190, v119, v115, s81
  v_perm_b32 v187, v127, v123, s80
  v_perm_b32 v191, v127, v123, s81
  s_branch L_wo2
L_ffn:
  s_mul_i32 s65, s4, 7
  s_add_u32 s65, s65, s5
  s_sub_u32 s65, s65, 24
  s_mov_b32 s48, s28
  s_mov_b32 s49, s29
  s_mov_b32 s50, 0x1c0000
  s_mov_b32 s51, 0x20000
  s_mov_b32 s52, s30
  s_mov_b32 s53, s31
  s_mov_b32 s54, 0x1c0000
  s_mov_b32 s55, 0x20000
  s_mov_b32 s56, s32
  s_mov_b32 s57, s33
  s_mov_b32 s58, 0x1c0000
  s_mov_b32 s59, 0x20000
  v_bfe_u32 v10, v0, 3, 1
  v_lshlrev_b32 v10, 5, v10
  v_lshrrev_b32 v11, 4, v0
  v_lshlrev_b32 v11, 3, v11
  v_add_u32 v10, v10, v11
  v_mul_u32_u24 v10, 3584, v10
  v_and_b32 v11, 3, v0
  v_lshlrev_b32 v11, 4, v11
  v_add_u32 v2, v10, v11
  s_mul_i32 s67, s64, 458752
  s_lshl_b32 s8, s65, 6
  s_add_u32 s67, s67, s8
  v_lshrrev_b32 v10, 4, v0
  v_lshlrev_b32 v10, 13, v10
  v_and_b32 v11, 15, v0
  v_lshlrev_b32 v11, 4, v11
  v_add_u32 v1, v10, v11
  s_lshl_b32 s69, s65, 15
  s_lshl_b32 s8, s64, 8
  s_add_u32 s69, s69, s8
  s_mov_b32 s72, 0x0f0f0f0f
  s_mov_b32 s73, 0x0f0f0f0f
  s_mov_b32 s74, 0xf0f0f0f0
  s_mov_b32 s75, 0xf0f0f0f0
  s_waitcnt lgkmcnt(0)
  s_mul_i32 s7, s6, 1664525
  s_add_u32 s7, s7, 1013904223
  s_and_b32 s7, s7, 0xbfffbfff
  s_cmp_lg_u32 s64, 0
  s_cbranch_scc1 L_qd_70
  v_lshrrev_b32 v8, 4, v0
  v_lshlrev_b32 v8, 9, v8
  v_and_b32 v9, 15, v0
  v_lshlrev_b32 v9, 4, v9
  v_add_u32 v8, v8, v9
  s_and_b32 s8, s5, 1
  s_lshl_b32 s8, s8, 8
  s_lshl_b32 s66, s4, 12
  s_add_u32 s66, s66, s8
  s_add_u32 s66, s66, 0x8000
  v_lshlrev_b32 v9, 3, v0
  v_mov_b32 v10, 1024
  buffer_load_dwordx4 v[32:35], v8, s[44:47], s66 offen offset:0 sc1
  buffer_load_dwordx4 v[36:39], v8, s[44:47], s66 offen offset:2048 sc1
  buffer_load_dwordx4 v[40:43], v8, s[44:47], s66 offen offset:0 sc1
  buffer_load_dwordx4 v[44:47], v8, s[44:47], s66 offen offset:2048 sc1
  buffer_load_dwordx4 v[48:51], v8, s[44:47], s66 offen offset:0 sc1
  buffer_load_dwordx4 v[52:55], v8, s[44:47], s66 offen offset:2048 sc1
  buffer_load_dwordx4 v[56:59], v8, s[44:47], s66 offen offset:0 sc1
  buffer_load_dwordx4 v[60:63], v8, s[44:47], s66 offen offset:2048 sc1
L_pp_71:
  s_waitcnt vmcnt(6)
  v_xor_b32 v12, s7, v35
  v_xor_b32 v13, s7, v39
  v_or_b32 v12, v12, v13
  v_cmp_ne_u32 vcc, 0, v12
  s_cbranch_vccz L_ppd_73
  buffer_load_dwordx4 v[32:35], v8, s[44:47], s66 offen offset:0 sc1
  buffer_load_dwordx4 v[36:39], v8, s[44:47], s66 offen offset:2048 sc1
  s_waitcnt vmcnt(6)
  v_xor_b32 v12, s7, v43
  v_xor_b32 v13, s7, v47
  v_or_b32 v12, v12, v13
  v_cmp_ne_u32 vcc, 0, v12
  s_cbranch_vccz L_ppd_74
  buffer_load_dwordx4 v[40:43], v8, s[44:47], s66 offen offset:0 sc1
  buffer_load_dwordx4 v[44:47], v8, s[44:47], s66 offen offset:2048 sc1
  s_waitcnt vmcnt(6)
  v_xor_b32 v12, s7, v51
  v_xor_b32 v13, s7, v55
  v_or_b32 v12, v12, v13
  v_cmp_ne_u32 vcc, 0, v12
  s_cbranch_vccz L_ppd_75
  buffer_load_dwordx4 v[48:51], v8, s[44:47], s66 offen offset:0 sc1
  buffer_load_dwordx4 v[52:55], v8, s[44:47], s66 offen offset:2048 sc1
  s_waitcnt vmcnt(6)
  v_xor_b32 v12, s7, v59
  v_xor_b32 v13, s7, v63
  v_or_b32 v12, v12, v13
  v_cmp_ne_u32 vcc, 0, v12
  s_cbranch_vccz L_ppd_76
  buffer_load_dwordx4 v[56:59], v8, s[44:47], s66 offen offset:0 sc1
  buffer_load_dwordx4 v[60:63], v8, s[44:47], s66 offen offset:2048 sc1
  s_sub_u32 s84, s84, 1
  s_cbranch_scc0 L_pp_71
  s_mov_b32 s84, 0
L_ppd_73:
  ds_write_b64 v9, v[32:33] offset:0
  ds_write_b64 v9, v[36:37] offset:512
  v_or_b32 v11, v34, v38
  s_branch L_ppf_72
L_ppd_74:
  ds_write_b64 v9, v[40:41] offset:0
  ds_write_b64 v9, v[44:45] offset:512
  v_or_b32 v11, v42, v46
  s_branch L_ppf_72
L_ppd_75:
  ds_write_b64 v9, v[48:49] offset:0
  ds_write_b64 v9, v[52:53] offset:512
  v_or_b32 v11, v50, v54
  s_branch L_ppf_72
L_ppd_76:
  ds_write_b64 v9, v[56:57] offset:0
  ds_write_b64 v9, v[60:61] offset:512
  v_or_b32 v11, v58, v62
L_ppf_72:
  v_cmp_ne_u32 vcc, 0, v11
  s_cmp_lg_u64 vcc, 0
  s_cselect_b32 s9, 2, 1
  v_mov_b32 v11, s9
  s_mov_b64 exec, 1
  ds_write_b32 v10, v11
  s_mov_b64 exec, -1
L_qd_70:
  v_mov_b32 v12, 1216
L_lw_77:
  ds_read_b128 v[8:11], v12
  s_waitcnt lgkmcnt(0)
  v_min3_u32 v8, v8, v9, v10
  v_min_u32 v8, v8, v11
  v_cmp_ne_u32 vcc, 0, v8
  s_cbranch_vccnz L_lwd_78
  s_sub_u32 s84, s84, 1
  s_cbranch_scc0 L_lw_77
  s_mov_b32 s84, 0
L_lwd_78:
  s_mov_b64 exec, s[72:73]
  buffer_load_dwordx4 v[64:67], v2, s[48:51], s67 offen nt
  s_add_u32 s68, s67, 3584
  buffer_load_dwordx4 v[68:71], v2, s[48:51], s68 offen nt
  s_add_u32 s68, s67, 7168
  buffer_load_dwordx4 v[72:75], v2, s[48:51], s68 offen nt
  s_add_u32 s68, s67, 10752
  buffer_load_dwordx4 v[76:79], v2, s[48:51], s68 offen nt
  s_add_u32 s68, s67, 14336
  buffer_load_dwordx4 v[80:83], v2, s[48:51], s68 offen nt
  s_add_u32 s68, s67, 17920
  buffer_load_dwordx4 v[84:87], v2, s[48:51], s68 offen nt
  s_add_u32 s68, s67, 21504
  buffer_load_dwordx4 v[88:91], v2, s[48:51], s68 offen nt
  s_add_u32 s68, s67, 25088
  buffer_load_dwordx4 v[92:95], v2, s[48:51], s68 offen nt
  s_mov_b64 exec, s[74:75]
  buffer_load_dwordx4 v[64:67], v2, s[52:55], s67 offen nt
  s_add_u32 s68, s67, 3584
  buffer_load_dwordx4 v[68:71], v2, s[52:55], s68 offen nt
  s_add_u32 s68, s67, 7168
  buffer_load_dwordx4 v[72:75], v2, s[52:55], s68 offen nt
  s_add_u32 s68, s67, 10752
  buffer_load_dwordx4 v[76:79], v2, s[52:55], s68 offen nt
  s_add_u32 s68, s67, 14336
  buffer_load_dwordx4 v[80:83], v2, s[52:55], s68 offen nt
  s_add_u32 s68, s67, 17920
  buffer_load_dwordx4 v[84:87], v2, s[52:55], s68 offen nt
  s_add_u32 s68, s67, 21504
  buffer_load_dwordx4 v[88:91], v2, s[52:55], s68 offen nt
  s_add_u32 s68, s67, 25088
  buffer_load_dwordx4 v[92:95], v2, s[52:55], s68 offen nt
  s_mov_b64 exec, s[72:73]
  s_add_u32 s68, s67, 229376
  buffer_load_dwordx4 v[96:99], v2, s[48:51], s68 offen nt
  s_add_u32 s68, s67, 232960
  buffer_load_dwordx4 v[100:103], v2, s[48:51], s68 offen nt
  s_add_u32 s68, s67, 236544
  buffer_load_dwordx4 v[104:107], v2, s[48:51], s68 offen nt
  s_add_u32 s68, s67, 240128
  buffer_load_dwordx4 v[108:111], v2, s[48:51], s68 offen nt
  s_add_u32 s68, s67, 243712
  buffer_load_dwordx4 v[112:115], v2, s[48:51], s68 offen nt
  s_add_u32 s68, s67, 247296
  buffer_load_dwordx4 v[116:119], v2, s[48:51], s68 offen nt
  s_add_u32 s68, s67, 250880
  buffer_load_dwordx4 v[120:123], v2, s[48:51], s68 offen nt
  s_add_u32 s68, s67, 254464
  buffer_load_dwordx4 v[124:127], v2, s[48:51], s68 offen nt
  s_mov_b64 exec, s[74:75]
  s_add_u32 s68, s67, 229376
  buffer_load_dwordx4 v[96:99], v2, s[52:55], s68 offen nt
  s_add_u32 s68, s67, 232960
  buffer_load_dwordx4 v[100:103], v2, s[52:55], s68 offen nt
  s_add_u32 s68, s67, 236544
  buffer_load_dwordx4 v[104:107], v2, s[52:55], s68 offen nt
  s_add_u32 s68, s67, 240128
  buffer_load_dwordx4 v[108:111], v2, s[52:55], s68 offen nt
  s_add_u32 s68, s67, 243712
  buffer_load_dwordx4 v[112:115], v2, s[52:55], s68 offen nt
  s_add_u32 s68, s67, 247296
  buffer_load_dwordx4 v[116:119], v2, s[52:55], s68 offen nt
  s_add_u32 s68, s67, 250880
  buffer_load_dwordx4 v[120:123], v2, s[52:55], s68 offen nt
  s_add_u32 s68, s67, 254464
  buffer_load_dwordx4 v[124:127], v2, s[52:55], s68 offen nt
  s_mov_b64 exec, -1
  s_lshl_b32 s70, s64, 10
  s_add_u32 s70, s70, 0x4000
  s_add_u32 s71, s70, 4096
  buffer_load_dwordx4 v[16:19], v5, s[44:47], s70 offen sc1
  buffer_load_dwordx4 v[20:23], v5, s[44:47], s71 offen sc1
  v_and_b32 v10, 1, v0
  v_lshlrev_b32 v12, 11, v10
  v_bfe_u32 v10, v0, 1, 1
  v_lshl_add_u32 v12, v10, 7, v12
  v_bfe_u32 v10, v0, 2, 1
  v_lshl_add_u32 v12, v10, 4, v12
  v_bfe_u32 v10, v0, 3, 1
  v_lshl_add_u32 v12, v10, 8, v12
  v_lshrrev_b32 v10, 4, v0
  v_lshl_add_u32 v12, v10, 5, v12
  s_lshl_b32 s8, s64, 9
  v_add_u32 v12, s8, v12
  v_lshrrev_b32 v10, 5, v0
  v_lshlrev_b32 v10, 8, v10
  v_and_b32 v11, 15, v0
  v_lshl_add_u32 v13, v11, 4, v10
  s_lshl_b32 s8, s4, 12
  s_add_u32 s8, s8, 0xb8000
  s_lshl_b32 s9, s4, 9
  s_add_u32 s9, s9, 0xc0000
  buffer_load_dwordx4 v[24:27], v12, s[44:47], s8 offen sc1
  buffer_load_dwordx4 v[28:31], v13, s[44:47], s9 offen sc1
  s_waitcnt vmcnt(20)
  v_perm_b32 v128, v68, v64, s80
  v_perm_b32 v132, v68, v64, s81
  v_perm_b32 v129, v76, v72, s80
  v_perm_b32 v133, v76, v72, s81
  v_perm_b32 v130, v84, v80, s80
  v_perm_b32 v134, v84, v80, s81
  v_perm_b32 v131, v92, v88, s80
  v_perm_b32 v135, v92, v88, s81
  v_perm_b32 v136, v69, v65, s80
  v_perm_b32 v140, v69, v65, s81
  v_perm_b32 v137, v77, v73, s80
  v_perm_b32 v141, v77, v73, s81
  v_perm_b32 v138, v85, v81, s80
  v_perm_b32 v142, v85, v81, s81
  v_perm_b32 v139, v93, v89, s80
  v_perm_b32 v143, v93, v89, s81
  v_perm_b32 v144, v70, v66, s80
  v_perm_b32 v148, v70, v66, s81
  v_perm_b32 v145, v78, v74, s80
  v_perm_b32 v149, v78, v74, s81
  v_perm_b32 v146, v86, v82, s80
  v_perm_b32 v150, v86, v82, s81
  v_perm_b32 v147, v94, v90, s80
  v_perm_b32 v151, v94, v90, s81
  v_perm_b32 v152, v71, v67, s80
  v_perm_b32 v156, v71, v67, s81
  v_perm_b32 v153, v79, v75, s80
  v_perm_b32 v157, v79, v75, s81
  v_perm_b32 v154, v87, v83, s80
  v_perm_b32 v158, v87, v83, s81
  v_perm_b32 v155, v95, v91, s80
  v_perm_b32 v159, v95, v91, s81
  s_waitcnt vmcnt(4)
  buffer_load_dwordx4 v[192:195], v1, s[56:59], s69 offen nt
  s_add_u32 s68, s69, 1024
  buffer_load_dwordx4 v[196:199], v1, s[56:59], s68 offen nt
  s_add_u32 s68, s69, 2048
  buffer_load_dwordx4 v[200:203], v1, s[56:59], s68 offen nt
  s_add_u32 s68, s69, 3072
  buffer_load_dwordx4 v[204:207], v1, s[56:59], s68 offen nt
  s_add_u32 s68, s69, 4096
  buffer_load_dwordx4 v[208:211], v1, s[56:59], s68 offen nt
  s_add_u32 s68, s69, 5120
  buffer_load_dwordx4 v[212:215], v1, s[56:59], s68 offen nt
  s_add_u32 s68, s69, 6144
  buffer_load_dwordx4 v[216:219], v1, s[56:59], s68 offen nt
  s_add_u32 s68, s69, 7168
  buffer_load_dwordx4 v[220:223], v1, s[56:59], s68 offen nt
  v_perm_b32 v160, v100, v96, s80
  v_perm_b32 v164, v100, v96, s81
  v_perm_b32 v161, v108, v104, s80
  v_perm_b32 v165, v108, v104, s81
  v_perm_b32 v162, v116, v112, s80
  v_perm_b32 v166, v116, v112, s81
  v_perm_b32 v163, v124, v120, s80
  v_perm_b32 v167, v124, v120, s81
  v_perm_b32 v168, v101, v97, s80
  v_perm_b32 v172, v101, v97, s81
  v_perm_b32 v169, v109, v105, s80
  v_perm_b32 v173, v109, v105, s81
  v_perm_b32 v170, v117, v113, s80
  v_perm_b32 v174, v117, v113, s81
  v_perm_b32 v171, v125, v121, s80
  v_perm_b32 v175, v125, v121, s81
  v_perm_b32 v176, v102, v98, s80
  v_perm_b32 v180, v102, v98, s81
  v_perm_b32 v177, v110, v106, s80
  v_perm_b32 v181, v110, v106, s81
  v_perm_b32 v178, v118, v114, s80
  v_perm_b32 v182, v118, v114, s81
  v_perm_b32 v179, v126, v122, s80
  v_perm_b32 v183, v126, v122, s81
  v_perm_b32 v184, v103, v99, s80
  v_perm_b32 v188, v103, v99, s81
  v_perm_b32 v185, v111, v107, s80
  v_perm_b32 v189, v111, v107, s81
  v_perm_b32 v186, v119, v115, s80
  v_perm_b32 v190, v119, v115, s81
  v_perm_b32 v187, v127, v123, s80
  v_perm_b32 v191, v127, v123, s81
  s_branch L_ffn2
L_qpoll:
  s_cmp_lg_u32 s64, 0
  s_cbranch_scc1 L_qd_79
  v_lshrrev_b32 v8, 4, v0
  v_lshlrev_b32 v8, 9, v8
  v_and_b32 v9, 15, v0
  v_lshlrev_b32 v9, 4, v9
  v_add_u32 v8, v8, v9
  s_and_b32 s8, s5, 1
  s_lshl_b32 s8, s8, 8
  s_lshl_b32 s66, s4, 12
  s_add_u32 s66, s66, s8
  s_add_u32 s66, s66, 0x8000
  v_lshlrev_b32 v9, 3, v0
  v_mov_b32 v10, 1024
  buffer_load_dwordx4 v[32:35], v8, s[44:47], s66 offen offset:0 sc1
  buffer_load_dwordx4 v[36:39], v8, s[44:47], s66 offen offset:2048 sc1
  buffer_load_dwordx4 v[40:43], v8, s[44:47], s66 offen offset:0 sc1
  buffer_load_dwordx4 v[44:47], v8, s[44:47], s66 offen offset:2048 sc1
  buffer_load_dwordx4 v[48:51], v8, s[44:47], s66 offen offset:0 sc1
  buffer_load_dwordx4 v[52:55], v8, s[44:47], s66 offen offset:2048 sc1
  buffer_load_dwordx4 v[56:59], v8, s[44:47], s66 offen offset:0 sc1
  buffer_load_dwordx4 v[60:63], v8, s[44:47], s66 offen offset:2048 sc1
L_pp_80:
  s_waitcnt vmcnt(6)
  v_xor_b32 v12, s7, v35
  v_xor_b32 v13, s7, v39
  v_or_b32 v12, v12, v13
  v_cmp_ne_u32 vcc, 0, v12
  s_cbranch_vccz L_ppd_82
  buffer_load_dwordx4 v[32:35], v8, s[44:47], s66 offen offset:0 sc1
  buffer_load_dwordx4 v[36:39], v8, s[44:47], s66 offen offset:2048 sc1
  s_waitcnt vmcnt(6)
  v_xor_b32 v12, s7, v43
  v_xor_b32 v13, s7, v47
  v_or_b32 v12, v12, v13
  v_cmp_ne_u32 vcc, 0, v12
  s_cbranch_vccz L_ppd_83
  buffer_load_dwordx4 v[40:43], v8, s[44:47], s66 offen offset:0 sc1
  buffer_load_dwordx4 v[44:47], v8, s[44:47], s66 offen offset:2048 sc1
  s_waitcnt vmcnt(6)
  v_xor_b32 v12, s7, v51
  v_xor_b32 v13, s7, v55
  v_or_b32 v12, v12, v13
  v_cmp_ne_u32 vcc, 0, v12
  s_cbranch_vccz L_ppd_84
  buffer_load_dwordx4 v[48:51], v8, s[44:47], s66 offen offset:0 sc1
  buffer_load_dwordx4 v[52:55], v8, s[44:47], s66 offen offset:2048 sc1
  s_waitcnt vmcnt(6)
  v_xor_b32 v12, s7, v59
  v_xor_b32 v13, s7, v63
  v_or_b32 v12, v12, v13
  v_cmp_ne_u32 vcc, 0, v12
  s_cbranch_vccz L_ppd_85
  buffer_load_dwordx4 v[56:59], v8, s[44:47], s66 offen offset:0 sc1
  buffer_load_dwordx4 v[60:63], v8, s[44:47], s66 offen offset:2048 sc1
  s_sub_u32 s84, s84, 1
  s_cbranch_scc0 L_pp_80
  s_mov_b32 s84, 0
L_ppd_82:
  ds_write_b64 v9, v[32:33] offset:0
  ds_write_b64 v9, v[36:37] offset:512
  v_or_b32 v11, v34, v38
  s_branch L_ppf_81
L_ppd_83:
  ds_write_b64 v9, v[40:41] offset:0
  ds_write_b64 v9, v[44:45] offset:512
  v_or_b32 v11, v42, v46
  s_branch L_ppf_81
L_ppd_84:
  ds_write_b64 v9, v[48:49] offset:0
  ds_write_b64 v9, v[52:53] offset:512
  v_or_b32 v11, v50, v54
  s_branch L_ppf_81
L_ppd_85:
  ds_write_b64 v9, v[56:57] offset:0
  ds_write_b64 v9, v[60:61] offset:512
  v_or_b32 v11, v58, v62
L_ppf_81:
  v_cmp_ne_u32 vcc, 0, v11
  s_cmp_lg_u64 vcc, 0
  s_cselect_b32 s9, 2, 1
  v_mov_b32 v11, s9
  s_mov_b64 exec, 1
  ds_write_b32 v10, v11
  s_mov_b64 exec, -1
L_qd_79:
  s_branch L_tdone
L_tail:
  s_cmp_eq_u32 s64, 1
  s_cbranch_scc1 L_tdone
  s_cmp_ge_u32 s5, 12
  s_cbranch_scc1 L_tdone
  s_mov_b32 s8, s5
L_pf2:
  s_lshl_b32 s76, s8, 1
  s_add_u32 s76, s76, s64
  s_sub_u32 s76, s76, 2
  s_mov_b32 s48, s28
  s_mov_b32 s49, s29
  s_mov_b32 s50, 0x1c0000
  s_mov_b32 s51, 0x20000
  s_mov_b32 s52, s30
  s_mov_b32 s53, s31
  s_mov_b32 s54, 0x1c0000
  s_mov_b32 s55, 0x20000
  s_mov_b32 s56, s32
  s_mov_b32 s57, s33
  s_mov_b32 s58, 0x1c0000
  s_mov_b32 s59, 0x20000
  v_lshrrev_b32 v8, 2, v0
  v_mul_u32_u24 v8, 3584, v8
  v_and_b32 v9, 3, v0
  v_mul_u32_u24 v9, 128, v9
  v_add_u32 v16, v8, v9
  v_mul_u32_u24 v17, 128, v0
  s_mul_i32 s64, s4, 448
  s_and_b32 s64, s64, 0xffffff80
  s_mul_i32 s65, s4, 229376
  v_mov_b32 v12, 1216
L_lw_86:
  ds_read_b128 v[8:11], v12
  s_waitcnt lgkmcnt(0)
  v_min3_u32 v8, v8, v9, v10
  v_min_u32 v8, v8, v11
  v_cmp_ne_u32 vcc, 0, v8
  s_cbranch_vccnz L_lwd_87
  s_sub_u32 s84, s84, 1
  s_cbranch_scc0 L_lw_86
  s_mov_b32 s84, 0
L_lwd_87:
  s_cmp_ge_u32 s76, 92
  s_cbranch_scc1 L_pf2d
  s_cmp_ge_u32 s76, 64
  s_cbranch_scc1 L_pw2_89
  s_cmp_ge_u32 s76, 32
  s_cbranch_scc1 L_pw3_88
  s_mul_i32 s9, s76, 57344
  s_add_u32 s9, s9, s64
  buffer_load_dword v20, v16, s[48:51], s9 offen
  s_branch L_pwd_90
L_pw3_88:
  s_sub_u32 s9, s76, 32
  s_mul_i32 s9, s9, 57344
  s_add_u32 s9, s9, s64
  buffer_load_dword v20, v16, s[52:55], s9 offen
  s_branch L_pwd_90
L_pw2_89:
  s_sub_u32 s9, s76, 64
  s_mul_i32 s9, s9, 8192
  s_add_u32 s9, s9, s65
  buffer_load_dword v20, v17, s[56:59], s9 offen
L_pwd_90:
  s_add_u32 s76, s76, 26
  s_cmp_ge_u32 s76, 92
  s_cbranch_scc1 L_pf2d
  s_cmp_ge_u32 s76, 64
  s_cbranch_scc1 L_pw2_92
  s_cmp_ge_u32 s76, 32
  s_cbranch_scc1 L_pw3_91
  s_mul_i32 s9, s76, 57344
  s_add_u32 s9, s9, s64
  buffer_load_dword v21, v16, s[48:51], s9 offen
  s_branch L_pwd_93
L_pw3_91:
  s_sub_u32 s9, s76, 32
  s_mul_i32 s9, s9, 57344
  s_add_u32 s9, s9, s64
  buffer_load_dword v21, v16, s[52:55], s9 offen
  s_branch L_pwd_93
L_pw2_92:
  s_sub_u32 s9, s76, 64
  s_mul_i32 s9, s9, 8192
  s_add_u32 s9, s9, s65
  buffer_load_dword v21, v17, s[56:59], s9 offen
L_pwd_93:
  s_add_u32 s76, s76, 26
  s_cmp_ge_u32 s76, 92
  s_cbranch_scc1 L_pf2d
  s_cmp_ge_u32 s76, 64
  s_cbranch_scc1 L_pw2_95
  s_cmp_ge_u32 s76, 32
  s_cbranch_scc1 L_pw3_94
  s_mul_i32 s9, s76, 57344
  s_add_u32 s9, s9, s64
  buffer_load_dword v22, v16, s[48:51], s9 offen
  s_branch L_pwd_96
L_pw3_94:
  s_sub_u32 s9, s76, 32
  s_mul_i32 s9, s9, 57344
  s_add_u32 s9, s9, s64
  buffer_load_dword v22, v16, s[52:55], s9 offen
  s_branch L_pwd_96
L_pw2_95:
  s_sub_u32 s9, s76, 64
  s_mul_i32 s9, s9, 8192
  s_add_u32 s9, s9, s65
  buffer_load_dword v22, v17, s[56:59], s9 offen
L_pwd_96:
  s_add_u32 s76, s76, 26
  s_cmp_ge_u32 s76, 92
  s_cbranch_scc1 L_pf2d
  s_cmp_ge_u32 s76, 64
  s_cbranch_scc1 L_pw2_98
  s_cmp_ge_u32 s76, 32
  s_cbranch_scc1 L_pw3_97
  s_mul_i32 s9, s76, 57344
  s_add_u32 s9, s9, s64
  buffer_load_dword v23, v16, s[48:51], s9 offen
  s_branch L_pwd_99
L_pw3_97:
  s_sub_u32 s9, s76, 32
  s_mul_i32 s9, s9, 57344
  s_add_u32 s9, s9, s64
  buffer_load_dword v23, v16, s[52:55], s9 offen
  s_branch L_pwd_99
L_pw2_98:
  s_sub_u32 s9, s76, 64
  s_mul_i32 s9, s9, 8192
  s_add_u32 s9, s9, s65
  buffer_load_dword v23, v17, s[56:59], s9 offen
L_pwd_99:
L_pf2d:
  s_waitcnt vmcnt(0)
  s_branch L_tdone
L_wo2:
  s_and_b32 s70, s64, 1
  s_lshr_b32 s71, s64, 1
  s_lshl_b32 s72, s68, 1
  s_add_u32 s72, s72, s70
  s_mul_i32 s72, s72, 9216
  s_add_u32 s72, s72, 0x10000
  s_lshl_b32 s8, s71, 8
  s_add_u32 s73, s72, s8
  s_add_u32 s74, s73, 4608
  v_lshrrev_b32 v8, 4, v0
  v_and_b32 v9, 15, v0
  v_mul_u32_u24 v10, 576, v8
  v_lshlrev_b32 v11, 4, v9
  v_add_u32 v12, v10, v11
  v_and_b32 v11, 3, v0
  v_mul_u32_u24 v11, 2304, v11
  v_add3_u32 v13, v10, v11, 0
  v_add_u32 v13, 512, v13
  s_mul_i32 s8, s70, 384
  s_lshl_b32 s9, s71, 7
  s_add_u32 s8, s8, s9
  s_add_u32 s8, s8, 15360
  v_lshlrev_b32 v14, 3, v9
  v_add_u32 v14, s8, v14
  v_add_u32 v25, 15360, v7
  s_lshl_b32 s8, s64, 2
  s_add_u32 s8, s8, 1088
  v_mov_b32 v86, s8
  v_mov_b32 v87, 1
  s_mov_b32 s76, 0
  s_mov_b32 s77, 0xff
  s_mov_b32 s78, 0x00ff00ff
  s_mov_b32 s79, 0xff
  v_add_u32 v11, v8, v9
  v_and_b32 v11, 15, v11
  v_mul_u32_u24 v11, 576, v11
  v_add_u32 v13, 512, v11
  v_and_b32 v10, 1, v9
  v_lshlrev_b32 v10, 4, v10
  v_mov_b32 v11, 0xffff
  v_lshlrev_b32 v10, v10, v11
  v_lshrrev_b32 v11, 1, v9
  v_cmp_eq_u32 vcc, 0, v11
  s_nop 1
  v_cndmask_b32 v84, 0, v10, vcc
  v_cmp_eq_u32 vcc, 1, v11
  s_nop 1
  v_cndmask_b32 v85, 0, v10, vcc
  v_bfe_u32 v2, v0, 2, 1
  v_mul_u32_u24 v2, 192, v2
  v_and_b32 v9, 3, v0
  v_lshl_add_u32 v2, v9, 4, v2
  s_lshl_b32 s8, s69, 5
  s_lshl_b32 s9, s64, 3
  s_add_u32 s8, s8, s9
  s_mul_i32 s8, s8, 48
  s_mul_i32 s75, s68, 3072
  s_add_u32 s75, s75, s8
  s_add_u32 s75, s75, 0xa0000
  v_mov_b32 v56, v12
  v_mov_b32 v66, 0
  v_mov_b32 v67, s7
  v_lshrrev_b32 v9, 4, v0
  v_lshl_add_u32 v2, v9, 6, v2
  s_mov_b32 s70, 0xff
  s_mov_b32 s71, 0
  v_mov_b32 v9, 1024
L_lw_100:
  ds_read_b32 v8, v9
  s_waitcnt lgkmcnt(0)
  v_cmp_ne_u32 vcc, 0, v8
  s_cbranch_vccnz L_lwd_101
  s_sub_u32 s84, s84, 1
  s_cbranch_scc0 L_lw_100
  s_mov_b32 s84, 0
L_lwd_101:
  v_readfirstlane_b32 s83, v8
  s_lshr_b32 s83, s83, 1
  s_sub_u32 s9, s5, 12
  s_lshl_b32 s9, s9, 1
  s_add_u32 s9, s9, s64
  s_mov_b32 s56, s16
  s_mov_b32 s57, s17
  s_mov_b32 s58, 0x800
  s_mov_b32 s59, 0x20000
  v_and_b32 v8, 3, v0
  v_lshrrev_b32 v11, 5, v0
  v_bfe_u32 v10, v0, 4, 1
  v_lshlrev_b32 v197, 10, v11
  v_lshl_add_u32 v197, v8, 4, v197
  v_lshl_add_u32 v197, v10, 3, v197
  s_lshl_b32 s8, s9, 6
  v_add_u32 v197, s8, v197
  v_lshlrev_b32 v196, 8, v11
  v_lshl_add_u32 v196, v8, 5, v196
  v_lshl_add_u32 v196, v10, 4, v196
  s_and_b32 s8, s9, 1
  s_lshl_b32 s8, s8, 7
  v_add_u32 v196, s8, v196
  s_lshr_b32 s10, s9, 1
  s_lshl_b32 s10, s10, 9
  s_add_u32 s10, s10, 0x3000
  s_add_u32 s11, s10, 8192
  s_add_u32 s8, s10, 12288
  buffer_load_dwordx2 v[198:199], v197, s[56:59], 0 offen
  buffer_load_dwordx4 v[200:203], v196, s[44:47], s10 offen sc1
  buffer_load_dwordx4 v[204:207], v196, s[44:47], s11 offen sc1
  buffer_load_dwordx4 v[208:211], v196, s[44:47], s8 offen sc1
  v_mov_b32 v12, 1216
L_lw_102:
  ds_read_b128 v[8:11], v12
  s_waitcnt lgkmcnt(0)
  v_min3_u32 v8, v8, v9, v10
  v_min_u32 v8, v8, v11
  v_cmp_ne_u32 vcc, 0, v8
  s_cbranch_vccnz L_lwd_103
  s_sub_u32 s84, s84, 1
  s_cbranch_scc0 L_lw_102
  s_mov_b32 s84, 0
L_lwd_103:
L_poll_104:
  buffer_load_dwordx4 v[32:35], v56, s[44:47], s73 offen offset:0 sc1
  buffer_load_dwordx4 v[36:39], v56, s[44:47], s73 offen offset:2304 sc1
  buffer_load_dwordx4 v[40:43], v56, s[44:47], s74 offen offset:0 sc1
  buffer_load_dwordx4 v[44:47], v56, s[44:47], s74 offen offset:2304 sc1
  buffer_load_dwordx4 v[48:51], v13, s[44:47], s72 offen offset:0 sc1
  s_waitcnt vmcnt(0)
  v_xor_b32 v8, s7, v35
  v_xor_b32 v9, s7, v39
  v_or_b32 v8, v8, v9
  v_xor_b32 v9, s7, v43
  v_or_b32 v8, v8, v9
  v_xor_b32 v9, s7, v47
  v_or_b32 v8, v8, v9
  v_xor_b32 v9, s7, v51
  v_or_b32 v8, v8, v9
  v_cmp_ne_u32 vcc, 0, v8
  s_cbranch_vccz L_pdone_105
  s_sub_u32 s84, s84, 1
  s_cbranch_scc0 L_poll_104
  s_mov_b32 s84, 0
L_pdone_105:
  v_max_f32_dpp v50, v48, v48 row_ror:8 row_mask:0xf bank_mask:0xf
  s_nop 1
  v_max_f32_dpp v50, v50, v50 row_ror:4 row_mask:0xf bank_mask:0xf
  s_nop 1
  v_max_f32_dpp v50, v50, v50 row_ror:2 row_mask:0xf bank_mask:0xf
  s_nop 1
  v_max_f32_dpp v50, v50, v50 row_ror:1 row_mask:0xf bank_mask:0xf
  v_sub_f32 v48, v48, v50
  v_mul_f32 v48, s85, v48
  v_exp_f32 v48, v48
  s_nop 0
  v_cvt_pk_bf16_f32 v51, v48, v48
  s_nop 1
  v_and_b32_dpp v68, v51, v84 row_newbcast:0 row_mask:0xf bank_mask:0xf
  v_and_b32_dpp v69, v51, v85 row_newbcast:0 row_mask:0xf bank_mask:0xf
  v_and_b32 v50, s82, v51
  v_mul_f32 v50, v50, v49
  v_mfma_f32_16x16x16_bf16 v[20:23], v[68:69], v[32:33], 0
  v_and_b32_dpp v70, v51, v84 row_newbcast:4 row_mask:0xf bank_mask:0xf
  v_and_b32_dpp v71, v51, v85 row_newbcast:4 row_mask:0xf bank_mask:0xf
  v_add_f32_dpp v50, v50, v50 row_ror:8 row_mask:0xf bank_mask:0xf
  s_nop 0
  v_mfma_f32_16x16x16_bf16 v[20:23], v[70:71], v[36:37], v[20:23]
  v_and_b32_dpp v72, v51, v84 row_newbcast:8 row_mask:0xf bank_mask:0xf
  v_and_b32_dpp v73, v51, v85 row_newbcast:8 row_mask:0xf bank_mask:0xf
  v_add_f32_dpp v50, v50, v50 row_ror:4 row_mask:0xf bank_mask:0xf
  s_nop 0
  v_mfma_f32_16x16x16_bf16 v[20:23], v[72:73], v[40:41], v[20:23]
  v_and_b32_dpp v74, v51, v84 row_newbcast:12 row_mask:0xf bank_mask:0xf
  v_and_b32_dpp v75, v51, v85 row_newbcast:12 row_mask:0xf bank_mask:0xf
  v_add_f32_dpp v50, v50, v50 row_ror:2 row_mask:0xf bank_mask:0xf
  s_nop 0
  v_mfma_f32_16x16x16_bf16 v[20:23], v[74:75], v[44:45], v[20:23]
  v_add_f32_dpp v50, v50, v50 row_ror:1 row_mask:0xf bank_mask:0xf
  v_rcp_f32 v50, v50
  s_nop 5
  v_mul_f32 v20, v20, v50
  v_mul_f32 v21, v21, v50
  v_mul_f32 v22, v22, v50
  v_mul_f32 v23, v23, v50
  v_cvt_pk_bf16_f32 v16, v20, v21
  v_cvt_pk_bf16_f32 v17, v22, v23
  s_mov_b64 exec, 0xffff
  ds_write_b64 v14, v[16:17]
  s_mov_b64 exec, 1
  ds_write_b32 v86, v87
  s_mov_b64 exec, -1
  v_mov_b32 v24, 1088
L_lw_107:
  ds_read_b128 v[20:23], v24
  ds_read_b128 v[8:11], v25 offset:0
  ds_read_b128 v[12:15], v25 offset:128
  s_waitcnt lgkmcnt(0)
  v_min3_u32 v20, v20, v21, v22
  v_min_u32 v20, v20, v23
  v_cmp_ne_u32 vcc, 0, v20
  s_cbranch_vccnz L_lwd_108
  s_sub_u32 s84, s84, 1
  s_cbranch_scc0 L_lw_107
  s_mov_b32 s84, 0
L_lwd_108:
  s_mov_b64 vcc, 0xff0000
  v_mfma_f32_16x16x32_bf16 v[32:35], v[8:11], v[128:131], 0
  v_mfma_f32_16x16x32_bf16 v[32:35], v[12:15], v[160:163], v[32:35]
  v_mfma_f32_16x16x32_bf16 v[36:39], v[8:11], v[132:135], 0
  v_mfma_f32_16x16x32_bf16 v[36:39], v[12:15], v[164:167], v[36:39]
  v_mfma_f32_16x16x32_bf16 v[40:43], v[8:11], v[136:139], 0
  v_mfma_f32_16x16x32_bf16 v[40:43], v[12:15], v[168:171], v[40:43]
  v_mfma_f32_16x16x32_bf16 v[44:47], v[8:11], v[140:143], 0
  v_mfma_f32_16x16x32_bf16 v[44:47], v[12:15], v[172:175], v[44:47]
  s_nop 1
  v_add_f32_dpp v16, v34, v32 row_shl:8 row_mask:0xf bank_mask:0xf
  v_add_f32_dpp v24, v35, v33 row_shl:8 row_mask:0xf bank_mask:0xf
  v_mfma_f32_16x16x32_bf16 v[48:51], v[8:11], v[144:147], 0
  v_mfma_f32_16x16x32_bf16 v[48:51], v[12:15], v[176:179], v[48:51]
  v_add_f32_dpp v17, v38, v36 row_shl:8 row_mask:0xf bank_mask:0xf
  v_add_f32_dpp v25, v39, v37 row_shl:8 row_mask:0xf bank_mask:0xf
  v_add_f32_dpp v18, v42, v40 row_shl:8 row_mask:0xf bank_mask:0xf
  v_add_f32_dpp v26, v43, v41 row_shl:8 row_mask:0xf bank_mask:0xf
  v_mfma_f32_16x16x32_bf16 v[52:55], v[8:11], v[148:151], 0
  v_mfma_f32_16x16x32_bf16 v[52:55], v[12:15], v[180:183], v[52:55]
  v_add_f32_dpp v19, v46, v44 row_shl:8 row_mask:0xf bank_mask:0xf
  v_add_f32_dpp v27, v47, v45 row_shl:8 row_mask:0xf bank_mask:0xf
  v_cvt_pk_bf16_f32 v64, v16, v17
  v_cvt_pk_bf16_f32 v65, v18, v19
  v_mfma_f32_16x16x32_bf16 v[56:59], v[8:11], v[152:155], 0
  v_mfma_f32_16x16x32_bf16 v[56:59], v[12:15], v[184:187], v[56:59]
  v_cvt_pk_bf16_f32 v68, v24, v25
  v_cvt_pk_bf16_f32 v69, v26, v27
  v_cndmask_b32 v65, v65, v68, vcc
  v_cndmask_b32 v66, v66, v69, vcc
  v_mfma_f32_16x16x32_bf16 v[60:63], v[8:11], v[156:159], 0
  v_mfma_f32_16x16x32_bf16 v[60:63], v[12:15], v[188:191], v[60:63]
  v_add_f32_dpp v20, v50, v48 row_shl:8 row_mask:0xf bank_mask:0xf
  v_add_f32_dpp v28, v51, v49 row_shl:8 row_mask:0xf bank_mask:0xf
  v_add_f32_dpp v21, v54, v52 row_shl:8 row_mask:0xf bank_mask:0xf
  v_add_f32_dpp v29, v55, v53 row_shl:8 row_mask:0xf bank_mask:0xf
  v_cvt_pk_bf16_f32 v68, v20, v21
  v_cvt_pk_bf16_f32 v69, v28, v29
  v_add_f32_dpp v22, v58, v56 row_shl:8 row_mask:0xf bank_mask:0xf
  v_add_f32_dpp v30, v59, v57 row_shl:8 row_mask:0xf bank_mask:0xf
  v_cndmask_b32 v66, v66, v68, s[70:71]
  v_cndmask_b32 v64, v64, v69, s[76:77]
  v_add_f32_dpp v23, v62, v60 row_shl:8 row_mask:0xf bank_mask:0xf
  v_add_f32_dpp v31, v63, v61 row_shl:8 row_mask:0xf bank_mask:0xf
  s_mov_b64 exec, 0xff0000
  v_cvt_pk_bf16_f32 v64, v22, v23
  s_mov_b64 exec, s[76:77]
  v_cvt_pk_bf16_f32 v65, v30, v31
  s_mov_b64 exec, s[78:79]
  buffer_store_dwordx4 v[64:67], v2, s[44:47], s75 offen sc1
  s_mov_b64 exec, -1
  s_cmp_ge_u32 s64, 2
  s_cbranch_scc1 L_tdone
  s_sub_u32 s65, s5, 12
  s_lshl_b32 s65, s65, 1
  s_add_u32 s65, s65, s64
  s_branch L_b1c
L_b1:
  s_sub_u32 s8, s5, 8
  s_cmp_ge_u32 s5, 20
  s_cselect_b32 s65, s8, s5
L_b1c:
  s_mov_b32 s56, s16
  s_mov_b32 s57, s17
  s_mov_b32 s58, 0x800
  s_mov_b32 s59, 0x20000
  s_mov_b32 s60, s38
  s_mov_b32 s61, s39
  s_mov_b32 s62, 0x800
  s_mov_b32 s63, 0x20000
  v_and_b32 v8, 3, v0
  v_bfe_u32 v9, v0, 2, 2
  v_lshrrev_b32 v10, 4, v0
  v_lshrrev_b32 v11, 5, v0
  v_bfe_u32 v12, v0, 4, 1
  v_lshlrev_b32 v13, 10, v11
  v_lshlrev_b32 v14, 4, v8
  v_lshlrev_b32 v15, 3, v12
  v_add3_u32 v13, v13, v14, v15
  s_lshl_b32 s8, s65, 6
  v_add_u32 v2, s8, v13
  v_lshlrev_b32 v13, 8, v11
  v_lshlrev_b32 v14, 5, v8
  v_lshlrev_b32 v15, 4, v12
  v_add3_u32 v13, v13, v14, v15
  s_and_b32 s8, s65, 1
  s_lshl_b32 s8, s8, 7
  v_add_u32 v3, s8, v13
  s_lshr_b32 s8, s65, 1
  s_lshl_b32 s8, s8, 9
  s_add_u32 s66, s8, 0x3000
  s_add_u32 s67, s66, 12288
  s_add_u32 s76, s66, 8192
  v_lshlrev_b32 v13, 11, v11
  v_lshlrev_b32 v14, 5, v8
  v_lshlrev_b32 v15, 4, v12
  v_add3_u32 v13, v13, v14, v15
  s_lshl_b32 s8, s65, 7
  v_add_u32 v4, s8, v13
  s_lshl_b32 s68, s4, 12
  s_add_u32 s68, s68, 0xb8000
  v_lshlrev_b32 v13, 8, v11
  s_lshl_b32 s8, s65, 4
  v_add_u32 v5, s8, v13
  s_lshl_b32 s69, s4, 9
  s_add_u32 s69, s69, 0xc0000
  v_lshlrev_b32 v13, 2, v10
  v_add_u32 v13, v13, v9
  v_mul_u32_u24 v13, 3072, v13
  v_lshlrev_b32 v14, 4, v8
  s_mul_i32 s8, s65, 192
  v_add3_u32 v6, v13, v14, s8
  s_mov_b32 s70, 0xa0000
  s_mov_b32 s71, 0xac000
  s_mov_b32 s72, 0xc8000
  s_mov_b32 s73, 0xd4000
  s_mov_b32 s74, 0xe0000
  s_mov_b32 s75, 0xec000
  v_bfe_u32 v13, v0, 1, 3
  v_and_b32 v14, 1, v0
  v_mov_b32 v15, 0x3f80
  v_mov_b32 v7, 0x3f800000
  v_cmp_eq_u32 vcc, 1, v14
  s_nop 1
  v_cndmask_b32 v15, v15, v7, vcc
  v_cmp_eq_u32 vcc, 0, v13
  s_nop 1
  v_cndmask_b32 v64, 0, v15, vcc
  v_cmp_eq_u32 vcc, 1, v13
  s_nop 1
  v_cndmask_b32 v65, 0, v15, vcc
  v_cmp_eq_u32 vcc, 2, v13
  s_nop 1
  v_cndmask_b32 v66, 0, v15, vcc
  v_mov_b32 v67, 0
  v_cmp_eq_u32 vcc, 3, v13
  s_nop 1
  v_cndmask_b32 v68, 0, v15, vcc
  v_cmp_eq_u32 vcc, 4, v13
  s_nop 1
  v_cndmask_b32 v69, 0, v15, vcc
  v_cmp_eq_u32 vcc, 5, v13
  s_nop 1
  v_cndmask_b32 v70, 0, v15, vcc
  v_mov_b32 v71, 0
  v_cmp_eq_u32 vcc, 6, v13
  s_nop 1
  v_cndmask_b32 v72, 0, v15, vcc
  v_cmp_eq_u32 vcc, 7, v13
  s_nop 1
  v_cndmask_b32 v73, 0, v15, vcc
  v_mov_b32 v74, 0
  v_mov_b32 v75, 0
  v_mov_b32 v52, 1216
L_lw_109:
  ds_read_b128 v[48:51], v52
  s_waitcnt lgkmcnt(0)
  v_min3_u32 v48, v48, v49, v50
  v_min_u32 v48, v48, v51
  v_cmp_ne_u32 vcc, 0, v48
  s_cbranch_vccnz L_lwd_110
  s_sub_u32 s84, s84, 1
  s_cbranch_scc0 L_lw_109
  s_mov_b32 s84, 0
L_lwd_110:
  v_mov_b32 v58, 0
  v_mov_b32 v59, s7
  s_waitcnt vmcnt(63)
L_bc_111:
  v_xor_b32 v13, s7, v203
  v_xor_b32 v14, s7, v207
  v_xor_b32 v15, s7, v211
  v_or3_b32 v13, v13, v14, v15
  v_cmp_ne_u32 vcc, 0, v13
  s_cbranch_vccz L_bo_112
  buffer_load_dwordx4 v[200:203], v3, s[44:47], s66 offen sc1
  buffer_load_dwordx4 v[204:207], v3, s[44:47], s76 offen sc1
  buffer_load_dwordx4 v[208:211], v3, s[44:47], s67 offen sc1
  s_waitcnt vmcnt(0)
  s_sub_u32 s84, s84, 1
  s_cbranch_scc0 L_bc_111
  s_mov_b32 s84, 0
L_bo_112:
  v_lshlrev_b32 v28, 16, v198
  v_and_b32 v29, s82, v198
  v_lshlrev_b32 v30, 16, v199
  v_and_b32 v31, s82, v199
  v_lshlrev_b32 v32, 16, v200
  v_and_b32 v33, s82, v200
  v_lshlrev_b32 v34, 16, v201
  v_and_b32 v35, s82, v201
  v_lshlrev_b32 v36, 16, v208
  v_and_b32 v37, s82, v208
  v_lshlrev_b32 v38, 16, v209
  v_and_b32 v39, s82, v209
  v_lshlrev_b32 v220, 16, v204
  v_and_b32 v221, s82, v204
  v_lshlrev_b32 v222, 16, v205
  v_and_b32 v223, s82, v205
  v_add_f32 v220, 1.0, v220
  v_add_f32 v221, 1.0, v221
  v_add_f32 v222, 1.0, v222
  v_add_f32 v223, 1.0, v223
  v_cvt_pk_bf16_f32 v13, v220, v221
  v_cvt_pk_bf16_f32 v14, v222, v223
  v_lshlrev_b32 v220, 16, v13
  v_and_b32 v221, s82, v13
  v_lshlrev_b32 v222, 16, v14
  v_and_b32 v223, s82, v14
  v_pk_mul_f32 v[212:213], v[28:29], v[220:221]
  v_pk_mul_f32 v[214:215], v[30:31], v[222:223]
  v_pk_mul_f32 v[216:217], v[32:33], v[220:221]
  v_pk_mul_f32 v[218:219], v[34:35], v[222:223]
  v_mov_b32 v226, 0
  v_mov_b32 v227, s7
  s_mov_b32 s78, 0x000f000f
  s_mov_b32 s79, 0x000f000f
  buffer_load_dwordx4 v[80:83], v6, s[44:47], s70 offen offset:0 sc1
  buffer_load_dwordx4 v[84:87], v6, s[44:47], s70 offen offset:64 sc1
  buffer_load_dwordx4 v[88:91], v6, s[44:47], s70 offen offset:128 sc1
  buffer_load_dwordx4 v[92:95], v6, s[44:47], s71 offen offset:0 sc1
  buffer_load_dwordx4 v[96:99], v6, s[44:47], s71 offen offset:64 sc1
  buffer_load_dwordx4 v[100:103], v6, s[44:47], s71 offen offset:128 sc1
L_gp_113:
  s_waitcnt vmcnt(5)
  v_mfma_f32_16x16x32_bf16 v[40:43], v[64:67], v[80:83], 0
  v_xor_b32 v13, s7, v83
  s_waitcnt vmcnt(4)
  v_mfma_f32_16x16x32_bf16 v[44:47], v[68:71], v[84:87], 0
  v_xor_b32 v14, s7, v87
  s_waitcnt vmcnt(3)
  v_mfma_f32_16x16x32_bf16 v[40:43], v[72:75], v[88:91], v[40:43]
  v_xor_b32 v15, s7, v91
  v_or3_b32 v13, v13, v14, v15
  s_waitcnt vmcnt(2)
  v_mfma_f32_16x16x32_bf16 v[44:47], v[64:67], v[92:95], v[44:47]
  v_xor_b32 v14, s7, v95
  s_waitcnt vmcnt(1)
  v_mfma_f32_16x16x32_bf16 v[40:43], v[68:71], v[96:99], v[40:43]
  v_xor_b32 v15, s7, v99
  v_or3_b32 v13, v13, v14, v15
  s_waitcnt vmcnt(0)
  v_mfma_f32_16x16x32_bf16 v[44:47], v[72:75], v[100:103], v[44:47]
  v_xor_b32 v14, s7, v103
  v_or_b32 v13, v13, v14
  v_cmp_ne_u32 vcc, 0, v13
  s_cbranch_vccz L_gf_114
  buffer_load_dwordx4 v[80:83], v6, s[44:47], s70 offen offset:0 sc1
  buffer_load_dwordx4 v[84:87], v6, s[44:47], s70 offen offset:64 sc1
  buffer_load_dwordx4 v[88:91], v6, s[44:47], s70 offen offset:128 sc1
  buffer_load_dwordx4 v[92:95], v6, s[44:47], s71 offen offset:0 sc1
  buffer_load_dwordx4 v[96:99], v6, s[44:47], s71 offen offset:64 sc1
  buffer_load_dwordx4 v[100:103], v6, s[44:47], s71 offen offset:128 sc1
  s_sub_u32 s84, s84, 1
  s_cbranch_scc0 L_gp_113
  s_mov_b32 s84, 0
L_gf_114:
  s_nop 3
  v_pk_add_f32 v[40:41], v[40:41], v[44:45]
  v_pk_add_f32 v[42:43], v[42:43], v[46:47]
  s_nop 0
  v_add_f32_dpp v40, v40, v40 row_ror:4 row_mask:0xf bank_mask:0xf
  v_add_f32_dpp v41, v41, v41 row_ror:4 row_mask:0xf bank_mask:0xf
  v_add_f32_dpp v42, v42, v42 row_ror:4 row_mask:0xf bank_mask:0xf
  v_add_f32_dpp v43, v43, v43 row_ror:4 row_mask:0xf bank_mask:0xf
  v_add_f32_dpp v40, v40, v40 row_ror:8 row_mask:0xf bank_mask:0xf
  v_add_f32_dpp v41, v41, v41 row_ror:8 row_mask:0xf bank_mask:0xf
  v_add_f32_dpp v42, v42, v42 row_ror:8 row_mask:0xf bank_mask:0xf
  v_add_f32_dpp v43, v43, v43 row_ror:8 row_mask:0xf bank_mask:0xf
  v_pk_fma_f32 v[44:45], v[216:217], v[40:41], v[212:213]
  v_pk_fma_f32 v[46:47], v[218:219], v[42:43], v[214:215]
  v_cvt_pk_bf16_f32 v224, v44, v45
  v_cvt_pk_bf16_f32 v225, v46, v47
  s_mov_b64 exec, s[78:79]
  s_cmp_eq_u32 s83, 0
  s_cbranch_scc1 L_slow_115
  buffer_store_dwordx4 v[224:227], v4, s[44:47], s68 offen
  s_branch L_sd_116
L_slow_115:
  buffer_store_dwordx4 v[224:227], v4, s[44:47], s68 offen sc1
L_sd_116:
  s_mov_b64 exec, -1
  v_pk_fma_f32 v[48:49], v[32:33], v[40:41], v[28:29]
  v_pk_fma_f32 v[50:51], v[34:35], v[42:43], v[30:31]
  v_pk_add_f32 v[52:53], v[48:49], v[50:51]
  v_pk_mul_f32 v[54:55], v[48:49], v[48:49]
  v_add_f32 v56, v52, v53
  v_pk_fma_f32 v[54:55], v[50:51], v[50:51], v[54:55]
  v_add_f32 v57, v54, v55
  v_add_f32_dpp v56, v56, v56 quad_perm:[1,0,3,2] row_mask:0xf bank_mask:0xf
  s_nop 0
  v_add_f32_dpp v57, v57, v57 quad_perm:[1,0,3,2] row_mask:0xf bank_mask:0xf
  v_add_f32_dpp v56, v56, v56 quad_perm:[2,3,0,1] row_mask:0xf bank_mask:0xf
  s_nop 0
  v_add_f32_dpp v57, v57, v57 quad_perm:[2,3,0,1] row_mask:0xf bank_mask:0xf
  v_mov_b32 v52, v56
  v_mov_b32 v53, v57
  s_nop 0
  v_permlane16_swap_b32 v56, v52
  v_permlane16_swap_b32 v57, v53
  v_add_f32 v56, v56, v52
  v_add_f32 v57, v57, v53
  s_mov_b32 s10, 1
  s_mov_b32 s11, 1
  s_mov_b64 exec, s[10:11]
  s_cmp_eq_u32 s83, 0
  s_cbranch_scc1 L_slow_117
  buffer_store_dwordx4 v[56:59], v5, s[44:47], s69 offen
  s_branch L_sd_118
L_slow_117:
  buffer_store_dwordx4 v[56:59], v5, s[44:47], s69 offen sc1
L_sd_118:
  s_mov_b64 exec, -1
  v_cvt_pk_bf16_f32 v13, v40, v41
  v_cvt_pk_bf16_f32 v14, v42, v43
  v_lshlrev_b32 v40, 16, v13
  v_and_b32 v41, s82, v13
  v_lshlrev_b32 v42, 16, v14
  v_and_b32 v43, s82, v14
  v_mul_f32 v40, v32, v40
  v_mul_f32 v41, v33, v41
  v_mul_f32 v42, v34, v42
  v_mul_f32 v43, v35, v43
  v_cvt_pk_bf16_f32 v13, v40, v41
  v_cvt_pk_bf16_f32 v14, v42, v43
  v_lshlrev_b32 v40, 16, v13
  v_and_b32 v41, s82, v13
  v_lshlrev_b32 v42, 16, v14
  v_and_b32 v43, s82, v14
  v_add_f32 v28, v28, v40
  v_add_f32 v29, v29, v41
  v_add_f32 v30, v30, v42
  v_add_f32 v31, v31, v43
  v_cvt_pk_bf16_f32 v13, v28, v29
  v_cvt_pk_bf16_f32 v14, v30, v31
  v_lshlrev_b32 v28, 16, v13
  v_and_b32 v29, s82, v13
  v_lshlrev_b32 v30, 16, v14
  v_and_b32 v31, s82, v14
  s_and_b32 s8, s65, 7
  s_cmp_lg_u32 s8, s4
  s_cbranch_scc1 L_tdone
  v_mov_b32 v116, 0
  v_mov_b32 v117, 0
  v_mov_b32 v118, 0
  v_mov_b32 v119, s7
  v_mov_b32 v120, 0
  v_mov_b32 v121, 0
  v_mov_b32 v122, 0
  v_mov_b32 v123, s7
  v_mov_b32 v124, 0
  v_mov_b32 v125, 0
  v_mov_b32 v126, 0
  v_mov_b32 v127, s7
  v_mov_b32 v164, 0
  v_mov_b32 v165, 0
  v_mov_b32 v166, 0
  v_mov_b32 v167, s7
  v_mov_b32 v168, 0
  v_mov_b32 v169, 0
  v_mov_b32 v170, 0
  v_mov_b32 v171, s7
  v_mov_b32 v172, 0
  v_mov_b32 v173, 0
  v_mov_b32 v174, 0
  v_mov_b32 v175, s7
  buffer_load_dwordx4 v[80:83], v6, s[44:47], s72 offen offset:0 sc1
  buffer_load_dwordx4 v[84:87], v6, s[44:47], s72 offen offset:64 sc1
  buffer_load_dwordx4 v[88:91], v6, s[44:47], s72 offen offset:128 sc1
  buffer_load_dwordx4 v[92:95], v6, s[44:47], s73 offen offset:0 sc1
  buffer_load_dwordx4 v[96:99], v6, s[44:47], s73 offen offset:64 sc1
  buffer_load_dwordx4 v[100:103], v6, s[44:47], s73 offen offset:128 sc1
  buffer_load_dwordx4 v[104:107], v6, s[44:47], s74 offen offset:0 sc1
  buffer_load_dwordx4 v[108:111], v6, s[44:47], s74 offen offset:64 sc1
  buffer_load_dwordx4 v[112:115], v6, s[44:47], s74 offen offset:128 sc1
  s_mov_b32 exec_hi, 0
  buffer_load_dwordx4 v[116:119], v6, s[44:47], s75 offen offset:0 sc1
  buffer_load_dwordx4 v[120:123], v6, s[44:47], s75 offen offset:64 sc1
  buffer_load_dwordx4 v[124:127], v6, s[44:47], s75 offen offset:128 sc1
  s_mov_b32 exec_hi, -1
  buffer_load_dwordx4 v[128:131], v6, s[44:47], s72 offen offset:0 sc1
  buffer_load_dwordx4 v[132:135], v6, s[44:47], s72 offen offset:64 sc1
  buffer_load_dwordx4 v[136:139], v6, s[44:47], s72 offen offset:128 sc1
  buffer_load_dwordx4 v[140:143], v6, s[44:47], s73 offen offset:0 sc1
  buffer_load_dwordx4 v[144:147], v6, s[44:47], s73 offen offset:64 sc1
  buffer_load_dwordx4 v[148:151], v6, s[44:47], s73 offen offset:128 sc1
  buffer_load_dwordx4 v[152:155], v6, s[44:47], s74 offen offset:0 sc1
  buffer_load_dwordx4 v[156:159], v6, s[44:47], s74 offen offset:64 sc1
  buffer_load_dwordx4 v[160:163], v6, s[44:47], s74 offen offset:128 sc1
  s_mov_b32 exec_hi, 0
  buffer_load_dwordx4 v[164:167], v6, s[44:47], s75 offen offset:0 sc1
  buffer_load_dwordx4 v[168:171], v6, s[44:47], s75 offen offset:64 sc1
  buffer_load_dwordx4 v[172:175], v6, s[44:47], s75 offen offset:128 sc1
  s_mov_b32 exec_hi, -1
L_gp_119:
  s_waitcnt vmcnt(23)
  v_mfma_f32_16x16x32_bf16 v[40:43], v[64:67], v[80:83], 0
  v_xor_b32 v13, s7, v83
  s_waitcnt vmcnt(22)
  v_mfma_f32_16x16x32_bf16 v[44:47], v[68:71], v[84:87], 0
  v_xor_b32 v14, s7, v87
  s_waitcnt vmcnt(21)
  v_mfma_f32_16x16x32_bf16 v[40:43], v[72:75], v[88:91], v[40:43]
  v_xor_b32 v15, s7, v91
  v_or3_b32 v13, v13, v14, v15
  s_waitcnt vmcnt(20)
  v_mfma_f32_16x16x32_bf16 v[44:47], v[64:67], v[92:95], v[44:47]
  v_xor_b32 v14, s7, v95
  s_waitcnt vmcnt(19)
  v_mfma_f32_16x16x32_bf16 v[40:43], v[68:71], v[96:99], v[40:43]
  v_xor_b32 v15, s7, v99
  v_or3_b32 v13, v13, v14, v15
  s_waitcnt vmcnt(18)
  v_mfma_f32_16x16x32_bf16 v[44:47], v[72:75], v[100:103], v[44:47]
  v_xor_b32 v14, s7, v103
  s_waitcnt vmcnt(17)
  v_mfma_f32_16x16x32_bf16 v[40:43], v[64:67], v[104:107], v[40:43]
  v_xor_b32 v15, s7, v107
  v_or3_b32 v13, v13, v14, v15
  s_waitcnt vmcnt(16)
  v_mfma_f32_16x16x32_bf16 v[44:47], v[68:71], v[108:111], v[44:47]
  v_xor_b32 v14, s7, v111
  s_waitcnt vmcnt(15)
  v_mfma_f32_16x16x32_bf16 v[40:43], v[72:75], v[112:115], v[40:43]
  v_xor_b32 v15, s7, v115
  v_or3_b32 v13, v13, v14, v15
  s_waitcnt vmcnt(14)
  v_mfma_f32_16x16x32_bf16 v[44:47], v[64:67], v[116:119], v[44:47]
  v_xor_b32 v14, s7, v119
  s_waitcnt vmcnt(13)
  v_mfma_f32_16x16x32_bf16 v[40:43], v[68:71], v[120:123], v[40:43]
  v_xor_b32 v15, s7, v123
  v_or3_b32 v13, v13, v14, v15
  s_waitcnt vmcnt(12)
  v_mfma_f32_16x16x32_bf16 v[44:47], v[72:75], v[124:127], v[44:47]
  v_xor_b32 v14, s7, v127
  v_or_b32 v13, v13, v14
  v_cmp_ne_u32 vcc, 0, v13
  s_cbranch_vccz L_gf_120
  buffer_load_dwordx4 v[80:83], v6, s[44:47], s72 offen offset:0 sc1
  buffer_load_dwordx4 v[84:87], v6, s[44:47], s72 offen offset:64 sc1
  buffer_load_dwordx4 v[88:91], v6, s[44:47], s72 offen offset:128 sc1
  buffer_load_dwordx4 v[92:95], v6, s[44:47], s73 offen offset:0 sc1
  buffer_load_dwordx4 v[96:99], v6, s[44:47], s73 offen offset:64 sc1
  buffer_load_dwordx4 v[100:103], v6, s[44:47], s73 offen offset:128 sc1
  buffer_load_dwordx4 v[104:107], v6, s[44:47], s74 offen offset:0 sc1
  buffer_load_dwordx4 v[108:111], v6, s[44:47], s74 offen offset:64 sc1
  buffer_load_dwordx4 v[112:115], v6, s[44:47], s74 offen offset:128 sc1
  s_mov_b32 exec_hi, 0
  buffer_load_dwordx4 v[116:119], v6, s[44:47], s75 offen offset:0 sc1
  buffer_load_dwordx4 v[120:123], v6, s[44:47], s75 offen offset:64 sc1
  buffer_load_dwordx4 v[124:127], v6, s[44:47], s75 offen offset:128 sc1
  s_mov_b32 exec_hi, -1
  s_waitcnt vmcnt(23)
  v_mfma_f32_16x16x32_bf16 v[40:43], v[64:67], v[128:131], 0
  v_xor_b32 v13, s7, v131
  s_waitcnt vmcnt(22)
  v_mfma_f32_16x16x32_bf16 v[44:47], v[68:71], v[132:135], 0
  v_xor_b32 v14, s7, v135
  s_waitcnt vmcnt(21)
  v_mfma_f32_16x16x32_bf16 v[40:43], v[72:75], v[136:139], v[40:43]
  v_xor_b32 v15, s7, v139
  v_or3_b32 v13, v13, v14, v15
  s_waitcnt vmcnt(20)
  v_mfma_f32_16x16x32_bf16 v[44:47], v[64:67], v[140:143], v[44:47]
  v_xor_b32 v14, s7, v143
  s_waitcnt vmcnt(19)
  v_mfma_f32_16x16x32_bf16 v[40:43], v[68:71], v[144:147], v[40:43]
  v_xor_b32 v15, s7, v147
  v_or3_b32 v13, v13, v14, v15
  s_waitcnt vmcnt(18)
  v_mfma_f32_16x16x32_bf16 v[44:47], v[72:75], v[148:151], v[44:47]
  v_xor_b32 v14, s7, v151
  s_waitcnt vmcnt(17)
  v_mfma_f32_16x16x32_bf16 v[40:43], v[64:67], v[152:155], v[40:43]
  v_xor_b32 v15, s7, v155
  v_or3_b32 v13, v13, v14, v15
  s_waitcnt vmcnt(16)
  v_mfma_f32_16x16x32_bf16 v[44:47], v[68:71], v[156:159], v[44:47]
  v_xor_b32 v14, s7, v159
  s_waitcnt vmcnt(15)
  v_mfma_f32_16x16x32_bf16 v[40:43], v[72:75], v[160:163], v[40:43]
  v_xor_b32 v15, s7, v163
  v_or3_b32 v13, v13, v14, v15
  s_waitcnt vmcnt(14)
  v_mfma_f32_16x16x32_bf16 v[44:47], v[64:67], v[164:167], v[44:47]
  v_xor_b32 v14, s7, v167
  s_waitcnt vmcnt(13)
  v_mfma_f32_16x16x32_bf16 v[40:43], v[68:71], v[168:171], v[40:43]
  v_xor_b32 v15, s7, v171
  v_or3_b32 v13, v13, v14, v15
  s_waitcnt vmcnt(12)
  v_mfma_f32_16x16x32_bf16 v[44:47], v[72:75], v[172:175], v[44:47]
  v_xor_b32 v14, s7, v175
  v_or_b32 v13, v13, v14
  v_cmp_ne_u32 vcc, 0, v13
  s_cbranch_vccz L_gf_120
  buffer_load_dwordx4 v[128:131], v6, s[44:47], s72 offen offset:0 sc1
  buffer_load_dwordx4 v[132:135], v6, s[44:47], s72 offen offset:64 sc1
  buffer_load_dwordx4 v[136:139], v6, s[44:47], s72 offen offset:128 sc1
  buffer_load_dwordx4 v[140:143], v6, s[44:47], s73 offen offset:0 sc1
  buffer_load_dwordx4 v[144:147], v6, s[44:47], s73 offen offset:64 sc1
  buffer_load_dwordx4 v[148:151], v6, s[44:47], s73 offen offset:128 sc1
  buffer_load_dwordx4 v[152:155], v6, s[44:47], s74 offen offset:0 sc1
  buffer_load_dwordx4 v[156:159], v6, s[44:47], s74 offen offset:64 sc1
  buffer_load_dwordx4 v[160:163], v6, s[44:47], s74 offen offset:128 sc1
  s_mov_b32 exec_hi, 0
  buffer_load_dwordx4 v[164:167], v6, s[44:47], s75 offen offset:0 sc1
  buffer_load_dwordx4 v[168:171], v6, s[44:47], s75 offen offset:64 sc1
  buffer_load_dwordx4 v[172:175], v6, s[44:47], s75 offen offset:128 sc1
  s_mov_b32 exec_hi, -1
  s_sub_u32 s84, s84, 1
  s_cbranch_scc0 L_gp_119
  s_mov_b32 s84, 0
L_gf_120:
  s_nop 3
  v_pk_add_f32 v[40:41], v[40:41], v[44:45]
  v_pk_add_f32 v[42:43], v[42:43], v[46:47]
  s_nop 0
  v_add_f32_dpp v40, v40, v40 row_ror:4 row_mask:0xf bank_mask:0xf
  v_add_f32_dpp v41, v41, v41 row_ror:4 row_mask:0xf bank_mask:0xf
  v_add_f32_dpp v42, v42, v42 row_ror:4 row_mask:0xf bank_mask:0xf
  v_add_f32_dpp v43, v43, v43 row_ror:4 row_mask:0xf bank_mask:0xf
  v_add_f32_dpp v40, v40, v40 row_ror:8 row_mask:0xf bank_mask:0xf
  v_add_f32_dpp v41, v41, v41 row_ror:8 row_mask:0xf bank_mask:0xf
  v_add_f32_dpp v42, v42, v42 row_ror:8 row_mask:0xf bank_mask:0xf
  v_add_f32_dpp v43, v43, v43 row_ror:8 row_mask:0xf bank_mask:0xf
  v_pk_fma_f32 v[40:41], v[36:37], v[40:41], v[28:29]
  v_pk_fma_f32 v[42:43], v[38:39], v[42:43], v[30:31]
  v_cvt_pk_bf16_f32 v44, v40, v41
  v_cvt_pk_bf16_f32 v45, v42, v43
  s_mov_b32 s10, 0x000f000f
  s_mov_b32 s11, 0x000f000f
  s_mov_b64 exec, s[10:11]
  buffer_store_dwordx2 v[44:45], v2, s[60:63], 0 offen
  s_mov_b64 exec, -1
  s_cmp_lg_u32 s65, 0
  s_cbranch_scc1 L_tdone
  v_mov_b32 v44, s7
  v_mov_b32 v45, 0
  s_mov_b64 exec, 1
  buffer_store_dword v44, v45, s[44:47], 0 offen sc1
  s_mov_b64 exec, -1
  s_branch L_tdone
L_ffn2:
  s_mov_b32 s76, 0x00ff00ff
  s_mov_b32 s77, 0xff
  s_lshl_b32 s66, s64, 10
  s_add_u32 s66, s66, 0x4000
  s_add_u32 s67, s66, 4096
  s_branch L_pchk_123
L_poll_121:
  buffer_load_dwordx4 v[16:19], v5, s[44:47], s66 offen offset:0 sc1
  buffer_load_dwordx4 v[20:23], v5, s[44:47], s67 offen offset:0 sc1
  s_waitcnt vmcnt(0)
  s_branch L_pck2_124
L_pchk_123:
  s_waitcnt vmcnt(8)
L_pck2_124:
  v_xor_b32 v12, s7, v19
  v_xor_b32 v13, s7, v23
  v_or_b32 v12, v12, v13
  v_cmp_ne_u32 vcc, 0, v12
  s_cbranch_vccz L_pdone_122
  s_sub_u32 s84, s84, 1
  s_cbranch_scc0 L_poll_121
  s_mov_b32 s84, 0
L_pdone_122:
  v_lshlrev_b32 v28, 16, v20
  v_and_b32 v29, s82, v20
  v_lshlrev_b32 v30, 16, v21
  v_and_b32 v31, s82, v21
  v_add_f32 v28, 1.0, v28
  v_add_f32 v29, 1.0, v29
  v_add_f32 v30, 1.0, v30
  v_add_f32 v31, 1.0, v31
  v_cvt_pk_bf16_f32 v12, v28, v29
  v_cvt_pk_bf16_f32 v13, v30, v31
  ds_write_b64 v3, v[12:13]
  ds_write_b64 v3, v[16:17] offset:6656
  v_bfe_u32 v104, v0, 3, 1
  v_mul_u32_u24 v104, 6656, v104
  v_add_u32 v104, v4, v104
  ds_read_b128 v[108:111], v104
  ds_read_b128 v[112:115], v104 offset:128
  v_lshrrev_b32 v10, 4, v0
  v_lshlrev_b32 v11, 11, v10
  v_add_u32 v11, 4608, v11
  v_cmp_eq_u32 vcc, 0, v10
  s_nop 1
  v_cndmask_b32 v11, v11, 0, vcc
  v_add_u32 v116, v6, v11
  v_lshrrev_b32 v10, 5, v0
  v_lshlrev_b32 v10, 8, v10
  v_and_b32 v11, 31, v0
  v_lshl_add_u32 v10, v11, 2, v10
  v_add_u32 v2, 13312, v10
  v_add_u32 v117, 14336, v10
  v_add_u32 v118, 19968, v10
  v_add_u32 v119, 20992, v10
  v_add_u32 v122, 22016, v10
  v_add_u32 v123, 23040, v10
  v_and_b32 v10, 1, v0
  v_lshlrev_b32 v120, 11, v10
  v_bfe_u32 v10, v0, 1, 1
  v_lshl_add_u32 v120, v10, 7, v120
  v_bfe_u32 v10, v0, 2, 1
  v_lshl_add_u32 v120, v10, 4, v120
  v_bfe_u32 v10, v0, 3, 1
  v_lshl_add_u32 v120, v10, 8, v120
  v_lshrrev_b32 v10, 4, v0
  v_lshl_add_u32 v120, v10, 5, v120
  s_lshl_b32 s8, s64, 9
  v_add_u32 v120, s8, v120
  v_lshrrev_b32 v10, 5, v0
  v_lshlrev_b32 v10, 8, v10
  v_and_b32 v11, 15, v0
  v_lshl_add_u32 v121, v11, 4, v10
  s_lshl_b32 s70, s4, 12
  s_add_u32 s70, s70, 0xb8000
  s_lshl_b32 s71, s4, 9
  s_add_u32 s71, s71, 0xc0000
  s_lshl_b32 s8, s64, 8
  s_add_u32 s8, s8, 16000
  v_lshrrev_b32 v10, 5, v0
  v_lshlrev_b32 v10, 7, v10
  v_and_b32 v11, 31, v0
  v_lshl_add_u32 v97, v11, 1, v10
  v_add_u32 v97, s8, v97
  v_and_b32 v10, 1, v0
  v_lshlrev_b32 v10, 7, v10
  v_lshrrev_b32 v12, 4, v0
  v_lshlrev_b32 v12, 4, v12
  v_add3_u32 v98, v10, v12, s8
  v_bfe_u32 v99, v0, 2, 2
  v_mul_u32_u24 v99, 192, v99
  v_and_b32 v10, 3, v0
  v_lshl_add_u32 v99, v10, 4, v99
  s_mul_i32 s8, s64, 768
  s_mul_i32 s75, s65, 3072
  s_add_u32 s75, s75, s8
  s_add_u32 s75, s75, 0xc8000
  v_mov_b32 v102, 0
  v_mov_b32 v103, s7
  v_lshrrev_b32 v10, 4, v0
  v_lshl_add_u32 v99, v10, 6, v99
  s_waitcnt lgkmcnt(0)
  v_mov_b32 v12, 1056
L_lw_125:
  ds_read_b128 v[8:11], v12
  s_waitcnt lgkmcnt(0)
  v_min3_u32 v8, v8, v9, v10
  v_min_u32 v8, v8, v11
  v_cmp_ne_u32 vcc, 0, v8
  s_cbranch_vccnz L_lwd_126
  s_sub_u32 s84, s84, 1
  s_cbranch_scc0 L_lw_125
  s_mov_b32 s84, 0
L_lwd_126:
L_poll_127:
  buffer_load_dwordx4 v[104:107], v121, s[44:47], s71 offen sc1
  buffer_load_dwordx4 v[8:11], v120, s[44:47], s70 offen offset:0 sc1
  s_waitcnt vmcnt(0)
  v_xor_b32 v20, s7, v11
  v_cmp_ne_u32 vcc, 0, v20
  s_cbranch_vccz L_pdone_128
  s_sub_u32 s84, s84, 1
  s_cbranch_scc0 L_poll_127
  s_mov_b32 s84, 0
L_pdone_128:
  v_xor_b32 v124, s7, v107
  v_cmp_ne_u32 vcc, 0, v124
  s_cbranch_vccnz L_xslow_130
  v_mov_b32_dpp v108, v8 quad_perm:[0,1,2,3] row_mask:0xf bank_mask:0x1
  v_mov_b32_dpp v109, v9 quad_perm:[0,1,2,3] row_mask:0xf bank_mask:0x1
  v_mov_b32_dpp v110, v8 row_shl:4 row_mask:0xf bank_mask:0x1
  v_mov_b32_dpp v111, v9 row_shl:4 row_mask:0xf bank_mask:0x1
  s_nop 1
  v_mfma_f32_16x16x32_bf16 v[32:35], v[108:111], v[128:131], 0
  v_mov_b32_dpp v112, v8 row_shl:8 row_mask:0xf bank_mask:0x1
  v_mov_b32_dpp v113, v9 row_shl:8 row_mask:0xf bank_mask:0x1
  v_mfma_f32_16x16x32_bf16 v[36:39], v[108:111], v[132:135], 0
  v_mov_b32_dpp v114, v8 row_shl:12 row_mask:0xf bank_mask:0x1
  v_mov_b32_dpp v115, v9 row_shl:12 row_mask:0xf bank_mask:0x1
  v_mfma_f32_16x16x32_bf16 v[40:43], v[108:111], v[136:139], 0
  v_add_f32_dpp v104, v104, v104 row_ror:8 row_mask:0xf bank_mask:0xf
  v_add_f32_dpp v105, v105, v105 row_ror:8 row_mask:0xf bank_mask:0xf
  s_nop 0
  v_add_f32_dpp v104, v104, v104 row_ror:4 row_mask:0xf bank_mask:0xf
  v_mfma_f32_16x16x32_bf16 v[44:47], v[108:111], v[140:143], 0
  v_add_f32_dpp v105, v105, v105 row_ror:4 row_mask:0xf bank_mask:0xf
  v_add_f32_dpp v104, v104, v104 row_ror:2 row_mask:0xf bank_mask:0xf
  s_nop 0
  v_add_f32_dpp v105, v105, v105 row_ror:2 row_mask:0xf bank_mask:0xf
  v_mfma_f32_16x16x32_bf16 v[48:51], v[108:111], v[144:147], 0
  v_add_f32_dpp v104, v104, v104 row_ror:1 row_mask:0xf bank_mask:0xf
  v_add_f32_dpp v105, v105, v105 row_ror:1 row_mask:0xf bank_mask:0xf
  v_mul_f32 v104, 0x3b000000, v104
  v_mfma_f32_16x16x32_bf16 v[52:55], v[108:111], v[148:151], 0
  v_mul_f32 v105, 0x3b000000, v105
  v_fma_f32 v105, -v104, v104, v105
  v_max_f32 v105, 0, v105
  v_mfma_f32_16x16x32_bf16 v[56:59], v[108:111], v[152:155], 0
  v_cvt_pk_bf16_f32 v12, v104, v104
  v_lshlrev_b32 v104, 16, v12
  v_cvt_pk_bf16_f32 v12, v105, v105
  v_mfma_f32_16x16x32_bf16 v[60:63], v[108:111], v[156:159], 0
  v_lshlrev_b32 v105, 16, v12
  v_add_f32 v105, 0x3727c5ac, v105
  v_cvt_pk_bf16_f32 v12, v105, v105
  v_mfma_f32_16x16x32_bf16 v[32:35], v[112:115], v[160:163], v[32:35]
  v_lshlrev_b32 v105, 16, v12
  v_sqrt_f32 v105, v105
  s_nop 0
  v_cvt_pk_bf16_f32 v12, v105, v105
  v_mfma_f32_16x16x32_bf16 v[36:39], v[112:115], v[164:167], v[36:39]
  v_lshlrev_b32 v105, 16, v12
  v_rcp_f32 v105, v105
  s_nop 0
  v_mul_f32 v106, v104, v105
  v_mfma_f32_16x16x32_bf16 v[40:43], v[112:115], v[168:171], v[40:43]
  v_mov_b32 v104, v105
  v_mfma_f32_16x16x32_bf16 v[44:47], v[112:115], v[172:175], v[44:47]
  v_mfma_f32_16x16x32_bf16 v[48:51], v[112:115], v[176:179], v[48:51]
  v_mfma_f32_16x16x32_bf16 v[52:55], v[112:115], v[180:183], v[52:55]
  v_mfma_f32_16x16x32_bf16 v[56:59], v[112:115], v[184:187], v[56:59]
  v_mfma_f32_16x16x32_bf16 v[60:63], v[112:115], v[188:191], v[60:63]
  v_add_f32_dpp v16, v34, v32 row_shl:8 row_mask:0xf bank_mask:0xf
  v_add_f32_dpp v24, v35, v33 row_shl:8 row_mask:0xf bank_mask:0xf
  v_add_f32_dpp v17, v38, v36 row_shl:8 row_mask:0xf bank_mask:0xf
  v_add_f32_dpp v25, v39, v37 row_shl:8 row_mask:0xf bank_mask:0xf
  v_add_f32_dpp v18, v42, v40 row_shl:8 row_mask:0xf bank_mask:0xf
  v_add_f32_dpp v26, v43, v41 row_shl:8 row_mask:0xf bank_mask:0xf
  v_add_f32_dpp v19, v46, v44 row_shl:8 row_mask:0xf bank_mask:0xf
  v_add_f32_dpp v27, v47, v45 row_shl:8 row_mask:0xf bank_mask:0xf
  v_add_f32_dpp v20, v50, v48 row_shl:8 row_mask:0xf bank_mask:0xf
  v_add_f32_dpp v28, v51, v49 row_shl:8 row_mask:0xf bank_mask:0xf
  v_add_f32_dpp v21, v54, v52 row_shl:8 row_mask:0xf bank_mask:0xf
  v_add_f32_dpp v29, v55, v53 row_shl:8 row_mask:0xf bank_mask:0xf
  v_add_f32_dpp v22, v58, v56 row_shl:8 row_mask:0xf bank_mask:0xf
  v_add_f32_dpp v30, v59, v57 row_shl:8 row_mask:0xf bank_mask:0xf
  v_add_f32_dpp v23, v62, v60 row_shl:8 row_mask:0xf bank_mask:0xf
  v_add_f32_dpp v31, v63, v61 row_shl:8 row_mask:0xf bank_mask:0xf
  s_mov_b64 exec, s[76:77]
  ds_write_b128 v116, v[16:19]
  ds_write_b128 v116, v[20:23] offset:16
  ds_write_b128 v116, v[24:27] offset:256
  ds_write_b128 v116, v[28:31] offset:272
  s_mov_b64 exec, -1
  s_lshl_b32 s8, s64, 2
  s_add_u32 s8, s8, 1072
  v_mov_b32 v8, s8
  v_mov_b32 v9, 1
  s_mov_b64 s[10:11], exec
  s_mov_b64 exec, 1
  ds_write_b32 v8, v9
  s_mov_b64 exec, s[10:11]
  v_perm_b32 v64, v196, v192, s80
  v_perm_b32 v68, v196, v192, s81
  v_perm_b32 v65, v204, v200, s80
  v_perm_b32 v69, v204, v200, s81
  v_perm_b32 v66, v212, v208, s80
  v_perm_b32 v70, v212, v208, s81
  v_perm_b32 v67, v220, v216, s80
  v_perm_b32 v71, v220, v216, s81
  v_perm_b32 v72, v197, v193, s80
  v_perm_b32 v76, v197, v193, s81
  v_perm_b32 v73, v205, v201, s80
  v_perm_b32 v77, v205, v201, s81
  v_perm_b32 v74, v213, v209, s80
  v_perm_b32 v78, v213, v209, s81
  v_perm_b32 v75, v221, v217, s80
  v_perm_b32 v79, v221, v217, s81
  v_perm_b32 v80, v198, v194, s80
  v_perm_b32 v84, v198, v194, s81
  v_perm_b32 v81, v206, v202, s80
  v_perm_b32 v85, v206, v202, s81
  v_perm_b32 v82, v214, v210, s80
  v_perm_b32 v86, v214, v210, s81
  v_perm_b32 v83, v222, v218, s80
  v_perm_b32 v87, v222, v218, s81
  v_perm_b32 v88, v199, v195, s80
  v_perm_b32 v92, v199, v195, s81
  v_perm_b32 v89, v207, v203, s80
  v_perm_b32 v93, v207, v203, s81
  v_perm_b32 v90, v215, v211, s80
  v_perm_b32 v94, v215, v211, s81
  v_perm_b32 v91, v223, v219, s80
  v_perm_b32 v95, v223, v219, s81
  s_branch L_xjoin_131
L_xslow_130:
  buffer_load_dwordx4 v[104:107], v121, s[44:47], s71 offen sc1
  v_mov_b32_dpp v108, v8 quad_perm:[0,1,2,3] row_mask:0xf bank_mask:0x1
  v_mov_b32_dpp v109, v9 quad_perm:[0,1,2,3] row_mask:0xf bank_mask:0x1
  v_mov_b32_dpp v110, v8 row_shl:4 row_mask:0xf bank_mask:0x1
  v_mov_b32_dpp v111, v9 row_shl:4 row_mask:0xf bank_mask:0x1
  s_nop 1
  v_mfma_f32_16x16x32_bf16 v[32:35], v[108:111], v[128:131], 0
  v_mov_b32_dpp v112, v8 row_shl:8 row_mask:0xf bank_mask:0x1
  v_mov_b32_dpp v113, v9 row_shl:8 row_mask:0xf bank_mask:0x1
  v_mfma_f32_16x16x32_bf16 v[36:39], v[108:111], v[132:135], 0
  v_mov_b32_dpp v114, v8 row_shl:12 row_mask:0xf bank_mask:0x1
  v_mov_b32_dpp v115, v9 row_shl:12 row_mask:0xf bank_mask:0x1
  v_mfma_f32_16x16x32_bf16 v[40:43], v[108:111], v[136:139], 0
  v_mfma_f32_16x16x32_bf16 v[44:47], v[108:111], v[140:143], 0
  v_mfma_f32_16x16x32_bf16 v[48:51], v[108:111], v[144:147], 0
  v_mfma_f32_16x16x32_bf16 v[52:55], v[108:111], v[148:151], 0
  v_mfma_f32_16x16x32_bf16 v[56:59], v[108:111], v[152:155], 0
  v_mfma_f32_16x16x32_bf16 v[60:63], v[108:111], v[156:159], 0
  v_mfma_f32_16x16x32_bf16 v[32:35], v[112:115], v[160:163], v[32:35]
  v_mfma_f32_16x16x32_bf16 v[36:39], v[112:115], v[164:167], v[36:39]
  v_mfma_f32_16x16x32_bf16 v[40:43], v[112:115], v[168:171], v[40:43]
  v_mfma_f32_16x16x32_bf16 v[44:47], v[112:115], v[172:175], v[44:47]
  v_mfma_f32_16x16x32_bf16 v[48:51], v[112:115], v[176:179], v[48:51]
  v_mfma_f32_16x16x32_bf16 v[52:55], v[112:115], v[180:183], v[52:55]
  v_mfma_f32_16x16x32_bf16 v[56:59], v[112:115], v[184:187], v[56:59]
  v_mfma_f32_16x16x32_bf16 v[60:63], v[112:115], v[188:191], v[60:63]
  s_nop 0
  v_add_f32_dpp v16, v34, v32 row_shl:8 row_mask:0xf bank_mask:0xf
  v_add_f32_dpp v24, v35, v33 row_shl:8 row_mask:0xf bank_mask:0xf
  v_add_f32_dpp v17, v38, v36 row_shl:8 row_mask:0xf bank_mask:0xf
  v_add_f32_dpp v25, v39, v37 row_shl:8 row_mask:0xf bank_mask:0xf
  v_add_f32_dpp v18, v42, v40 row_shl:8 row_mask:0xf bank_mask:0xf
  v_add_f32_dpp v26, v43, v41 row_shl:8 row_mask:0xf bank_mask:0xf
  v_add_f32_dpp v19, v46, v44 row_shl:8 row_mask:0xf bank_mask:0xf
  v_add_f32_dpp v27, v47, v45 row_shl:8 row_mask:0xf bank_mask:0xf
  v_add_f32_dpp v20, v50, v48 row_shl:8 row_mask:0xf bank_mask:0xf
  v_add_f32_dpp v28, v51, v49 row_shl:8 row_mask:0xf bank_mask:0xf
  v_add_f32_dpp v21, v54, v52 row_shl:8 row_mask:0xf bank_mask:0xf
  v_add_f32_dpp v29, v55, v53 row_shl:8 row_mask:0xf bank_mask:0xf
  v_add_f32_dpp v22, v58, v56 row_shl:8 row_mask:0xf bank_mask:0xf
  v_add_f32_dpp v30, v59, v57 row_shl:8 row_mask:0xf bank_mask:0xf
  v_add_f32_dpp v23, v62, v60 row_shl:8 row_mask:0xf bank_mask:0xf
  v_add_f32_dpp v31, v63, v61 row_shl:8 row_mask:0xf bank_mask:0xf
  s_mov_b64 exec, s[76:77]
  ds_write_b128 v116, v[16:19]
  ds_write_b128 v116, v[20:23] offset:16
  ds_write_b128 v116, v[24:27] offset:256
  ds_write_b128 v116, v[28:31] offset:272
  s_mov_b64 exec, -1
  s_lshl_b32 s8, s64, 2
  s_add_u32 s8, s8, 1072
  v_mov_b32 v8, s8
  v_mov_b32 v9, 1
  s_mov_b64 s[10:11], exec
  s_mov_b64 exec, 1
  ds_write_b32 v8, v9
  s_mov_b64 exec, s[10:11]
  v_perm_b32 v64, v196, v192, s80
  v_perm_b32 v68, v196, v192, s81
  v_perm_b32 v65, v204, v200, s80
  v_perm_b32 v69, v204, v200, s81
  v_perm_b32 v66, v212, v208, s80
  v_perm_b32 v70, v212, v208, s81
  v_perm_b32 v67, v220, v216, s80
  v_perm_b32 v71, v220, v216, s81
  v_perm_b32 v72, v197, v193, s80
  v_perm_b32 v76, v197, v193, s81
  v_perm_b32 v73, v205, v201, s80
  v_perm_b32 v77, v205, v201, s81
  v_perm_b32 v74, v213, v209, s80
  v_perm_b32 v78, v213, v209, s81
  v_perm_b32 v75, v221, v217, s80
  v_perm_b32 v79, v221, v217, s81
  v_perm_b32 v80, v198, v194, s80
  v_perm_b32 v84, v198, v194, s81
  v_perm_b32 v81, v206, v202, s80
  v_perm_b32 v85, v206, v202, s81
  v_perm_b32 v82, v214, v210, s80
  v_perm_b32 v86, v214, v210, s81
  v_perm_b32 v83, v222, v218, s80
  v_perm_b32 v87, v222, v218, s81
  v_perm_b32 v88, v199, v195, s80
  v_perm_b32 v92, v199, v195, s81
  v_perm_b32 v89, v207, v203, s80
  v_perm_b32 v93, v207, v203, s81
  v_perm_b32 v90, v215, v211, s80
  v_perm_b32 v94, v215, v211, s81
  v_perm_b32 v91, v223, v219, s80
  v_perm_b32 v95, v223, v219, s81
  s_waitcnt vmcnt(0)
L_xc_132:
  v_xor_b32 v124, s7, v107
  v_cmp_ne_u32 vcc, 0, v124
  s_cbranch_vccz L_xo_133
  buffer_load_dwordx4 v[104:107], v121, s[44:47], s71 offen sc1
  s_waitcnt vmcnt(0)
  s_sub_u32 s84, s84, 1
  s_cbranch_scc0 L_xc_132
  s_mov_b32 s84, 0
L_xo_133:
  v_add_f32_dpp v104, v104, v104 row_ror:8 row_mask:0xf bank_mask:0xf
  v_add_f32_dpp v105, v105, v105 row_ror:8 row_mask:0xf bank_mask:0xf
  s_nop 0
  v_add_f32_dpp v104, v104, v104 row_ror:4 row_mask:0xf bank_mask:0xf
  v_add_f32_dpp v105, v105, v105 row_ror:4 row_mask:0xf bank_mask:0xf
  s_nop 0
  v_add_f32_dpp v104, v104, v104 row_ror:2 row_mask:0xf bank_mask:0xf
  v_add_f32_dpp v105, v105, v105 row_ror:2 row_mask:0xf bank_mask:0xf
  s_nop 0
  v_add_f32_dpp v104, v104, v104 row_ror:1 row_mask:0xf bank_mask:0xf
  v_add_f32_dpp v105, v105, v105 row_ror:1 row_mask:0xf bank_mask:0xf
  v_mul_f32 v104, 0x3b000000, v104
  v_mul_f32 v105, 0x3b000000, v105
  v_fma_f32 v105, -v104, v104, v105
  v_max_f32 v105, 0, v105
  v_cvt_pk_bf16_f32 v12, v104, v104
  v_lshlrev_b32 v104, 16, v12
  v_cvt_pk_bf16_f32 v12, v105, v105
  v_lshlrev_b32 v105, 16, v12
  v_add_f32 v105, 0x3727c5ac, v105
  v_cvt_pk_bf16_f32 v12, v105, v105
  v_lshlrev_b32 v105, 16, v12
  v_sqrt_f32 v105, v105
  s_nop 0
  v_cvt_pk_bf16_f32 v12, v105, v105
  v_lshlrev_b32 v105, 16, v12
  v_rcp_f32 v105, v105
  s_nop 0
  v_mul_f32 v106, v104, v105
  v_mov_b32 v104, v105
L_xjoin_131:
  v_mov_b32 v12, 1072
L_lw_134:
  ds_read_b128 v[8:11], v12
  ds_read2_b32 v[32:33], v2 offset0:0 offset1:32
  ds_read2_b32 v[34:35], v2 offset0:128 offset1:160
  ds_read2_b32 v[36:37], v117 offset0:0 offset1:32
  ds_read2_b32 v[38:39], v117 offset0:128 offset1:160
  ds_read2_b32 v[40:41], v118 offset0:0 offset1:32
  ds_read2_b32 v[42:43], v118 offset0:128 offset1:160
  ds_read2_b32 v[44:45], v119 offset0:0 offset1:32
  ds_read2_b32 v[46:47], v119 offset0:128 offset1:160
  ds_read2_b32 v[48:49], v122 offset0:0 offset1:32
  ds_read2_b32 v[50:51], v122 offset0:128 offset1:160
  ds_read2_b32 v[52:53], v123 offset0:0 offset1:32
  ds_read2_b32 v[54:55], v123 offset0:128 offset1:160
  s_waitcnt lgkmcnt(0)
  v_min3_u32 v8, v8, v9, v10
  v_min_u32 v8, v8, v11
  v_cmp_ne_u32 vcc, 0, v8
  s_cbranch_vccnz L_lwd_135
  s_sub_u32 s84, s84, 1
  s_cbranch_scc0 L_lw_134
  s_mov_b32 s84, 0
L_lwd_135:
  v_pk_add_f32 v[40:41], v[40:41], v[42:43]
  v_pk_add_f32 v[44:45], v[44:45], v[46:47]
  v_pk_add_f32 v[48:49], v[48:49], v[50:51]
  v_pk_add_f32 v[52:53], v[52:53], v[54:55]
  v_pk_add_f32 v[32:33], v[32:33], v[34:35]
  v_pk_add_f32 v[36:37], v[36:37], v[38:39]
  v_pk_add_f32 v[40:41], v[40:41], v[44:45]
  v_pk_add_f32 v[48:49], v[48:49], v[52:53]
  v_pk_add_f32 v[32:33], v[32:33], v[36:37]
  v_pk_fma_f32 v[48:49], v[106:107], v[40:41], v[48:49] op_sel_hi:[0,1,1] neg_lo:[1,0,0] neg_hi:[1,0,0]
  v_pk_fma_f32 v[32:33], v[104:105], v[32:33], v[48:49]
  v_mul_f32 v34, s85, v32
  v_exp_f32 v34, -v34
  s_nop 0
  v_add_f32 v34, 1.0, v34
  v_rcp_f32 v34, v34
  s_nop 0
  v_mul_f32 v32, v32, v34
  v_mul_f32 v32, v32, v33
  v_cvt_pk_bf16_f32 v12, v32, v32
  ds_write_b16 v97, v12
  ds_read_b128 v[8:11], v98 offset:0
  s_waitcnt lgkmcnt(0)
  v_mfma_f32_16x16x32_bf16 v[32:35], v[8:11], v[64:67], 0
  v_mfma_f32_16x16x32_bf16 v[36:39], v[8:11], v[68:71], 0
  v_mfma_f32_16x16x32_bf16 v[40:43], v[8:11], v[72:75], 0
  v_mfma_f32_16x16x32_bf16 v[44:47], v[8:11], v[76:79], 0
  v_mfma_f32_16x16x32_bf16 v[48:51], v[8:11], v[80:83], 0
  v_mfma_f32_16x16x32_bf16 v[52:55], v[8:11], v[84:87], 0
  v_mfma_f32_16x16x32_bf16 v[56:59], v[8:11], v[88:91], 0
  v_mfma_f32_16x16x32_bf16 v[60:63], v[8:11], v[92:95], 0
  s_mov_b64 exec, 0xffff
  s_nop 0
  v_cvt_pk_bf16_f32 v100, v32, v36
  s_nop 0
  v_cvt_pk_bf16_f32 v101, v40, v44
  s_nop 0
  v_cvt_pk_bf16_f32 v102, v48, v52
  s_mov_b32 exec_lo, 0xffff0000
  v_cvt_pk_bf16_f32 v100, v56, v60
  v_cvt_pk_bf16_f32 v101, v33, v37
  v_cvt_pk_bf16_f32 v102, v41, v45
  s_mov_b32 exec_lo, 0
  s_mov_b32 exec_hi, 0xffff
  v_cvt_pk_bf16_f32 v100, v49, v53
  v_cvt_pk_bf16_f32 v101, v57, v61
  s_mov_b32 exec_lo, 0xffffffff
  buffer_store_dwordx4 v[100:103], v99, s[44:47], s75 offen sc1
  s_mov_b64 exec, -1
L_tdone:
  s_endpgm
L_exit:
  s_endpgm
.section .rodata,"a"
.p2align 6
.amdhsa_kernel adaLN_cond__sliding_block_cached__glu_gated_swiglu__decode_kernel
  .amdhsa_next_free_vgpr 256
  .amdhsa_next_free_sgpr 102
  .amdhsa_accum_offset 256
  .amdhsa_group_segment_fixed_size 0
  .amdhsa_kernarg_size 112
  .amdhsa_user_sgpr_count 2
  .amdhsa_user_sgpr_kernarg_segment_ptr 1
  .amdhsa_system_sgpr_workgroup_id_x 1
.end_amdhsa_kernel
```
